```python
import torch

def _softmax(x, axis=-1):
    return torch.softmax(x, dim=axis)
def _gelu(x):
    return torch.nn.functional.gelu(x, approximate="tanh")
def _silu(x):
    return torch.nn.functional.silu(x)
def _sigmoid(x):
    return torch.sigmoid(x)
def _layernorm(x, axis=-1, eps=1e-5):
    m = x.mean(dim=axis, keepdim=True)
    v = x.var(dim=axis, keepdim=True, unbiased=False)
    return (x - m) / torch.sqrt(v + eps)
def _scatter_add(tgt, idx, src, axis=0):
    return tgt.clone().index_add_(axis, idx, src)
def _segment_sum(src, seg, n):
    out = torch.zeros((n,) + src.shape[1:], dtype=src.dtype)
    return out.index_add_(0, seg, src)
def _pad(x, pw):
    flat = tuple(v for pair in reversed(pw) for v in pair)
    return torch.nn.functional.pad(x, flat)

kernel_name = 'recurrent_scan__spectral_fnet__glu_gated_glu__prompt'

def setup_inputs():

    _w = (lambda a: (lambda t: t.to(torch.bfloat16) if t.is_floating_point() else t)(torch.as_tensor(a)))
    def _A_setup():
        B, S, D = 1, 2048, 512
        ns = torch.arange(S)[:, None] * torch.arange(S)[None, :]
        nd = torch.arange(D)[:, None] * torch.arange(D)[None, :]
        Ws_re = torch.cos(-2.0 * torch.pi * ns / S).to(float)
        Ws_im = torch.sin(-2.0 * torch.pi * ns / S).to(float)
        Wd_re = torch.cos(-2.0 * torch.pi * nd / D).to(float)
        Wd_im = torch.sin(-2.0 * torch.pi * nd / D).to(float)
        return {
            "x": _w((lambda *s: torch.randn(*s, dtype=torch.bfloat16) * 0.05)(B, S, D)),
            "dft_seq_re": _w(Ws_re),
            "dft_seq_im": _w(Ws_im),
            "dft_hid_re": _w(Wd_re),
            "dft_hid_im": _w(Wd_im),
        }
    _A_in = _A_setup()

    def _B_setup():
        B, S, D, F = 1, 2048, 512, 1792
        return {
            "x": _w((lambda *s: torch.randn(*s, dtype=torch.bfloat16) * 0.05)(B, S, D)),
            "w_gate": _w((lambda *s: torch.randn(*s, dtype=torch.bfloat16) * 0.05)(D, F)),
            "w_up": _w((lambda *s: torch.randn(*s, dtype=torch.bfloat16) * 0.05)(D, F)),
            "w_down": _w((lambda *s: torch.randn(*s, dtype=torch.bfloat16) * 0.05)(F, D)),
        }
    _B_in = _B_setup()

    return {
        "A_x": _A_in["x"],
        "A_dft_seq_re": _A_in["dft_seq_re"],
        "A_dft_seq_im": _A_in["dft_seq_im"],
        "A_dft_hid_re": _A_in["dft_hid_re"],
        "A_dft_hid_im": _A_in["dft_hid_im"],
        "B_x": _B_in["x"],
        "B_w_gate": _B_in["w_gate"],
        "B_w_up": _B_in["w_up"],
        "B_w_down": _B_in["w_down"],
    }

def reference(A_x, A_dft_seq_re, A_dft_seq_im, A_dft_hid_re, A_dft_hid_im, B_x, B_w_gate, B_w_up, B_w_down):
    def _A_ref(x, dft_seq_re, dft_seq_im, dft_hid_re, dft_hid_im):
        a = torch.einsum("bsd,ed->bse", x, dft_hid_re)
        b = torch.einsum("bsd,ed->bse", x, dft_hid_im)
        y = torch.einsum("ts,bse->bte", dft_seq_re, a) - torch.einsum("ts,bse->bte", dft_seq_im, b)
        return y

    def _B_ref(x, w_gate, w_up, w_down):
        g = torch.einsum("bsd,df->bsf", x, w_gate)
        u = torch.einsum("bsd,df->bsf", x, w_up)
        h = _sigmoid(g) * u
        return torch.einsum("bsf,fd->bsd", h, w_down)

    x = A_x
    xn = _layernorm(x, axis=-1)
    s = _A_ref(xn, A_dft_seq_re, A_dft_seq_im, A_dft_hid_re, A_dft_hid_im)
    g = _silu(_B_ref(xn, B_w_gate, B_w_up, B_w_down))
    return x + s * g
```

```asm
; @launch grid=(256,1,1) block=(256,1,1) lds=163840
.amdgcn_target "amdgcn-amd-amdhsa--gfx950"
.text
.globl recurrent_scan__spectral_fnet__glu_gated_glu__prompt_kernel
.p2align 8
.type recurrent_scan__spectral_fnet__glu_gated_glu__prompt_kernel,@function
recurrent_scan__spectral_fnet__glu_gated_glu__prompt_kernel:
    s_load_dwordx2 s[4:5], s[0:1], 0
    s_getpc_b64 s[40:41]
L_pc:
    s_cmpk_ge_u32 s2, 0x100
    s_cbranch_scc1 L_end
    s_mov_b32 s42, L_end-L_pc
    s_mov_b32 s43, 0x20000
    v_lshrrev_b32 v27, 4, v0
    v_lshlrev_b32 v27, 7, v27
    s_lshr_b32 s100, s2, 3
    s_lshl_b32 s94, s100, 11
    buffer_load_dword v38, v27, s[40:43], s94 offen
    s_lshl_b32 s6, 1, 21
    s_mov_b32 s7, s43
    s_load_dwordx16 s[44:59], s[0:1], 0
    s_load_dwordx8 s[60:67], s[0:1], 64
    v_lshrrev_b32 v1, 6, v0
    v_and_b32 v0, 63, v0
    v_readfirstlane_b32 s68, v1
    s_and_b32 s69, s2, 1
    s_lshl_b32 s69, s69, 3
    s_and_b32 s95, s100, 7
    s_add_u32 s69, s69, s95
    s_and_b32 s70, s2, 6
    s_lshl_b32 s70, s70, 1
    s_lshr_b32 s94, s100, 3
    s_add_u32 s70, s70, s94
    s_lshl_b32 s71, s94, 1
    s_add_u32 s71, s71, s95
    s_bfe_u32 s95, s2, 0x10001
    s_add_u32 s71, s71, s95
    s_and_b32 s71, s71, 7
    v_lshrrev_b32 v24, 3, v0
    v_and_b32 v25, 7, v0
    v_lshrrev_b32 v26, 1, v24
    v_xor_b32 v26, v26, v25
    v_lshlrev_b32 v26, 4, v26
    v_lshl_add_u32 v1, v24, 17, v26
    v_xor_b32 v2, 64, v1
    v_add_u32 v2, 0xffc00, v2
    s_lshl_b32 s95, s68, 5
    s_add_u32 s95, s95, s69
    s_lshl_b32 s3, s95, 10
    s_lshl_b32 s95, s68, 15
    s_add_u32 s101, s95, 32768
    s_waitcnt lgkmcnt(0)
    s_lshl_b32 s98, s71, 7
    s_add_u32 s98, s98, s3
    s_add_u32 s99, s98, 14336
    s_add_u32 m0, s101, 0
    s_nop 0
    buffer_load_dwordx4 v1, s[4:7], s98 offen offset:0 lds
    buffer_load_dwordx4 v2, s[4:7], s98 offen offset:1024 lds
    buffer_load_dwordx4 v1, s[4:7], s99 offen offset:2048 lds
    buffer_load_dwordx4 v2, s[4:7], s99 offen offset:3072 lds
    s_cmp_ge_u32 s70, 14
    s_cselect_b32 s94, 0, 1
    v_lshrrev_b32 v24, 2, v0
    v_add_u32 v24, v24, v0
    v_mad_u32_u24 v24, v24, s94, v0
    v_add_u32 v24, s71, v24
    v_and_b32 v35, 7, v24
    v_lshlrev_b32 v24, 7, v35
    v_add_u32 v24, s3, v24
    v_add_u32 v40, 0x3800, v1
    v_add_u32 v41, 0x3800, v2
    v_readlane_b32 s81, v24, 1
    v_readlane_b32 s82, v24, 2
    v_readlane_b32 s83, v24, 3
    v_readlane_b32 s84, v24, 4
    v_readlane_b32 s85, v24, 5
    v_readlane_b32 s86, v24, 6
    v_readlane_b32 s87, v24, 7
    s_mov_b32 s20, s66
    s_mov_b32 s21, s67
    s_mov_b32 s22, 0xe00000
    s_mov_b32 s23, 0x20000
    s_mov_b32 s36, s64
    s_mov_b32 s37, s65
    s_mov_b32 s38, 0x100
    s_mov_b32 s39, 0x20000
    s_or_b32 s95, s2, s68
    s_cmp_lg_u32 s95, 0
    s_cbranch_scc1 L_notag
    buffer_load_dword v63, off, s[20:23], 0 sc1
L_notag:
    s_mov_b32 s16, s60
    s_mov_b32 s17, s61
    s_mov_b32 s18, 0x1c0000
    s_mov_b32 s19, 0x20000
    s_mov_b32 s24, s62
    s_mov_b32 s25, s63
    s_mov_b32 s26, 0x200000
    s_mov_b32 s27, 0x20000
    s_mov_b32 s76, 0xffff0000
    s_mov_b32 s77, 0x3f803f80
    v_lshrrev_b32 v24, 5, v0
    v_and_b32 v25, 31, v0
    v_bfe_u32 v26, v0, 1, 3
    v_xor_b32 v26, v26, v24
    v_lshlrev_b32 v26, 4, v26
    v_lshl_add_u32 v26, v25, 7, v26
    v_add_u32 v3, s101, v26
    v_xor_b32 v4, 32, v3
    v_xor_b32 v5, 64, v3
    v_xor_b32 v6, 96, v3
    v_mov_b32 v18, 0
    v_mov_b32 v19, 0
    v_mov_b32 v20, 0
    v_mov_b32 v21, 0
    s_cmp_ge_u32 s70, 14
    s_cbranch_scc1 L_dft
    s_mov_b32 s8, s56
    s_mov_b32 s9, s57
    s_mov_b32 s10, 0x1c0000
    s_mov_b32 s11, 0x20000
    s_sub_u32 s12, s58, 0x800
    s_subb_u32 s13, s59, 0
    s_mov_b32 s14, 0x1c0800
    s_mov_b32 s15, 0x20000
    v_lshrrev_b32 v24, 3, v0
    v_bfe_u32 v25, v0, 1, 2
    v_bfe_u32 v26, v0, 4, 1
    v_xor_b32 v25, v25, v26
    v_lshlrev_b32 v25, 5, v25
    v_and_b32 v26, 1, v0
    v_lshl_add_u32 v25, v26, 4, v25
    v_mul_u32_u24 v24, 0xe00, v24
    v_add_u32 v7, v24, v25
    v_xor_b32 v25, 64, v25
    v_add_u32 v8, v24, v25
    v_add_u32 v36, 0x6c00, v7
    v_add_u32 v37, 0x6c00, v8
    s_mul_i32 s96, s68, 57344
    s_lshl_b32 s94, s70, 8
    s_add_u32 s96, s96, s94
    s_lshl_b32 s45, s68, 12
    v_mul_u32_u24 v24, 0x38000, v35
    v_add_u32 v24, s96, v24
    s_nop 0
    v_readlane_b32 s28, v24, 0
    v_readlane_b32 s29, v24, 1
    v_readlane_b32 s30, v24, 2
    v_readlane_b32 s31, v24, 3
    v_readlane_b32 s32, v24, 4
    v_readlane_b32 s33, v24, 5
    v_readlane_b32 s34, v24, 6
    v_readlane_b32 s35, v24, 7
    s_mov_b32 s44, s101
    s_and_b32 s78, s2, 7
    s_lshl_b32 s78, s78, 1
    s_and_b32 s94, s100, 1
    s_add_u32 s78, s78, s94
    s_bfe_u32 s72, s100, 0x10001
    s_lshr_b32 s73, s100, 2
    s_mov_b32 s95, s73
    s_lshr_b32 s74, s73, 2
    s_mul_i32 s74, s74, 7
    s_and_b32 s94, s2, 7
    s_add_u32 s74, s74, s94
    s_cmp_ge_u32 s74, 14
    s_cselect_b32 s94, 14, 0
    s_sub_u32 s74, s74, s94
    s_mov_b32 s66, 0xbfb8aa3b
    s_mov_b32 s67, 0xbfb8aa3b
    s_mul_i32 s46, s68, 20480
    s_add_u32 s46, s46, 81920
    v_lshlrev_b32 v62, 4, v0
    v_lshrrev_b32 v24, 3, v0
    v_and_b32 v25, 7, v0
    v_and_b32 v26, 6, v24
    v_xor_b32 v25, v25, v26
    v_lshlrev_b32 v25, 4, v25
    v_lshl_add_u32 v13, v24, 10, v25
    v_add_u32 v14, 0x1c00, v13
    v_lshrrev_b32 v24, 5, v0
    v_bfe_u32 v25, v0, 2, 3
    v_lshlrev_b32 v26, 7, v25
    v_lshl_add_u32 v26, v24, 11, v26
    v_lshrrev_b32 v25, 1, v25
    v_lshl_add_u32 v26, v25, 5, v26
    v_and_b32 v25, 3, v0
    v_lshl_add_u32 v26, v25, 3, v26
    v_add_u32 v56, s46, v26
    v_xor_b32 v57, 32, v56
    v_xor_b32 v15, 64, v56
    v_xor_b32 v35, 96, v56
    s_lshl_b32 s94, s69, 2
    s_add_u32 s94, s94, s68
    s_mul_i32 s94, s94, 112
    s_lshl_b32 s95, s70, 3
    s_add_u32 s94, s94, s95
    s_lshl_b32 s94, s94, 10
    s_add_u32 s52, s94, 0x20000
    s_lshl_b32 s94, s69, 8
    s_lshl_b32 s95, s70, 2
    s_add_u32 s94, s94, s95
    s_add_u32 s53, s94, 0x1000
    v_lshrrev_b32 v24, 5, v0
    v_bfe_u32 v25, v0, 2, 2
    v_lshl_add_u32 v24, v24, 3, v25
    v_lshlrev_b32 v24, 7, v24
    v_bfe_u32 v25, v0, 4, 1
    v_lshl_add_u32 v24, v25, 11, v24
    v_bfe_u32 v26, v0, 3, 2
    v_lshl_add_u32 v24, v26, 5, v24
    v_and_b32 v26, 3, v0
    v_lshl_add_u32 v9, v26, 3, v24
    v_xor_b32 v10, 32, v9
    v_xor_b32 v11, 64, v9
    v_xor_b32 v12, 96, v9
    v_bfe_u32 v24, v0, 2, 1
    v_lshrrev_b32 v25, 5, v0
    v_xor_b32 v24, v24, v25
    v_bfe_u32 v25, v0, 3, 1
    v_bfe_u32 v26, v0, 1, 1
    v_lshl_add_u32 v25, v25, 1, v26
    v_lshl_add_u32 v25, v24, 2, v25
    v_and_b32 v26, 1, v0
    v_lshlrev_b32 v26, 4, v26
    v_mov_b32 v27, 0x3f80
    v_lshlrev_b32 v26, v26, v27
    v_bfe_u32 v27, v0, 4, 1
    v_lshl_add_u32 v25, v27, 3, v25
    v_cmp_eq_u32 vcc, 0, v25
    s_nop 1
    v_cndmask_b32 v112, 0, v26, vcc
    v_cmp_eq_u32 vcc, 1, v25
    s_nop 1
    v_cndmask_b32 v113, 0, v26, vcc
    v_cmp_eq_u32 vcc, 2, v25
    s_nop 1
    v_cndmask_b32 v114, 0, v26, vcc
    v_cmp_eq_u32 vcc, 3, v25
    s_nop 1
    v_cndmask_b32 v115, 0, v26, vcc
    v_cmp_eq_u32 vcc, 8, v25
    s_nop 1
    v_cndmask_b32 v116, 0, v26, vcc
    v_cmp_eq_u32 vcc, 9, v25
    s_nop 1
    v_cndmask_b32 v117, 0, v26, vcc
    v_cmp_eq_u32 vcc, 10, v25
    s_nop 1
    v_cndmask_b32 v118, 0, v26, vcc
    v_cmp_eq_u32 vcc, 11, v25
    s_nop 1
    v_cndmask_b32 v119, 0, v26, vcc
    s_add_u32 m0, s101, 4096
    s_nop 0
    buffer_load_dwordx4 v1, s[4:7], s81 offen offset:0 lds
    buffer_load_dwordx4 v2, s[4:7], s81 offen offset:1024 lds
    buffer_load_dwordx4 v40, s[4:7], s81 offen offset:2048 lds
    buffer_load_dwordx4 v41, s[4:7], s81 offen offset:3072 lds
    s_add_u32 m0, s101, 8192
    s_nop 0
    buffer_load_dwordx4 v1, s[4:7], s82 offen offset:0 lds
    buffer_load_dwordx4 v2, s[4:7], s82 offen offset:1024 lds
    buffer_load_dwordx4 v40, s[4:7], s82 offen offset:2048 lds
    buffer_load_dwordx4 v41, s[4:7], s82 offen offset:3072 lds
    s_add_u32 m0, s101, 12288
    s_nop 0
    buffer_load_dwordx4 v1, s[4:7], s83 offen offset:0 lds
    buffer_load_dwordx4 v2, s[4:7], s83 offen offset:1024 lds
    buffer_load_dwordx4 v40, s[4:7], s83 offen offset:2048 lds
    buffer_load_dwordx4 v41, s[4:7], s83 offen offset:3072 lds
    s_waitcnt vmcnt(12)
    ds_read_b128 v[128:131], v3 offset:0
    ds_read_b128 v[132:135], v4 offset:0
    ds_read_b128 v[136:139], v5 offset:0
    ds_read_b128 v[140:143], v6 offset:0
    s_waitcnt vmcnt(8)
    ds_read_b128 v[144:147], v3 offset:4096
    ds_read_b128 v[148:151], v4 offset:4096
    ds_read_b128 v[152:155], v5 offset:4096
    ds_read_b128 v[156:159], v6 offset:4096
    s_waitcnt lgkmcnt(4)
    s_add_u32 m0, s101, 16384
    s_nop 0
    buffer_load_dwordx4 v1, s[4:7], s84 offen offset:0 lds
    v_dot2c_f32_bf16 v18, s77, v128
    v_dot2c_f32_bf16 v20, v128, v128
    v_dot2c_f32_bf16 v19, s77, v129
    v_dot2c_f32_bf16 v21, v129, v129
    v_dot2c_f32_bf16 v18, s77, v130
    v_dot2c_f32_bf16 v20, v130, v130
    v_dot2c_f32_bf16 v19, s77, v131
    v_dot2c_f32_bf16 v21, v131, v131
    buffer_load_dwordx4 v2, s[4:7], s84 offen offset:1024 lds
    v_dot2c_f32_bf16 v18, s77, v132
    v_dot2c_f32_bf16 v20, v132, v132
    v_dot2c_f32_bf16 v19, s77, v133
    v_dot2c_f32_bf16 v21, v133, v133
    v_dot2c_f32_bf16 v18, s77, v134
    v_dot2c_f32_bf16 v20, v134, v134
    v_dot2c_f32_bf16 v19, s77, v135
    v_dot2c_f32_bf16 v21, v135, v135
    buffer_load_dwordx4 v40, s[4:7], s84 offen offset:2048 lds
    v_dot2c_f32_bf16 v18, s77, v136
    v_dot2c_f32_bf16 v20, v136, v136
    v_dot2c_f32_bf16 v19, s77, v137
    v_dot2c_f32_bf16 v21, v137, v137
    v_dot2c_f32_bf16 v18, s77, v138
    v_dot2c_f32_bf16 v20, v138, v138
    v_dot2c_f32_bf16 v19, s77, v139
    v_dot2c_f32_bf16 v21, v139, v139
    buffer_load_dwordx4 v41, s[4:7], s84 offen offset:3072 lds
    v_dot2c_f32_bf16 v18, s77, v140
    v_dot2c_f32_bf16 v20, v140, v140
    v_dot2c_f32_bf16 v19, s77, v141
    v_dot2c_f32_bf16 v21, v141, v141
    v_dot2c_f32_bf16 v18, s77, v142
    v_dot2c_f32_bf16 v20, v142, v142
    v_dot2c_f32_bf16 v19, s77, v143
    v_dot2c_f32_bf16 v21, v143, v143
    s_or_b32 s94, s2, s68
    s_cmp_lg_u32 s94, 0
    s_cbranch_scc1 L_notag_1
    s_waitcnt vmcnt(16)
    v_add_u32 v63, 1, v63
    v_max_u32 v63, 1, v63
    buffer_store_dword v63, off, s[20:23], 0 sc1
    buffer_store_dword v63, off, s[36:39], 0 sc1
L_notag_1:
    s_waitcnt vmcnt(8)
    ds_read_b128 v[160:163], v3 offset:8192
    ds_read_b128 v[164:167], v4 offset:8192
    ds_read_b128 v[168:171], v5 offset:8192
    ds_read_b128 v[172:175], v6 offset:8192
    s_waitcnt lgkmcnt(4)
    s_add_u32 m0, s101, 20480
    s_nop 0
    buffer_load_dwordx4 v1, s[4:7], s85 offen offset:0 lds
    v_dot2c_f32_bf16 v18, s77, v144
    v_dot2c_f32_bf16 v20, v144, v144
    v_dot2c_f32_bf16 v19, s77, v145
    v_dot2c_f32_bf16 v21, v145, v145
    v_dot2c_f32_bf16 v18, s77, v146
    v_dot2c_f32_bf16 v20, v146, v146
    v_dot2c_f32_bf16 v19, s77, v147
    v_dot2c_f32_bf16 v21, v147, v147
    buffer_load_dwordx4 v2, s[4:7], s85 offen offset:1024 lds
    v_dot2c_f32_bf16 v18, s77, v148
    v_dot2c_f32_bf16 v20, v148, v148
    v_dot2c_f32_bf16 v19, s77, v149
    v_dot2c_f32_bf16 v21, v149, v149
    v_dot2c_f32_bf16 v18, s77, v150
    v_dot2c_f32_bf16 v20, v150, v150
    v_dot2c_f32_bf16 v19, s77, v151
    v_dot2c_f32_bf16 v21, v151, v151
    buffer_load_dwordx4 v40, s[4:7], s85 offen offset:2048 lds
    v_dot2c_f32_bf16 v18, s77, v152
    v_dot2c_f32_bf16 v20, v152, v152
    v_dot2c_f32_bf16 v19, s77, v153
    v_dot2c_f32_bf16 v21, v153, v153
    v_dot2c_f32_bf16 v18, s77, v154
    v_dot2c_f32_bf16 v20, v154, v154
    v_dot2c_f32_bf16 v19, s77, v155
    v_dot2c_f32_bf16 v21, v155, v155
    buffer_load_dwordx4 v41, s[4:7], s85 offen offset:3072 lds
    v_dot2c_f32_bf16 v18, s77, v156
    v_dot2c_f32_bf16 v20, v156, v156
    v_dot2c_f32_bf16 v19, s77, v157
    v_dot2c_f32_bf16 v21, v157, v157
    v_dot2c_f32_bf16 v18, s77, v158
    v_dot2c_f32_bf16 v20, v158, v158
    v_dot2c_f32_bf16 v19, s77, v159
    v_dot2c_f32_bf16 v21, v159, v159
    s_waitcnt vmcnt(8)
    ds_read_b128 v[176:179], v3 offset:12288
    ds_read_b128 v[180:183], v4 offset:12288
    ds_read_b128 v[184:187], v5 offset:12288
    ds_read_b128 v[188:191], v6 offset:12288
    s_waitcnt lgkmcnt(4)
    s_add_u32 m0, s101, 24576
    s_nop 0
    buffer_load_dwordx4 v1, s[4:7], s86 offen offset:0 lds
    v_dot2c_f32_bf16 v18, s77, v160
    v_dot2c_f32_bf16 v20, v160, v160
    v_dot2c_f32_bf16 v19, s77, v161
    v_dot2c_f32_bf16 v21, v161, v161
    v_dot2c_f32_bf16 v18, s77, v162
    v_dot2c_f32_bf16 v20, v162, v162
    v_dot2c_f32_bf16 v19, s77, v163
    v_dot2c_f32_bf16 v21, v163, v163
    buffer_load_dwordx4 v2, s[4:7], s86 offen offset:1024 lds
    v_dot2c_f32_bf16 v18, s77, v164
    v_dot2c_f32_bf16 v20, v164, v164
    v_dot2c_f32_bf16 v19, s77, v165
    v_dot2c_f32_bf16 v21, v165, v165
    v_dot2c_f32_bf16 v18, s77, v166
    v_dot2c_f32_bf16 v20, v166, v166
    v_dot2c_f32_bf16 v19, s77, v167
    v_dot2c_f32_bf16 v21, v167, v167
    buffer_load_dwordx4 v40, s[4:7], s86 offen offset:2048 lds
    v_dot2c_f32_bf16 v18, s77, v168
    v_dot2c_f32_bf16 v20, v168, v168
    v_dot2c_f32_bf16 v19, s77, v169
    v_dot2c_f32_bf16 v21, v169, v169
    v_dot2c_f32_bf16 v18, s77, v170
    v_dot2c_f32_bf16 v20, v170, v170
    v_dot2c_f32_bf16 v19, s77, v171
    v_dot2c_f32_bf16 v21, v171, v171
    buffer_load_dwordx4 v41, s[4:7], s86 offen offset:3072 lds
    v_dot2c_f32_bf16 v18, s77, v172
    v_dot2c_f32_bf16 v20, v172, v172
    v_dot2c_f32_bf16 v19, s77, v173
    v_dot2c_f32_bf16 v21, v173, v173
    v_dot2c_f32_bf16 v18, s77, v174
    v_dot2c_f32_bf16 v20, v174, v174
    v_dot2c_f32_bf16 v19, s77, v175
    v_dot2c_f32_bf16 v21, v175, v175
    s_waitcnt vmcnt(8)
    ds_read_b128 v[192:195], v3 offset:16384
    ds_read_b128 v[196:199], v4 offset:16384
    ds_read_b128 v[200:203], v5 offset:16384
    ds_read_b128 v[204:207], v6 offset:16384
    s_waitcnt lgkmcnt(4)
    s_add_u32 m0, s101, 28672
    s_nop 0
    buffer_load_dwordx4 v1, s[4:7], s87 offen offset:0 lds
    v_dot2c_f32_bf16 v18, s77, v176
    v_dot2c_f32_bf16 v20, v176, v176
    v_dot2c_f32_bf16 v19, s77, v177
    v_dot2c_f32_bf16 v21, v177, v177
    v_dot2c_f32_bf16 v18, s77, v178
    v_dot2c_f32_bf16 v20, v178, v178
    v_dot2c_f32_bf16 v19, s77, v179
    v_dot2c_f32_bf16 v21, v179, v179
    buffer_load_dwordx4 v2, s[4:7], s87 offen offset:1024 lds
    v_dot2c_f32_bf16 v18, s77, v180
    v_dot2c_f32_bf16 v20, v180, v180
    v_dot2c_f32_bf16 v19, s77, v181
    v_dot2c_f32_bf16 v21, v181, v181
    v_dot2c_f32_bf16 v18, s77, v182
    v_dot2c_f32_bf16 v20, v182, v182
    v_dot2c_f32_bf16 v19, s77, v183
    v_dot2c_f32_bf16 v21, v183, v183
    buffer_load_dwordx4 v40, s[4:7], s87 offen offset:2048 lds
    v_dot2c_f32_bf16 v18, s77, v184
    v_dot2c_f32_bf16 v20, v184, v184
    v_dot2c_f32_bf16 v19, s77, v185
    v_dot2c_f32_bf16 v21, v185, v185
    v_dot2c_f32_bf16 v18, s77, v186
    v_dot2c_f32_bf16 v20, v186, v186
    v_dot2c_f32_bf16 v19, s77, v187
    v_dot2c_f32_bf16 v21, v187, v187
    buffer_load_dwordx4 v41, s[4:7], s87 offen offset:3072 lds
    v_dot2c_f32_bf16 v18, s77, v188
    v_dot2c_f32_bf16 v20, v188, v188
    v_dot2c_f32_bf16 v19, s77, v189
    v_dot2c_f32_bf16 v21, v189, v189
    v_dot2c_f32_bf16 v18, s77, v190
    v_dot2c_f32_bf16 v20, v190, v190
    v_dot2c_f32_bf16 v19, s77, v191
    v_dot2c_f32_bf16 v21, v191, v191
    s_waitcnt vmcnt(8)
    ds_read_b128 v[208:211], v3 offset:20480
    ds_read_b128 v[212:215], v4 offset:20480
    ds_read_b128 v[216:219], v5 offset:20480
    ds_read_b128 v[220:223], v6 offset:20480
    s_waitcnt lgkmcnt(4)
    s_add_u32 m0, s45, 0
    s_nop 0
    buffer_load_dwordx4 v7, s[8:11], s28 offen offset:0 lds
    v_dot2c_f32_bf16 v18, s77, v192
    v_dot2c_f32_bf16 v20, v192, v192
    v_dot2c_f32_bf16 v19, s77, v193
    v_dot2c_f32_bf16 v21, v193, v193
    v_dot2c_f32_bf16 v18, s77, v194
    v_dot2c_f32_bf16 v20, v194, v194
    v_dot2c_f32_bf16 v19, s77, v195
    v_dot2c_f32_bf16 v21, v195, v195
    buffer_load_dwordx4 v36, s[8:11], s28 offen offset:1024 lds
    v_dot2c_f32_bf16 v18, s77, v196
    v_dot2c_f32_bf16 v20, v196, v196
    v_dot2c_f32_bf16 v19, s77, v197
    v_dot2c_f32_bf16 v21, v197, v197
    v_dot2c_f32_bf16 v18, s77, v198
    v_dot2c_f32_bf16 v20, v198, v198
    v_dot2c_f32_bf16 v19, s77, v199
    v_dot2c_f32_bf16 v21, v199, v199
    buffer_load_dwordx4 v8, s[12:15], s28 offen offset:2048 lds
    v_dot2c_f32_bf16 v18, s77, v200
    v_dot2c_f32_bf16 v20, v200, v200
    v_dot2c_f32_bf16 v19, s77, v201
    v_dot2c_f32_bf16 v21, v201, v201
    v_dot2c_f32_bf16 v18, s77, v202
    v_dot2c_f32_bf16 v20, v202, v202
    v_dot2c_f32_bf16 v19, s77, v203
    v_dot2c_f32_bf16 v21, v203, v203
    buffer_load_dwordx4 v37, s[12:15], s28 offen offset:3072 lds
    v_dot2c_f32_bf16 v18, s77, v204
    v_dot2c_f32_bf16 v20, v204, v204
    v_dot2c_f32_bf16 v19, s77, v205
    v_dot2c_f32_bf16 v21, v205, v205
    v_dot2c_f32_bf16 v18, s77, v206
    v_dot2c_f32_bf16 v20, v206, v206
    v_dot2c_f32_bf16 v19, s77, v207
    v_dot2c_f32_bf16 v21, v207, v207
    s_waitcnt vmcnt(8)
    ds_read_b128 v[224:227], v3 offset:24576
    ds_read_b128 v[228:231], v4 offset:24576
    ds_read_b128 v[232:235], v5 offset:24576
    ds_read_b128 v[236:239], v6 offset:24576
    s_waitcnt lgkmcnt(4)
    s_add_u32 m0, s45, 16384
    s_nop 0
    buffer_load_dwordx4 v7, s[8:11], s29 offen offset:0 lds
    v_dot2c_f32_bf16 v18, s77, v208
    v_dot2c_f32_bf16 v20, v208, v208
    v_dot2c_f32_bf16 v19, s77, v209
    v_dot2c_f32_bf16 v21, v209, v209
    v_dot2c_f32_bf16 v18, s77, v210
    v_dot2c_f32_bf16 v20, v210, v210
    v_dot2c_f32_bf16 v19, s77, v211
    v_dot2c_f32_bf16 v21, v211, v211
    buffer_load_dwordx4 v36, s[8:11], s29 offen offset:1024 lds
    v_dot2c_f32_bf16 v18, s77, v212
    v_dot2c_f32_bf16 v20, v212, v212
    v_dot2c_f32_bf16 v19, s77, v213
    v_dot2c_f32_bf16 v21, v213, v213
    v_dot2c_f32_bf16 v18, s77, v214
    v_dot2c_f32_bf16 v20, v214, v214
    v_dot2c_f32_bf16 v19, s77, v215
    v_dot2c_f32_bf16 v21, v215, v215
    buffer_load_dwordx4 v8, s[12:15], s29 offen offset:2048 lds
    v_dot2c_f32_bf16 v18, s77, v216
    v_dot2c_f32_bf16 v20, v216, v216
    v_dot2c_f32_bf16 v19, s77, v217
    v_dot2c_f32_bf16 v21, v217, v217
    v_dot2c_f32_bf16 v18, s77, v218
    v_dot2c_f32_bf16 v20, v218, v218
    v_dot2c_f32_bf16 v19, s77, v219
    v_dot2c_f32_bf16 v21, v219, v219
    buffer_load_dwordx4 v37, s[12:15], s29 offen offset:3072 lds
    v_dot2c_f32_bf16 v18, s77, v220
    v_dot2c_f32_bf16 v20, v220, v220
    v_dot2c_f32_bf16 v19, s77, v221
    v_dot2c_f32_bf16 v21, v221, v221
    v_dot2c_f32_bf16 v18, s77, v222
    v_dot2c_f32_bf16 v20, v222, v222
    v_dot2c_f32_bf16 v19, s77, v223
    v_dot2c_f32_bf16 v21, v223, v223
    s_waitcnt lgkmcnt(0)
    v_dot2c_f32_bf16 v18, s77, v224
    v_dot2c_f32_bf16 v20, v224, v224
    v_dot2c_f32_bf16 v19, s77, v225
    v_dot2c_f32_bf16 v21, v225, v225
    v_dot2c_f32_bf16 v18, s77, v226
    v_dot2c_f32_bf16 v20, v226, v226
    v_dot2c_f32_bf16 v19, s77, v227
    v_dot2c_f32_bf16 v21, v227, v227
    v_dot2c_f32_bf16 v18, s77, v228
    v_dot2c_f32_bf16 v20, v228, v228
    v_dot2c_f32_bf16 v19, s77, v229
    v_dot2c_f32_bf16 v21, v229, v229
    v_dot2c_f32_bf16 v18, s77, v230
    v_dot2c_f32_bf16 v20, v230, v230
    v_dot2c_f32_bf16 v19, s77, v231
    v_dot2c_f32_bf16 v21, v231, v231
    v_dot2c_f32_bf16 v18, s77, v232
    v_dot2c_f32_bf16 v20, v232, v232
    v_dot2c_f32_bf16 v19, s77, v233
    v_dot2c_f32_bf16 v21, v233, v233
    v_dot2c_f32_bf16 v18, s77, v234
    v_dot2c_f32_bf16 v20, v234, v234
    v_dot2c_f32_bf16 v19, s77, v235
    v_dot2c_f32_bf16 v21, v235, v235
    v_dot2c_f32_bf16 v18, s77, v236
    v_dot2c_f32_bf16 v20, v236, v236
    v_dot2c_f32_bf16 v19, s77, v237
    v_dot2c_f32_bf16 v21, v237, v237
    v_dot2c_f32_bf16 v18, s77, v238
    v_dot2c_f32_bf16 v20, v238, v238
    v_dot2c_f32_bf16 v19, s77, v239
    v_dot2c_f32_bf16 v21, v239, v239
    s_waitcnt vmcnt(8)
    ds_read_b128 v[240:243], v3 offset:28672
    ds_read_b128 v[244:247], v4 offset:28672
    ds_read_b128 v[248:251], v5 offset:28672
    ds_read_b128 v[252:255], v6 offset:28672
    s_waitcnt lgkmcnt(0)
    v_dot2c_f32_bf16 v18, s77, v240
    v_dot2c_f32_bf16 v20, v240, v240
    v_dot2c_f32_bf16 v19, s77, v241
    v_dot2c_f32_bf16 v21, v241, v241
    v_dot2c_f32_bf16 v18, s77, v242
    v_dot2c_f32_bf16 v20, v242, v242
    v_dot2c_f32_bf16 v19, s77, v243
    v_dot2c_f32_bf16 v21, v243, v243
    v_dot2c_f32_bf16 v18, s77, v244
    v_dot2c_f32_bf16 v20, v244, v244
    v_dot2c_f32_bf16 v19, s77, v245
    v_dot2c_f32_bf16 v21, v245, v245
    v_dot2c_f32_bf16 v18, s77, v246
    v_dot2c_f32_bf16 v20, v246, v246
    v_dot2c_f32_bf16 v19, s77, v247
    v_dot2c_f32_bf16 v21, v247, v247
    v_dot2c_f32_bf16 v18, s77, v248
    v_dot2c_f32_bf16 v20, v248, v248
    v_dot2c_f32_bf16 v19, s77, v249
    v_dot2c_f32_bf16 v21, v249, v249
    v_dot2c_f32_bf16 v18, s77, v250
    v_dot2c_f32_bf16 v20, v250, v250
    v_dot2c_f32_bf16 v19, s77, v251
    v_dot2c_f32_bf16 v21, v251, v251
    v_dot2c_f32_bf16 v18, s77, v252
    v_dot2c_f32_bf16 v20, v252, v252
    v_dot2c_f32_bf16 v19, s77, v253
    v_dot2c_f32_bf16 v21, v253, v253
    v_dot2c_f32_bf16 v18, s77, v254
    v_dot2c_f32_bf16 v20, v254, v254
    v_dot2c_f32_bf16 v19, s77, v255
    v_dot2c_f32_bf16 v21, v255, v255
    s_nop 2
    v_add_f32 v24, v18, v19
    v_add_f32 v26, v20, v21
    v_mov_b32 v25, v24
    v_mov_b32 v27, v26
    s_nop 1
    v_permlane32_swap_b32 v24, v25
    v_permlane32_swap_b32 v26, v27
    v_add_f32 v24, v24, v25
    v_add_f32 v26, v26, v27
    v_mul_f32 v24, 0x3b000000, v24
    v_mul_f32 v26, 0x3b000000, v26
    v_cvt_pk_bf16_f32 v25, v24, v24
    v_fma_f32 v26, -v24, v24, v26
    v_lshlrev_b32 v17, 16, v25
    v_mov_b32 v22, v26
    v_xor_b32 v64, 0x80000000, v17
    v_mov_b32 v65, v64
    v_mov_b32 v66, v64
    v_mov_b32 v67, v64
    v_mov_b32 v68, v64
    v_mov_b32 v69, v64
    v_mov_b32 v70, v64
    v_mov_b32 v71, v64
    v_mov_b32 v72, v64
    v_mov_b32 v73, v64
    v_mov_b32 v74, v64
    v_mov_b32 v75, v64
    v_mov_b32 v76, v64
    v_mov_b32 v77, v64
    v_mov_b32 v78, v64
    v_mov_b32 v79, v64
    s_barrier
    s_add_u32 m0, s45, 32768
    v_mfma_f32_32x32x16_bf16 v[80:95], v[112:115], v[128:131], v[64:79]
    buffer_load_dwordx4 v7, s[8:11], s30 offen offset:0 lds
    v_mfma_f32_32x32x16_bf16 v[80:95], v[116:119], v[132:135], v[80:95]
    v_mfma_f32_32x32x16_bf16 v[96:111], v[112:115], v[136:139], v[64:79]
    v_mfma_f32_32x32x16_bf16 v[96:111], v[116:119], v[140:143], v[96:111]
    s_and_b32 s94, s68, 1
    s_lshl_b32 s95, s94, 2
    s_sub_u32 s94, s95, s94
    s_add_u32 s96, s94, 8
    s_add_u32 s97, s95, 6
    buffer_load_dwordx4 v36, s[8:11], s30 offen offset:1024 lds
    s_cmp_lt_u32 s68, 2
    s_cselect_b32 s95, s95, s96
    s_cselect_b32 s94, s94, s97
    s_cselect_b32 s96, 0xfea9500, 0
    s_cselect_b32 s97, 0x93924e4, 0
    s_cselect_b32 s54, 0, 0xffa9540
    s_cselect_b32 s55, 0, 0xe493924
    s_or_b32 s96, s96, s54
    s_or_b32 s97, s97, s55
    buffer_load_dwordx4 v8, s[12:15], s30 offen offset:2048 lds
    s_sub_i32 s94, s94, s95
    s_add_u32 s95, s95, s74
    v_lshlrev_b32 v24, 1, v0
    v_bfe_u32 v25, s96, v24, 2
    v_bfe_u32 v26, s97, v24, 2
    v_and_b32 v27, 1, v25
    v_add_u32 v26, s95, v26
    v_mad_i32_i24 v26, v27, s94, v26
    s_add_u32 s94, s73, s100
    buffer_load_dwordx4 v37, s[12:15], s30 offen offset:3072 lds
    s_lshl_b32 s95, s73, 7
    v_subrev_u32 v27, 14, v26
    v_min_u32 v26, v26, v27
    v_add_u32 v25, s94, v25
    v_and_b32 v25, 3, v25
    v_lshlrev_b32 v26, 17, v26
    v_lshl_add_u32 v26, v25, 14, v26
    v_add_u32 v26, s95, v26
    s_add_u32 m0, s45, 49152
    s_nop 0
    buffer_load_dwordx4 v7, s[8:11], s31 offen offset:0 lds
    v_readlane_b32 s80, v26, 0
    v_readlane_b32 s81, v26, 1
    v_readlane_b32 s82, v26, 2
    v_readlane_b32 s83, v26, 3
    v_readlane_b32 s84, v26, 4
    v_readlane_b32 s85, v26, 5
    v_readlane_b32 s86, v26, 6
    v_readlane_b32 s87, v26, 7
    v_readlane_b32 s88, v26, 8
    buffer_load_dwordx4 v36, s[8:11], s31 offen offset:1024 lds
    v_readlane_b32 s89, v26, 9
    v_readlane_b32 s90, v26, 10
    v_readlane_b32 s91, v26, 11
    v_readlane_b32 s92, v26, 12
    v_readlane_b32 s93, v26, 13
    v_cvt_pk_bf16_f32 v128, v80, v81
    v_cvt_pk_bf16_f32 v129, v82, v83
    v_cvt_pk_bf16_f32 v130, v84, v85
    v_cvt_pk_bf16_f32 v131, v86, v87
    buffer_load_dwordx4 v8, s[12:15], s31 offen offset:2048 lds
    v_cvt_pk_bf16_f32 v132, v88, v89
    v_cvt_pk_bf16_f32 v133, v90, v91
    v_cvt_pk_bf16_f32 v134, v92, v93
    v_cvt_pk_bf16_f32 v135, v94, v95
    v_cvt_pk_bf16_f32 v136, v96, v97
    v_cvt_pk_bf16_f32 v137, v98, v99
    v_cvt_pk_bf16_f32 v138, v100, v101
    v_cvt_pk_bf16_f32 v139, v102, v103
    v_cvt_pk_bf16_f32 v140, v104, v105
    buffer_load_dwordx4 v37, s[12:15], s31 offen offset:3072 lds
    v_cvt_pk_bf16_f32 v141, v106, v107
    v_cvt_pk_bf16_f32 v142, v108, v109
    v_cvt_pk_bf16_f32 v143, v110, v111
    v_mov_b32 v26, v22
    v_add_u32 v3, 0x10000, v9
    v_add_u32 v4, 0x10000, v10
    v_add_u32 v5, 0x10000, v11
    v_add_u32 v6, 0x10000, v12
    s_waitcnt vmcnt(12)
    s_barrier
    ds_read_b64_tr_b16 a[64:65], v9 offset:0
    ds_read_b64_tr_b16 a[66:67], v9 offset:512
    ds_read_b64_tr_b16 a[68:69], v10 offset:0
    ds_read_b64_tr_b16 a[70:71], v10 offset:512
    ds_read_b64_tr_b16 a[72:73], v11 offset:0
    ds_read_b64_tr_b16 a[74:75], v11 offset:512
    ds_read_b64_tr_b16 a[76:77], v12 offset:0
    ds_read_b64_tr_b16 a[78:79], v12 offset:512
    ds_read_b64_tr_b16 a[80:81], v9 offset:4096
    ds_read_b64_tr_b16 a[82:83], v9 offset:4608
    ds_read_b64_tr_b16 a[84:85], v10 offset:4096
    ds_read_b64_tr_b16 a[86:87], v10 offset:4608
    ds_read_b64_tr_b16 a[88:89], v11 offset:4096
    ds_read_b64_tr_b16 a[90:91], v11 offset:4608
    s_waitcnt lgkmcnt(6)
    v_mfma_f32_32x32x16_bf16 a[0:15], a[64:67], v[128:131], 0
    ds_read_b64_tr_b16 a[92:93], v12 offset:4096
    ds_read_b64_tr_b16 a[94:95], v12 offset:4608
    v_max_f32 v26, 0, v26
    v_cvt_pk_bf16_f32 v26, v26, v26
    v_lshlrev_b32 v26, 16, v26
    v_add_f32 v26, 0x3727c5ac, v26
    v_mfma_f32_32x32x16_bf16 a[16:31], a[68:71], v[128:131], 0
    v_cvt_pk_bf16_f32 v26, v26, v26
    v_lshlrev_b32 v26, 16, v26
    v_sqrt_f32 v26, v26
    s_nop 0
    v_cvt_pk_bf16_f32 v26, v26, v26
    v_mfma_f32_32x32x16_bf16 v[80:95], v[112:115], v[144:147], v[64:79]
    v_lshlrev_b32 v26, 16, v26
    v_rcp_f32 v18, v26
    s_nop 0
    v_mul_f32 v20, 0xbfb8aa3b, v18
    v_mov_b32 v19, v18
    v_mfma_f32_32x32x16_bf16 v[80:95], v[116:119], v[148:151], v[80:95]
    s_add_u32 m0, s45, 65536
    ds_read_b64_tr_b16 a[64:65], v9 offset:8192
    ds_read_b64_tr_b16 a[66:67], v9 offset:8704
    buffer_load_dwordx4 v7, s[8:11], s32 offen offset:0 lds
    v_mfma_f32_32x32x16_bf16 a[32:47], a[72:75], v[128:131], 0
    ds_read_b64_tr_b16 a[68:69], v10 offset:8192
    ds_read_b64_tr_b16 a[70:71], v10 offset:8704
    v_mov_b32 v21, v20
    v_mfma_f32_32x32x16_bf16 a[48:63], a[76:79], v[128:131], 0
    ds_read_b64_tr_b16 a[72:73], v11 offset:8192
    ds_read_b64_tr_b16 a[74:75], v11 offset:8704
    buffer_load_dwordx4 v36, s[8:11], s32 offen offset:1024 lds
    s_waitcnt lgkmcnt(6)
    v_mfma_f32_32x32x16_bf16 a[0:15], a[80:83], v[132:135], a[0:15]
    ds_read_b64_tr_b16 a[76:77], v12 offset:8192
    ds_read_b64_tr_b16 a[78:79], v12 offset:8704
    v_cvt_pk_bf16_f32 v144, v80, v81
    v_cvt_pk_bf16_f32 v145, v82, v83
    v_cvt_pk_bf16_f32 v146, v84, v85
    v_cvt_pk_bf16_f32 v147, v86, v87
    v_mfma_f32_32x32x16_bf16 a[16:31], a[84:87], v[132:135], a[16:31]
    ds_read_b64_tr_b16 a[80:81], v9 offset:12288
    ds_read_b64_tr_b16 a[82:83], v9 offset:12800
    buffer_load_dwordx4 v8, s[12:15], s32 offen offset:2048 lds
    v_cvt_pk_bf16_f32 v148, v88, v89
    v_mfma_f32_32x32x16_bf16 a[32:47], a[88:91], v[132:135], a[32:47]
    ds_read_b64_tr_b16 a[84:85], v10 offset:12288
    ds_read_b64_tr_b16 a[86:87], v10 offset:12800
    v_cvt_pk_bf16_f32 v149, v90, v91
    v_cvt_pk_bf16_f32 v150, v92, v93
    v_cvt_pk_bf16_f32 v151, v94, v95
    v_mfma_f32_32x32x16_bf16 a[48:63], a[92:95], v[132:135], a[48:63]
    ds_read_b64_tr_b16 a[88:89], v11 offset:12288
    ds_read_b64_tr_b16 a[90:91], v11 offset:12800
    buffer_load_dwordx4 v37, s[12:15], s32 offen offset:3072 lds
    s_waitcnt lgkmcnt(6)
    v_mfma_f32_32x32x16_bf16 a[0:15], a[64:67], v[136:139], a[0:15]
    ds_read_b64_tr_b16 a[92:93], v12 offset:12288
    ds_read_b64_tr_b16 a[94:95], v12 offset:12800
    v_mfma_f32_32x32x16_bf16 a[16:31], a[68:71], v[136:139], a[16:31]
    v_mfma_f32_32x32x16_bf16 v[96:111], v[112:115], v[152:155], v[64:79]
    v_mfma_f32_32x32x16_bf16 v[96:111], v[116:119], v[156:159], v[96:111]
    s_waitcnt vmcnt(12)
    s_barrier
    ds_read_b64_tr_b16 a[64:65], v9 offset:16384
    ds_read_b64_tr_b16 a[66:67], v9 offset:16896
    v_mfma_f32_32x32x16_bf16 a[32:47], a[72:75], v[136:139], a[32:47]
    ds_read_b64_tr_b16 a[68:69], v10 offset:16384
    ds_read_b64_tr_b16 a[70:71], v10 offset:16896
    v_mfma_f32_32x32x16_bf16 a[48:63], a[76:79], v[136:139], a[48:63]
    s_add_u32 m0, s46, 0
    ds_read_b64_tr_b16 a[72:73], v11 offset:16384
    ds_read_b64_tr_b16 a[74:75], v11 offset:16896
    buffer_load_dwordx4 v13, s[16:19], s80 offen offset:0 lds
    s_waitcnt lgkmcnt(6)
    v_mfma_f32_32x32x16_bf16 a[0:15], a[80:83], v[140:143], a[0:15]
    ds_read_b64_tr_b16 a[76:77], v12 offset:16384
    ds_read_b64_tr_b16 a[78:79], v12 offset:16896
    v_cvt_pk_bf16_f32 v152, v96, v97
    v_cvt_pk_bf16_f32 v153, v98, v99
    v_cvt_pk_bf16_f32 v154, v100, v101
    v_cvt_pk_bf16_f32 v155, v102, v103
    v_mfma_f32_32x32x16_bf16 a[16:31], a[84:87], v[140:143], a[16:31]
    ds_read_b64_tr_b16 a[80:81], v9 offset:20480
    ds_read_b64_tr_b16 a[82:83], v9 offset:20992
    buffer_load_dwordx4 v14, s[16:19], s80 offen offset:1024 lds
    v_cvt_pk_bf16_f32 v156, v104, v105
    v_mfma_f32_32x32x16_bf16 a[32:47], a[88:91], v[140:143], a[32:47]
    ds_read_b64_tr_b16 a[84:85], v10 offset:20480
    ds_read_b64_tr_b16 a[86:87], v10 offset:20992
    v_cvt_pk_bf16_f32 v157, v106, v107
    v_cvt_pk_bf16_f32 v158, v108, v109
    v_cvt_pk_bf16_f32 v159, v110, v111
    s_lshl_b32 s61, s78, 8
    v_mfma_f32_32x32x16_bf16 a[48:63], a[92:95], v[140:143], a[48:63]
    s_add_u32 m0, s46, 2048
    ds_read_b64_tr_b16 a[88:89], v11 offset:20480
    ds_read_b64_tr_b16 a[90:91], v11 offset:20992
    buffer_load_dwordx4 v13, s[16:19], s81 offen offset:0 lds
    s_waitcnt lgkmcnt(6)
    v_mfma_f32_32x32x16_bf16 a[0:15], a[64:67], v[144:147], a[0:15]
    ds_read_b64_tr_b16 a[92:93], v12 offset:20480
    ds_read_b64_tr_b16 a[94:95], v12 offset:20992
    s_add_u32 s61, s61, 0x1000
    s_lshl_b32 s94, s78, 1
    s_add_u32 s94, s94, s72
    s_mul_i32 s94, s94, 229376
    v_mfma_f32_32x32x16_bf16 a[16:31], a[68:71], v[144:147], a[16:31]
    s_lshl_b32 s96, s73, 3
    s_sub_u32 s94, s94, s96
    s_add_u32 s59, s94, 0x20000
    s_lshl_b32 s47, s68, 12
    s_mov_b32 s64, 1.0
    s_mov_b32 s65, 1.0
    v_mfma_f32_32x32x16_bf16 v[80:95], v[112:115], v[160:163], v[64:79]
    v_add_u32 v16, 113664, v62
    v_and_b32 v58, 0xf0, v62
    v_bfe_u32 v59, v0, 4, 1
    v_lshl_add_u32 v58, v59, 9, v58
    v_lshrrev_b32 v59, 5, v0
    v_lshl_add_u32 v58, v59, 11, v58
    v_mfma_f32_32x32x16_bf16 v[80:95], v[116:119], v[164:167], v[80:95]
    ds_read_b64_tr_b16 a[64:65], v9 offset:24576
    ds_read_b64_tr_b16 a[66:67], v9 offset:25088
    buffer_load_dwordx4 v14, s[16:19], s81 offen offset:1024 lds
    s_add_u32 s94, s47, 0x4000
    v_mfma_f32_32x32x16_bf16 a[32:47], a[72:75], v[144:147], a[32:47]
    ds_read_b64_tr_b16 a[68:69], v10 offset:24576
    ds_read_b64_tr_b16 a[70:71], v10 offset:25088
    v_add_u32 v58, s94, v58
    v_min_u32 v59, 13, v0
    v_lshlrev_b32 v59, 2, v59
    s_lshl_b32 s94, s78, 8
    v_mfma_f32_32x32x16_bf16 a[48:63], a[76:79], v[144:147], a[48:63]
    ds_read_b64_tr_b16 a[72:73], v11 offset:24576
    ds_read_b64_tr_b16 a[74:75], v11 offset:25088
    s_lshl_b32 s95, s72, 7
    s_add_u32 s94, s94, s95
    s_add_u32 s95, s94, 0x3000
    s_waitcnt lgkmcnt(6)
    v_mfma_f32_32x32x16_bf16 a[0:15], a[80:83], v[148:151], a[0:15]
    ds_read_b64_tr_b16 a[76:77], v12 offset:24576
    ds_read_b64_tr_b16 a[78:79], v12 offset:25088
    v_cvt_pk_bf16_f32 v160, v80, v81
    v_cvt_pk_bf16_f32 v161, v82, v83
    v_cvt_pk_bf16_f32 v162, v84, v85
    v_cvt_pk_bf16_f32 v163, v86, v87
    v_mfma_f32_32x32x16_bf16 a[16:31], a[84:87], v[148:151], a[16:31]
    ds_read_b64_tr_b16 a[80:81], v9 offset:28672
    ds_read_b64_tr_b16 a[82:83], v9 offset:29184
    v_cvt_pk_bf16_f32 v164, v88, v89
    v_cvt_pk_bf16_f32 v165, v90, v91
    v_cvt_pk_bf16_f32 v166, v92, v93
    v_cvt_pk_bf16_f32 v167, v94, v95
    v_mfma_f32_32x32x16_bf16 a[32:47], a[88:91], v[148:151], a[32:47]
    ds_read_b64_tr_b16 a[84:85], v10 offset:28672
    ds_read_b64_tr_b16 a[86:87], v10 offset:29184
    s_add_u32 s94, s94, 0x4000
    v_and_b32 v24, 31, v0
    v_lshlrev_b32 v22, 2, v24
    v_add_u32 v22, s95, v22
    v_mfma_f32_32x32x16_bf16 a[48:63], a[92:95], v[148:151], a[48:63]
    ds_read_b64_tr_b16 a[88:89], v11 offset:28672
    ds_read_b64_tr_b16 a[90:91], v11 offset:29184
    v_min_u32 v24, 27, v0
    v_lshlrev_b32 v24, 2, v24
    v_add_u32 v23, s94, v24
    s_waitcnt lgkmcnt(6)
    v_mfma_f32_32x32x16_bf16 a[0:15], a[64:67], v[152:155], a[0:15]
    ds_read_b64_tr_b16 a[92:93], v12 offset:28672
    ds_read_b64_tr_b16 a[94:95], v12 offset:29184
    s_lshl_b32 s96, s72, 2
    s_add_u32 s96, s96, s68
    s_lshl_b32 s96, s96, 4
    s_add_u32 s96, s96, s78
    v_mfma_f32_32x32x16_bf16 a[16:31], a[68:71], v[152:155], a[16:31]
    s_lshl_b32 s48, s96, 10
    s_lshl_b32 s97, s73, 7
    s_add_u32 s48, s48, s97
    v_lshrrev_b32 v26, 3, v0
    v_and_b32 v27, 7, v0
    v_lshlrev_b32 v28, 4, v27
    v_mfma_f32_32x32x16_bf16 v[96:111], v[112:115], v[168:171], v[64:79]
    v_lshl_add_u32 v60, v26, 17, v28
    v_lshl_add_u32 v54, v26, 16, v28
    v_and_b32 v28, 15, v0
    v_lshlrev_b32 v55, 17, v28
    v_and_b32 v28, 1, v27
    v_lshlrev_b32 v28, 9, v28
    v_mfma_f32_32x32x16_bf16 v[96:111], v[116:119], v[172:175], v[96:111]
    s_waitcnt vmcnt(12)
    s_barrier
    ds_read_b64_tr_b16 a[64:65], v9 offset:32768
    ds_read_b64_tr_b16 a[66:67], v9 offset:33280
    v_lshrrev_b32 v30, 1, v27
    v_lshl_add_u32 v28, v30, 10, v28
    v_mfma_f32_32x32x16_bf16 a[32:47], a[72:75], v[152:155], a[32:47]
    ds_read_b64_tr_b16 a[68:69], v10 offset:32768
    ds_read_b64_tr_b16 a[70:71], v10 offset:33280
    v_and_b32 v29, 3, v27
    v_lshl_add_u32 v29, v29, 2, v26
    s_lshl_b32 s95, s68, 14
    s_add_u32 s95, s95, 0x4000
    v_mfma_f32_32x32x16_bf16 a[48:63], a[76:79], v[152:155], a[48:63]
    s_add_u32 m0, s45, 0
    ds_read_b64_tr_b16 a[72:73], v11 offset:32768
    ds_read_b64_tr_b16 a[74:75], v11 offset:33280
    buffer_load_dwordx4 v7, s[8:11], s33 offen offset:0 lds
    s_waitcnt lgkmcnt(6)
    v_mfma_f32_32x32x16_bf16 a[0:15], a[80:83], v[156:159], a[0:15]
    ds_read_b64_tr_b16 a[76:77], v12 offset:32768
    ds_read_b64_tr_b16 a[78:79], v12 offset:33280
    v_cvt_pk_bf16_f32 v168, v96, v97
    v_cvt_pk_bf16_f32 v169, v98, v99
    v_cvt_pk_bf16_f32 v170, v100, v101
    v_cvt_pk_bf16_f32 v171, v102, v103
    v_mfma_f32_32x32x16_bf16 a[16:31], a[84:87], v[156:159], a[16:31]
    ds_read_b64_tr_b16 a[80:81], v9 offset:36864
    ds_read_b64_tr_b16 a[82:83], v9 offset:37376
    buffer_load_dwordx4 v36, s[8:11], s33 offen offset:1024 lds
    v_cvt_pk_bf16_f32 v172, v104, v105
    v_mfma_f32_32x32x16_bf16 a[32:47], a[88:91], v[156:159], a[32:47]
    ds_read_b64_tr_b16 a[84:85], v10 offset:36864
    ds_read_b64_tr_b16 a[86:87], v10 offset:37376
    v_cvt_pk_bf16_f32 v173, v106, v107
    v_cvt_pk_bf16_f32 v174, v108, v109
    v_cvt_pk_bf16_f32 v175, v110, v111
    s_mov_b32 s97, s47
    v_mfma_f32_32x32x16_bf16 a[48:63], a[92:95], v[156:159], a[48:63]
    ds_read_b64_tr_b16 a[88:89], v11 offset:36864
    ds_read_b64_tr_b16 a[90:91], v11 offset:37376
    buffer_load_dwordx4 v8, s[12:15], s33 offen offset:2048 lds
    s_waitcnt lgkmcnt(6)
    v_mfma_f32_32x32x16_bf16 a[0:15], a[64:67], v[160:163], a[0:15]
    ds_read_b64_tr_b16 a[92:93], v12 offset:36864
    ds_read_b64_tr_b16 a[94:95], v12 offset:37376
    v_add_u32 v31, 0, v29
    v_and_b32 v31, 15, v31
    v_lshl_add_u32 v31, v31, 4, v28
    v_add_u32 v48, s95, v31
    v_mfma_f32_32x32x16_bf16 a[16:31], a[68:71], v[160:163], a[16:31]
    v_add_u32 v31, 8, v29
    v_and_b32 v31, 15, v31
    v_lshl_add_u32 v31, v31, 4, v28
    v_add_u32 v49, s95, v31
    v_and_b32 v28, 1, v27
    v_lshlrev_b32 v28, 11, v28
    v_mfma_f32_32x32x16_bf16 v[80:95], v[112:115], v[176:179], v[64:79]
    v_bfe_u32 v31, v27, 1, 1
    v_lshl_add_u32 v28, v31, 9, v28
    v_lshrrev_b32 v30, 2, v27
    v_lshl_add_u32 v29, v30, 4, v29
    v_add_u32 v31, 0, v29
    v_and_b32 v31, 31, v31
    v_mfma_f32_32x32x16_bf16 v[80:95], v[116:119], v[180:183], v[80:95]
    ds_read_b64_tr_b16 a[64:65], v9 offset:40960
    ds_read_b64_tr_b16 a[66:67], v9 offset:41472
    buffer_load_dwordx4 v37, s[12:15], s33 offen offset:3072 lds
    v_lshl_add_u32 v31, v31, 4, v28
    v_mfma_f32_32x32x16_bf16 a[32:47], a[72:75], v[160:163], a[32:47]
    ds_read_b64_tr_b16 a[68:69], v10 offset:40960
    ds_read_b64_tr_b16 a[70:71], v10 offset:41472
    v_add_u32 v50, s97, v31
    v_add_u32 v31, 8, v29
    v_and_b32 v31, 31, v31
    v_lshl_add_u32 v31, v31, 4, v28
    v_mfma_f32_32x32x16_bf16 a[48:63], a[76:79], v[160:163], a[48:63]
    s_add_u32 m0, s46, 4096
    ds_read_b64_tr_b16 a[72:73], v11 offset:40960
    ds_read_b64_tr_b16 a[74:75], v11 offset:41472
    buffer_load_dwordx4 v13, s[16:19], s82 offen offset:0 lds
    s_waitcnt lgkmcnt(6)
    v_mfma_f32_32x32x16_bf16 a[0:15], a[80:83], v[164:167], a[0:15]
    ds_read_b64_tr_b16 a[76:77], v12 offset:40960
    ds_read_b64_tr_b16 a[78:79], v12 offset:41472
    v_cvt_pk_bf16_f32 v176, v80, v81
    v_cvt_pk_bf16_f32 v177, v82, v83
    v_cvt_pk_bf16_f32 v178, v84, v85
    v_cvt_pk_bf16_f32 v179, v86, v87
    v_mfma_f32_32x32x16_bf16 a[16:31], a[84:87], v[164:167], a[16:31]
    ds_read_b64_tr_b16 a[80:81], v9 offset:45056
    ds_read_b64_tr_b16 a[82:83], v9 offset:45568
    buffer_load_dwordx4 v14, s[16:19], s82 offen offset:1024 lds
    v_cvt_pk_bf16_f32 v180, v88, v89
    v_mfma_f32_32x32x16_bf16 a[32:47], a[88:91], v[164:167], a[32:47]
    ds_read_b64_tr_b16 a[84:85], v10 offset:45056
    ds_read_b64_tr_b16 a[86:87], v10 offset:45568
    v_cvt_pk_bf16_f32 v181, v90, v91
    v_cvt_pk_bf16_f32 v182, v92, v93
    v_cvt_pk_bf16_f32 v183, v94, v95
    v_add_u32 v51, s97, v31
    v_mfma_f32_32x32x16_bf16 a[48:63], a[92:95], v[164:167], a[48:63]
    s_add_u32 m0, s46, 6144
    ds_read_b64_tr_b16 a[88:89], v11 offset:45056
    ds_read_b64_tr_b16 a[90:91], v11 offset:45568
    buffer_load_dwordx4 v13, s[16:19], s83 offen offset:0 lds
    s_waitcnt lgkmcnt(6)
    v_mfma_f32_32x32x16_bf16 a[0:15], a[64:67], v[168:171], a[0:15]
    ds_read_b64_tr_b16 a[92:93], v12 offset:45056
    ds_read_b64_tr_b16 a[94:95], v12 offset:45568
    v_lshrrev_b32 v24, 5, v0
    v_lshl_add_u32 v28, v24, 3, v0
    v_add_u32 v29, 0, v28
    v_and_b32 v29, 31, v29
    v_mfma_f32_32x32x16_bf16 a[16:31], a[68:71], v[168:171], a[16:31]
    v_lshlrev_b32 v29, 4, v29
    v_lshl_add_u32 v29, v24, 9, v29
    v_add_u32 v52, s47, v29
    v_add_u32 v29, 4, v28
    v_and_b32 v29, 31, v29
    v_lshlrev_b32 v29, 4, v29
    v_mfma_f32_32x32x16_bf16 v[96:111], v[112:115], v[184:187], v[64:79]
    v_lshl_add_u32 v29, v24, 9, v29
    v_add_u32 v53, s47, v29
    s_sub_u32 s94, 7, s73
    s_sub_u32 s95, 0x80, s96
    s_and_b32 s95, s95, 0x7f
    v_mfma_f32_32x32x16_bf16 v[96:111], v[116:119], v[188:191], v[96:111]
    s_waitcnt vmcnt(15)
    s_barrier
    ds_read_b64_tr_b16 a[64:65], v9 offset:49152
    ds_read_b64_tr_b16 a[66:67], v9 offset:49664
    v_mfma_f32_32x32x16_bf16 a[32:47], a[72:75], v[168:171], a[32:47]
    ds_read_b64_tr_b16 a[68:69], v10 offset:49152
    ds_read_b64_tr_b16 a[70:71], v10 offset:49664
    s_cmp_ge_u32 s73, 4
    s_cselect_b32 s94, s94, s73
    s_cselect_b32 s95, s95, s96
    s_cselect_b64 vcc, -1, 0
    v_mfma_f32_32x32x16_bf16 a[48:63], a[76:79], v[168:171], a[48:63]
    s_add_u32 m0, s45, 16384
    ds_read_b64_tr_b16 a[72:73], v11 offset:49152
    ds_read_b64_tr_b16 a[74:75], v11 offset:49664
    buffer_load_dwordx4 v7, s[8:11], s34 offen offset:0 lds
    s_waitcnt lgkmcnt(6)
    v_mfma_f32_32x32x16_bf16 a[0:15], a[80:83], v[172:175], a[0:15]
    ds_read_b64_tr_b16 a[76:77], v12 offset:49152
    ds_read_b64_tr_b16 a[78:79], v12 offset:49664
    s_waitcnt vmcnt(8)
    ds_read_b64_tr_b16 a[128:129], v56 offset:0
    v_cvt_pk_bf16_f32 v184, v96, v97
    v_cvt_pk_bf16_f32 v185, v98, v99
    v_mfma_f32_32x32x16_bf16 a[16:31], a[84:87], v[172:175], a[16:31]
    ds_read_b64_tr_b16 a[80:81], v9 offset:53248
    ds_read_b64_tr_b16 a[82:83], v9 offset:53760
    buffer_load_dwordx4 v36, s[8:11], s34 offen offset:1024 lds
    v_cvt_pk_bf16_f32 v186, v100, v101
    v_mfma_f32_32x32x16_bf16 a[32:47], a[88:91], v[172:175], a[32:47]
    ds_read_b64_tr_b16 a[84:85], v10 offset:53248
    ds_read_b64_tr_b16 a[86:87], v10 offset:53760
    v_cvt_pk_bf16_f32 v187, v102, v103
    v_cvt_pk_bf16_f32 v188, v104, v105
    v_cvt_pk_bf16_f32 v189, v106, v107
    v_cvt_pk_bf16_f32 v190, v108, v109
    v_mfma_f32_32x32x16_bf16 a[48:63], a[92:95], v[172:175], a[48:63]
    ds_read_b64_tr_b16 a[88:89], v11 offset:53248
    ds_read_b64_tr_b16 a[90:91], v11 offset:53760
    buffer_load_dwordx4 v8, s[12:15], s34 offen offset:2048 lds
    s_waitcnt lgkmcnt(7)
    v_mfma_f32_32x32x16_bf16 a[0:15], a[64:67], v[176:179], a[0:15]
    ds_read_b64_tr_b16 a[92:93], v12 offset:53248
    ds_read_b64_tr_b16 a[94:95], v12 offset:53760
    ds_read_b64_tr_b16 a[130:131], v56 offset:1024
    v_cvt_pk_bf16_f32 v191, v110, v111
    s_lshl_b32 s95, s95, 9
    s_add_u32 s95, s95, 0x800000
    v_mfma_f32_32x32x16_bf16 a[16:31], a[68:71], v[176:179], a[16:31]
    s_lshl_b32 s94, s94, 7
    s_add_u32 s49, s95, s94
    s_add_u32 s94, s94, 0x80
    s_and_b32 s94, s94, 0x1ff
    s_add_u32 s50, s95, s94
    s_lshr_b32 s94, s96, 6
    v_mfma_f32_32x32x16_bf16 v[80:95], v[112:115], v[192:195], v[64:79]
    s_lshl_b32 s94, s94, 8
    s_and_b32 s95, s96, 1
    s_lshl_b32 s95, s95, 7
    s_add_u32 s94, s94, s95
    s_and_b32 s95, s96, 62
    s_lshl_b32 s95, s95, 1
    v_mfma_f32_32x32x16_bf16 v[80:95], v[116:119], v[196:199], v[80:95]
    ds_read_b64_tr_b16 a[64:65], v9 offset:57344
    ds_read_b64_tr_b16 a[66:67], v9 offset:57856
    buffer_load_dwordx4 v37, s[12:15], s34 offen offset:3072 lds
    s_add_u32 s94, s94, s95
    v_mfma_f32_32x32x16_bf16 a[32:47], a[72:75], v[176:179], a[32:47]
    ds_read_b64_tr_b16 a[68:69], v10 offset:57344
    ds_read_b64_tr_b16 a[70:71], v10 offset:57856
    s_and_b32 s95, s94, 12
    s_sub_u32 s94, s94, s95
    s_add_u32 s94, s94, 0xc00000
    v_mfma_f32_32x32x16_bf16 a[48:63], a[76:79], v[176:179], a[48:63]
    s_add_u32 m0, s46, 6144
    ds_read_b64_tr_b16 a[72:73], v11 offset:57344
    s_waitcnt lgkmcnt(9)
    ds_read_b64_tr_b16 a[74:75], v11 offset:57856
    buffer_load_dwordx4 v14, s[16:19], s83 offen offset:1024 lds
    s_waitcnt lgkmcnt(7)
    v_mfma_f32_32x32x16_bf16 a[0:15], a[80:83], v[180:183], a[0:15]
    ds_read_b64_tr_b16 a[76:77], v12 offset:57344
    ds_read_b64_tr_b16 a[78:79], v12 offset:57856
    ds_read_b64_tr_b16 a[132:133], v57 offset:0
    v_cvt_pk_bf16_f32 v192, v80, v81
    v_cvt_pk_bf16_f32 v193, v82, v83
    v_cvt_pk_bf16_f32 v194, v84, v85
    v_mfma_f32_32x32x16_bf16 a[16:31], a[84:87], v[180:183], a[16:31]
    s_add_u32 m0, s46, 8192
    ds_read_b64_tr_b16 a[80:81], v9 offset:61440
    ds_read_b64_tr_b16 a[82:83], v9 offset:61952
    buffer_load_dwordx4 v13, s[16:19], s84 offen offset:0 lds
    v_mfma_f32_32x32x16_bf16 a[32:47], a[88:91], v[180:183], a[32:47]
    ds_read_b64_tr_b16 a[84:85], v10 offset:61440
    ds_read_b64_tr_b16 a[86:87], v10 offset:61952
    v_cvt_pk_bf16_f32 v195, v86, v87
    v_cvt_pk_bf16_f32 v196, v88, v89
    v_cvt_pk_bf16_f32 v197, v90, v91
    v_cvt_pk_bf16_f32 v198, v92, v93
    v_mfma_f32_32x32x16_bf16 a[48:63], a[92:95], v[180:183], a[48:63]
    ds_read_b64_tr_b16 a[88:89], v11 offset:61440
    s_waitcnt lgkmcnt(9)
    ds_read_b64_tr_b16 a[90:91], v11 offset:61952
    buffer_load_dwordx4 v14, s[16:19], s84 offen offset:1024 lds
    s_waitcnt lgkmcnt(7)
    v_mfma_f32_32x32x16_bf16 a[0:15], a[64:67], v[184:187], a[0:15]
    ds_read_b64_tr_b16 a[92:93], v12 offset:61440
    ds_read_b64_tr_b16 a[94:95], v12 offset:61952
    ds_read_b64_tr_b16 a[134:135], v57 offset:1024
    v_cvt_pk_bf16_f32 v199, v94, v95
    v_mfma_f32_32x32x16_bf16 a[16:31], a[68:71], v[184:187], a[16:31]
    s_cmp_eq_u32 s73, 0
    s_cselect_b32 s50, s94, s50
    s_cselect_b32 s55, s95, 0
    s_cselect_b32 s54, 0, 64
    v_and_b32 v27, 3, v0
    v_bfe_u32 v28, v0, 2, 1
    v_mfma_f32_32x32x16_bf16 v[96:111], v[112:115], v[200:203], v[64:79]
    v_lshl_add_u32 v27, v28, 4, v27
    v_bfe_u32 v28, v0, 3, 2
    v_lshl_add_u32 v27, v28, 2, v27
    v_add_u32 v28, 0, v27
    v_sub_u32 v29, 64, v28
    v_cndmask_b32 v28, v28, v29, vcc
    v_mfma_f32_32x32x16_bf16 v[96:111], v[116:119], v[204:207], v[96:111]
    s_barrier
    ds_read_b64_tr_b16 a[64:65], v3 offset:0
    ds_read_b64_tr_b16 a[66:67], v3 offset:512
    v_and_b32 v29, 1, v28
    v_lshrrev_b32 v31, 1, v28
    v_lshlrev_b32 v31, 2, v31
    v_mfma_f32_32x32x16_bf16 a[32:47], a[72:75], v[184:187], a[32:47]
    ds_read_b64_tr_b16 a[68:69], v4 offset:0
    ds_read_b64_tr_b16 a[70:71], v4 offset:512
    v_lshl_add_u32 v31, v29, 7, v31
    v_lshl_add_u32 v31, v24, 10, v31
    v_add_u32 v33, s97, v31
    v_mov_b32 v34, v28
    v_mfma_f32_32x32x16_bf16 a[48:63], a[76:79], v[184:187], a[48:63]
    s_add_u32 m0, s45, 32768
    ds_read_b64_tr_b16 a[72:73], v5 offset:0
    s_waitcnt lgkmcnt(9)
    ds_read_b64_tr_b16 a[74:75], v5 offset:512
    buffer_load_dwordx4 v7, s[8:11], s35 offen offset:0 lds
    s_waitcnt lgkmcnt(7)
    v_mfma_f32_32x32x16_bf16 a[0:15], a[80:83], v[188:191], a[0:15]
    ds_read_b64_tr_b16 a[76:77], v6 offset:0
    ds_read_b64_tr_b16 a[78:79], v6 offset:512
    ds_read_b64_tr_b16 a[136:137], v15 offset:0
    v_cvt_pk_bf16_f32 v200, v96, v97
    v_cvt_pk_bf16_f32 v201, v98, v99
    v_cvt_pk_bf16_f32 v202, v100, v101
    v_mfma_f32_32x32x16_bf16 a[16:31], a[84:87], v[188:191], a[16:31]
    ds_read_b64_tr_b16 a[80:81], v3 offset:4096
    ds_read_b64_tr_b16 a[82:83], v3 offset:4608
    buffer_load_dwordx4 v36, s[8:11], s35 offen offset:1024 lds
    v_cvt_pk_bf16_f32 v203, v102, v103
    v_mfma_f32_32x32x16_bf16 a[32:47], a[88:91], v[188:191], a[32:47]
    ds_read_b64_tr_b16 a[84:85], v4 offset:4096
    ds_read_b64_tr_b16 a[86:87], v4 offset:4608
    v_cvt_pk_bf16_f32 v204, v104, v105
    v_cvt_pk_bf16_f32 v205, v106, v107
    v_cvt_pk_bf16_f32 v206, v108, v109
    v_cvt_pk_bf16_f32 v207, v110, v111
    v_mfma_f32_32x32x16_bf16 a[48:63], a[92:95], v[188:191], a[48:63]
    ds_read_b64_tr_b16 a[88:89], v5 offset:4096
    s_waitcnt lgkmcnt(9)
    ds_read_b64_tr_b16 a[90:91], v5 offset:4608
    buffer_load_dwordx4 v8, s[12:15], s35 offen offset:2048 lds
    s_waitcnt lgkmcnt(7)
    v_mfma_f32_32x32x16_bf16 a[0:15], a[64:67], v[192:195], a[0:15]
    ds_read_b64_tr_b16 a[92:93], v6 offset:4096
    ds_read_b64_tr_b16 a[94:95], v6 offset:4608
    ds_read_b64_tr_b16 a[138:139], v15 offset:1024
    v_add_u32 v28, 32, v27
    v_sub_u32 v29, 64, v28
    v_cndmask_b32 v28, v28, v29, vcc
    v_mfma_f32_32x32x16_bf16 a[16:31], a[68:71], v[192:195], a[16:31]
    v_and_b32 v29, 1, v28
    v_lshrrev_b32 v31, 1, v28
    v_lshlrev_b32 v31, 2, v31
    v_lshl_add_u32 v31, v29, 7, v31
    v_lshl_add_u32 v31, v24, 10, v31
    v_add_u32 v61, s97, v31
    v_mfma_f32_32x32x16_bf16 v[80:95], v[112:115], v[208:211], v[64:79]
    v_and_b32 v25, 15, v0
    s_cmp_eq_u32 s96, 0
    s_cselect_b32 s94, 16, 15
    v_sub_u32 v30, s94, v25
    v_and_b32 v30, 15, v30
    v_cndmask_b32 v30, v25, v30, vcc
    v_mfma_f32_32x32x16_bf16 v[80:95], v[116:119], v[212:215], v[80:95]
    ds_read_b64_tr_b16 a[64:65], v3 offset:8192
    ds_read_b64_tr_b16 a[66:67], v3 offset:8704
    buffer_load_dwordx4 v37, s[12:15], s35 offen offset:3072 lds
    v_cmp_eq_u32 vcc, s54, v34
    v_mfma_f32_32x32x16_bf16 a[32:47], a[72:75], v[192:195], a[32:47]
    ds_read_b64_tr_b16 a[68:69], v4 offset:8192
    ds_read_b64_tr_b16 a[70:71], v4 offset:8704
    s_add_u32 s94, s46, 16384
    s_add_u32 s94, s94, s55
    v_lshlrev_b32 v28, 6, v24
    v_add_u32 v28, s94, v28
    v_mfma_f32_32x32x16_bf16 a[48:63], a[76:79], v[192:195], a[48:63]
    s_add_u32 m0, s46, 10240
    ds_read_b64_tr_b16 a[72:73], v5 offset:8192
    s_waitcnt lgkmcnt(9)
    ds_read_b64_tr_b16 a[74:75], v5 offset:8704
    buffer_load_dwordx4 v13, s[16:19], s85 offen offset:0 lds
    s_waitcnt lgkmcnt(7)
    v_mfma_f32_32x32x16_bf16 a[0:15], a[80:83], v[196:199], a[0:15]
    ds_read_b64_tr_b16 a[76:77], v6 offset:8192
    ds_read_b64_tr_b16 a[78:79], v6 offset:8704
    ds_read_b64_tr_b16 a[140:141], v35 offset:0
    v_cvt_pk_bf16_f32 v208, v80, v81
    v_cvt_pk_bf16_f32 v209, v82, v83
    v_cvt_pk_bf16_f32 v210, v84, v85
    v_mfma_f32_32x32x16_bf16 a[16:31], a[84:87], v[196:199], a[16:31]
    ds_read_b64_tr_b16 a[80:81], v3 offset:12288
    ds_read_b64_tr_b16 a[82:83], v3 offset:12800
    buffer_load_dwordx4 v14, s[16:19], s85 offen offset:1024 lds
    v_cvt_pk_bf16_f32 v211, v86, v87
    v_mfma_f32_32x32x16_bf16 a[32:47], a[88:91], v[196:199], a[32:47]
    ds_read_b64_tr_b16 a[84:85], v4 offset:12288
    ds_read_b64_tr_b16 a[86:87], v4 offset:12800
    v_cvt_pk_bf16_f32 v212, v88, v89
    v_cvt_pk_bf16_f32 v213, v90, v91
    v_cvt_pk_bf16_f32 v214, v92, v93
    v_cvt_pk_bf16_f32 v215, v94, v95
    v_mfma_f32_32x32x16_bf16 a[48:63], a[92:95], v[196:199], a[48:63]
    s_add_u32 m0, s46, 12288
    ds_read_b64_tr_b16 a[88:89], v5 offset:12288
    s_waitcnt lgkmcnt(9)
    ds_read_b64_tr_b16 a[90:91], v5 offset:12800
    buffer_load_dwordx4 v13, s[16:19], s86 offen offset:0 lds
    s_waitcnt lgkmcnt(7)
    v_mfma_f32_32x32x16_bf16 a[0:15], a[64:67], v[200:203], a[0:15]
    ds_read_b64_tr_b16 a[92:93], v6 offset:12288
    ds_read_b64_tr_b16 a[94:95], v6 offset:12800
    ds_read_b64_tr_b16 a[142:143], v35 offset:1024
    v_mov_b32 v29, 0x100
    v_cndmask_b32 v1, v33, v28, vcc
    v_cndmask_b32 v2, v29, 16, vcc
    v_mfma_f32_32x32x16_bf16 a[16:31], a[68:71], v[200:203], a[16:31]
    v_bfe_u32 v26, v0, 4, 1
    v_cvt_f32_u32 v31, v30
    v_lshlrev_b32 v30, 31, v30
    v_mul_f32 v31, 0x3d800000, v31
    v_cvt_f32_u32 v32, v24
    v_lshrrev_b32 v29, 16, v30
    v_mfma_f32_32x32x16_bf16 v[96:111], v[112:115], v[216:219], v[64:79]
    v_mul_f32 v32, 4.0, v32
    v_or_b32 v30, v30, v29
    v_mul_f32 v32, v32, v31
    v_cmp_eq_u32 vcc, 0, v26
    v_cos_f32 v33, v32
    v_mfma_f32_32x32x16_bf16 v[96:111], v[116:119], v[220:223], v[96:111]
    s_waitcnt vmcnt(17)
    s_barrier
    ds_read_b64_tr_b16 a[64:65], v9 offset:0
    ds_read_b64_tr_b16 a[66:67], v9 offset:512
    v_sin_f32 v34, v32
    v_mfma_f32_32x32x16_bf16 a[32:47], a[72:75], v[200:203], a[32:47]
    ds_read_b64_tr_b16 a[68:69], v10 offset:0
    ds_read_b64_tr_b16 a[70:71], v10 offset:512
    v_add_f32 v32, v32, v31
    v_cvt_pk_bf16_f32 v33, v33, v34
    v_cndmask_b32 v34, 0, v33, vcc
    v_cndmask_b32 v29, 0, v30, vcc
    v_mfma_f32_32x32x16_bf16 a[48:63], a[76:79], v[200:203], a[48:63]
    v_add_u32 v7, 0x80, v7
    v_add_u32 v8, 0x80, v8
    v_add_u32 v36, 0x80, v36
    v_add_u32 v37, 0x80, v37
    s_add_u32 m0, s45, 49152
    ds_read_b64_tr_b16 a[72:73], v11 offset:0
    s_waitcnt lgkmcnt(9)
    ds_read_b64_tr_b16 a[74:75], v11 offset:512
    buffer_load_dwordx4 v7, s[8:11], s28 offen offset:0 lds
    s_waitcnt lgkmcnt(7)
    v_mfma_f32_32x32x16_bf16 a[0:15], a[80:83], v[204:207], a[0:15]
    ds_read_b64_tr_b16 a[76:77], v12 offset:0
    ds_read_b64_tr_b16 a[78:79], v12 offset:512
    s_waitcnt vmcnt(10)
    ds_read_b64_tr_b16 a[144:145], v56 offset:4096
    v_cvt_pk_bf16_f32 v216, v96, v97
    v_cvt_pk_bf16_f32 v217, v98, v99
    v_mfma_f32_32x32x16_bf16 a[16:31], a[84:87], v[204:207], a[16:31]
    ds_read_b64_tr_b16 a[80:81], v9 offset:4096
    ds_read_b64_tr_b16 a[82:83], v9 offset:4608
    buffer_load_dwordx4 v36, s[8:11], s28 offen offset:1024 lds
    v_cvt_pk_bf16_f32 v218, v100, v101
    v_mfma_f32_32x32x16_bf16 a[32:47], a[88:91], v[204:207], a[32:47]
    ds_read_b64_tr_b16 a[84:85], v10 offset:4096
    ds_read_b64_tr_b16 a[86:87], v10 offset:4608
    v_cvt_pk_bf16_f32 v219, v102, v103
    v_cvt_pk_bf16_f32 v220, v104, v105
    v_cvt_pk_bf16_f32 v221, v106, v107
    v_cvt_pk_bf16_f32 v222, v108, v109
    v_mfma_f32_32x32x16_bf16 a[48:63], a[92:95], v[204:207], a[48:63]
    ds_read_b64_tr_b16 a[88:89], v11 offset:4096
    s_waitcnt lgkmcnt(9)
    ds_read_b64_tr_b16 a[90:91], v11 offset:4608
    buffer_load_dwordx4 v8, s[12:15], s28 offen offset:2048 lds
    s_waitcnt lgkmcnt(7)
    v_mfma_f32_32x32x16_bf16 a[0:15], a[64:67], v[208:211], a[0:15]
    ds_read_b64_tr_b16 a[92:93], v12 offset:4096
    ds_read_b64_tr_b16 a[94:95], v12 offset:4608
    ds_read_b64_tr_b16 a[146:147], v56 offset:5120
    v_cvt_pk_bf16_f32 v223, v110, v111
    v_accvgpr_write_b32 a240, v34
    v_xor_b32 v33, v33, v34
    v_mfma_f32_32x32x16_bf16 a[16:31], a[68:71], v[208:211], a[16:31]
    v_xor_b32 v34, v34, v29
    v_accvgpr_write_b32 a248, v33
    v_xor_b32 v29, v29, v30
    v_accvgpr_write_b32 a244, v34
    v_xor_b32 v33, v33, v29
    v_accvgpr_write_b32 a252, v33
    v_mfma_f32_32x32x16_bf16 v[80:95], v[112:115], v[224:227], v[64:79]
    v_cos_f32 v33, v32
    v_sin_f32 v34, v32
    v_add_f32 v32, v32, v31
    v_cvt_pk_bf16_f32 v33, v33, v34
    v_mfma_f32_32x32x16_bf16 v[80:95], v[116:119], v[228:231], v[80:95]
    ds_read_b64_tr_b16 a[64:65], v9 offset:8192
    ds_read_b64_tr_b16 a[66:67], v9 offset:8704
    buffer_load_dwordx4 v37, s[12:15], s28 offen offset:3072 lds
    v_cndmask_b32 v34, 0, v33, vcc
    v_mfma_f32_32x32x16_bf16 a[32:47], a[72:75], v[208:211], a[32:47]
    ds_read_b64_tr_b16 a[68:69], v10 offset:8192
    ds_read_b64_tr_b16 a[70:71], v10 offset:8704
    v_cndmask_b32 v29, 0, v30, vcc
    v_accvgpr_write_b32 a241, v34
    v_xor_b32 v33, v33, v34
    v_xor_b32 v34, v34, v29
    v_mfma_f32_32x32x16_bf16 a[48:63], a[76:79], v[208:211], a[48:63]
    s_add_u32 m0, s46, 12288
    ds_read_b64_tr_b16 a[72:73], v11 offset:8192
    s_waitcnt lgkmcnt(9)
    ds_read_b64_tr_b16 a[74:75], v11 offset:8704
    buffer_load_dwordx4 v14, s[16:19], s86 offen offset:1024 lds
    s_waitcnt lgkmcnt(7)
    v_mfma_f32_32x32x16_bf16 a[0:15], a[80:83], v[212:215], a[0:15]
    ds_read_b64_tr_b16 a[76:77], v12 offset:8192
    ds_read_b64_tr_b16 a[78:79], v12 offset:8704
    ds_read_b64_tr_b16 a[148:149], v57 offset:4096
    v_cvt_pk_bf16_f32 v224, v80, v81
    v_cvt_pk_bf16_f32 v225, v82, v83
    v_cvt_pk_bf16_f32 v226, v84, v85
    v_mfma_f32_32x32x16_bf16 a[16:31], a[84:87], v[212:215], a[16:31]
    s_add_u32 m0, s46, 14336
    ds_read_b64_tr_b16 a[80:81], v9 offset:12288
    ds_read_b64_tr_b16 a[82:83], v9 offset:12800
    buffer_load_dwordx4 v13, s[16:19], s87 offen offset:0 lds
    v_mfma_f32_32x32x16_bf16 a[32:47], a[88:91], v[212:215], a[32:47]
    ds_read_b64_tr_b16 a[84:85], v10 offset:12288
    ds_read_b64_tr_b16 a[86:87], v10 offset:12800
    v_cvt_pk_bf16_f32 v227, v86, v87
    v_cvt_pk_bf16_f32 v228, v88, v89
    v_cvt_pk_bf16_f32 v229, v90, v91
    v_cvt_pk_bf16_f32 v230, v92, v93
    v_mfma_f32_32x32x16_bf16 a[48:63], a[92:95], v[212:215], a[48:63]
    ds_read_b64_tr_b16 a[88:89], v11 offset:12288
    s_waitcnt lgkmcnt(9)
    ds_read_b64_tr_b16 a[90:91], v11 offset:12800
    buffer_load_dwordx4 v14, s[16:19], s87 offen offset:1024 lds
    s_waitcnt lgkmcnt(7)
    v_mfma_f32_32x32x16_bf16 a[0:15], a[64:67], v[216:219], a[0:15]
    ds_read_b64_tr_b16 a[92:93], v12 offset:12288
    ds_read_b64_tr_b16 a[94:95], v12 offset:12800
    ds_read_b64_tr_b16 a[150:151], v57 offset:5120
    v_cvt_pk_bf16_f32 v231, v94, v95
    v_accvgpr_write_b32 a249, v33
    v_xor_b32 v29, v29, v30
    v_mfma_f32_32x32x16_bf16 a[16:31], a[68:71], v[216:219], a[16:31]
    v_accvgpr_write_b32 a245, v34
    v_xor_b32 v33, v33, v29
    v_accvgpr_write_b32 a253, v33
    v_cos_f32 v33, v32
    v_mfma_f32_32x32x16_bf16 v[96:111], v[112:115], v[232:235], v[64:79]
    v_sin_f32 v34, v32
    v_add_f32 v32, v32, v31
    v_cvt_pk_bf16_f32 v33, v33, v34
    v_cndmask_b32 v34, 0, v33, vcc
    v_cndmask_b32 v29, 0, v30, vcc
    v_mfma_f32_32x32x16_bf16 v[96:111], v[116:119], v[236:239], v[96:111]
    s_barrier
    buffer_load_dword v63, off, s[36:39], 0 sc1
    ds_read_b64_tr_b16 a[64:65], v9 offset:16384
    ds_read_b64_tr_b16 a[66:67], v9 offset:16896
    v_accvgpr_write_b32 a242, v34
    v_xor_b32 v33, v33, v34
    v_mfma_f32_32x32x16_bf16 a[32:47], a[72:75], v[216:219], a[32:47]
    ds_read_b64_tr_b16 a[68:69], v10 offset:16384
    ds_read_b64_tr_b16 a[70:71], v10 offset:16896
    v_xor_b32 v34, v34, v29
    v_accvgpr_write_b32 a250, v33
    v_xor_b32 v29, v29, v30
    v_accvgpr_write_b32 a246, v34
    v_mfma_f32_32x32x16_bf16 a[48:63], a[76:79], v[216:219], a[48:63]
    s_add_u32 m0, s45, 65536
    ds_read_b64_tr_b16 a[72:73], v11 offset:16384
    s_waitcnt lgkmcnt(9)
    ds_read_b64_tr_b16 a[74:75], v11 offset:16896
    buffer_load_dwordx4 v7, s[8:11], s29 offen offset:0 lds
    s_waitcnt lgkmcnt(7)
    v_mfma_f32_32x32x16_bf16 a[0:15], a[80:83], v[220:223], a[0:15]
    ds_read_b64_tr_b16 a[76:77], v12 offset:16384
    ds_read_b64_tr_b16 a[78:79], v12 offset:16896
    ds_read_b64_tr_b16 a[152:153], v15 offset:4096
    v_cvt_pk_bf16_f32 v232, v96, v97
    v_cvt_pk_bf16_f32 v233, v98, v99
    v_cvt_pk_bf16_f32 v234, v100, v101
    v_mfma_f32_32x32x16_bf16 a[16:31], a[84:87], v[220:223], a[16:31]
    ds_read_b64_tr_b16 a[80:81], v9 offset:20480
    ds_read_b64_tr_b16 a[82:83], v9 offset:20992
    buffer_load_dwordx4 v36, s[8:11], s29 offen offset:1024 lds
    v_cvt_pk_bf16_f32 v235, v102, v103
    v_mfma_f32_32x32x16_bf16 a[32:47], a[88:91], v[220:223], a[32:47]
    ds_read_b64_tr_b16 a[84:85], v10 offset:20480
    ds_read_b64_tr_b16 a[86:87], v10 offset:20992
    v_cvt_pk_bf16_f32 v236, v104, v105
    v_cvt_pk_bf16_f32 v237, v106, v107
    v_cvt_pk_bf16_f32 v238, v108, v109
    v_cvt_pk_bf16_f32 v239, v110, v111
    v_mfma_f32_32x32x16_bf16 a[48:63], a[92:95], v[220:223], a[48:63]
    ds_read_b64_tr_b16 a[88:89], v11 offset:20480
    s_waitcnt lgkmcnt(9)
    ds_read_b64_tr_b16 a[90:91], v11 offset:20992
    buffer_load_dwordx4 v8, s[12:15], s29 offen offset:2048 lds
    s_waitcnt lgkmcnt(7)
    v_mfma_f32_32x32x16_bf16 a[0:15], a[64:67], v[224:227], a[0:15]
    ds_read_b64_tr_b16 a[92:93], v12 offset:20480
    ds_read_b64_tr_b16 a[94:95], v12 offset:20992
    ds_read_b64_tr_b16 a[154:155], v15 offset:5120
    v_xor_b32 v33, v33, v29
    v_accvgpr_write_b32 a254, v33
    v_mfma_f32_32x32x16_bf16 a[16:31], a[68:71], v[224:227], a[16:31]
    v_cos_f32 v33, v32
    v_sin_f32 v34, v32
    v_add_f32 v32, v32, v31
    v_cvt_pk_bf16_f32 v33, v33, v34
    v_mfma_f32_32x32x16_bf16 v[80:95], v[112:115], v[240:243], v[64:79]
    v_cndmask_b32 v34, 0, v33, vcc
    v_cndmask_b32 v29, 0, v30, vcc
    v_accvgpr_write_b32 a243, v34
    v_xor_b32 v33, v33, v34
    v_xor_b32 v34, v34, v29
    v_accvgpr_write_b32 a251, v33
    v_mfma_f32_32x32x16_bf16 v[80:95], v[116:119], v[244:247], v[80:95]
    ds_read_b64_tr_b16 a[64:65], v9 offset:24576
    ds_read_b64_tr_b16 a[66:67], v9 offset:25088
    buffer_load_dwordx4 v37, s[12:15], s29 offen offset:3072 lds
    v_xor_b32 v29, v29, v30
    v_mfma_f32_32x32x16_bf16 a[32:47], a[72:75], v[224:227], a[32:47]
    ds_read_b64_tr_b16 a[68:69], v10 offset:24576
    ds_read_b64_tr_b16 a[70:71], v10 offset:25088
    v_accvgpr_write_b32 a247, v34
    v_xor_b32 v33, v33, v29
    v_accvgpr_write_b32 a255, v33
    v_mfma_f32_32x32x16_bf16 a[48:63], a[76:79], v[224:227], a[48:63]
    s_add_u32 m0, s46, 16384
    ds_read_b64_tr_b16 a[72:73], v11 offset:24576
    s_waitcnt lgkmcnt(9)
    ds_read_b64_tr_b16 a[74:75], v11 offset:25088
    buffer_load_dwordx4 v13, s[16:19], s88 offen offset:0 lds
    s_waitcnt lgkmcnt(7)
    v_mfma_f32_32x32x16_bf16 a[0:15], a[80:83], v[228:231], a[0:15]
    ds_read_b64_tr_b16 a[76:77], v12 offset:24576
    ds_read_b64_tr_b16 a[78:79], v12 offset:25088
    ds_read_b64_tr_b16 a[156:157], v35 offset:4096
    v_cvt_pk_bf16_f32 v240, v80, v81
    v_cvt_pk_bf16_f32 v241, v82, v83
    v_cvt_pk_bf16_f32 v242, v84, v85
    v_mfma_f32_32x32x16_bf16 a[16:31], a[84:87], v[228:231], a[16:31]
    ds_read_b64_tr_b16 a[80:81], v9 offset:28672
    ds_read_b64_tr_b16 a[82:83], v9 offset:29184
    buffer_load_dwordx4 v14, s[16:19], s88 offen offset:1024 lds
    v_cvt_pk_bf16_f32 v243, v86, v87
    v_mfma_f32_32x32x16_bf16 a[32:47], a[88:91], v[228:231], a[32:47]
    ds_read_b64_tr_b16 a[84:85], v10 offset:28672
    ds_read_b64_tr_b16 a[86:87], v10 offset:29184
    v_cvt_pk_bf16_f32 v244, v88, v89
    v_cvt_pk_bf16_f32 v245, v90, v91
    v_cvt_pk_bf16_f32 v246, v92, v93
    v_cvt_pk_bf16_f32 v247, v94, v95
    v_mfma_f32_32x32x16_bf16 a[48:63], a[92:95], v[228:231], a[48:63]
    s_add_u32 m0, s46, 18432
    ds_read_b64_tr_b16 a[88:89], v11 offset:28672
    s_waitcnt lgkmcnt(9)
    ds_read_b64_tr_b16 a[90:91], v11 offset:29184
    buffer_load_dwordx4 v13, s[16:19], s89 offen offset:0 lds
    s_waitcnt lgkmcnt(7)
    v_mfma_f32_32x32x16_bf16 a[0:15], a[64:67], v[232:235], a[0:15]
    ds_read_b64_tr_b16 a[92:93], v12 offset:28672
    ds_read_b64_tr_b16 a[94:95], v12 offset:29184
    ds_read_b64_tr_b16 a[158:159], v35 offset:5120
    v_mfma_f32_32x32x16_bf16 a[16:31], a[68:71], v[232:235], a[16:31]
    v_mfma_f32_32x32x16_bf16 v[96:111], v[112:115], v[248:251], v[64:79]
    v_mfma_f32_32x32x16_bf16 v[96:111], v[116:119], v[252:255], v[96:111]
    s_waitcnt vmcnt(18)
    s_barrier
    ds_read_b64_tr_b16 a[64:65], v9 offset:32768
    ds_read_b64_tr_b16 a[66:67], v9 offset:33280
    v_mfma_f32_32x32x16_bf16 a[32:47], a[72:75], v[232:235], a[32:47]
    ds_read_b64_tr_b16 a[68:69], v10 offset:32768
    ds_read_b64_tr_b16 a[70:71], v10 offset:33280
    v_mfma_f32_32x32x16_bf16 a[48:63], a[76:79], v[232:235], a[48:63]
    s_add_u32 m0, s45, 0
    ds_read_b64_tr_b16 a[72:73], v11 offset:32768
    s_waitcnt lgkmcnt(9)
    ds_read_b64_tr_b16 a[74:75], v11 offset:33280
    buffer_load_dwordx4 v7, s[8:11], s30 offen offset:0 lds
    s_waitcnt lgkmcnt(7)
    v_mfma_f32_32x32x16_bf16 a[0:15], a[80:83], v[236:239], a[0:15]
    ds_read_b64_tr_b16 a[76:77], v12 offset:32768
    ds_read_b64_tr_b16 a[78:79], v12 offset:33280
    s_waitcnt vmcnt(17)
    ds_read_b64_tr_b16 a[160:161], v56 offset:8192
    v_cvt_pk_bf16_f32 v248, v96, v97
    v_cvt_pk_bf16_f32 v249, v98, v99
    v_mfma_f32_32x32x16_bf16 a[16:31], a[84:87], v[236:239], a[16:31]
    ds_read_b64_tr_b16 a[80:81], v9 offset:36864
    ds_read_b64_tr_b16 a[82:83], v9 offset:37376
    buffer_load_dwordx4 v36, s[8:11], s30 offen offset:1024 lds
    v_cvt_pk_bf16_f32 v250, v100, v101
    v_mfma_f32_32x32x16_bf16 a[32:47], a[88:91], v[236:239], a[32:47]
    ds_read_b64_tr_b16 a[84:85], v10 offset:36864
    ds_read_b64_tr_b16 a[86:87], v10 offset:37376
    v_cvt_pk_bf16_f32 v251, v102, v103
    v_cvt_pk_bf16_f32 v252, v104, v105
    v_cvt_pk_bf16_f32 v253, v106, v107
    v_cvt_pk_bf16_f32 v254, v108, v109
    v_mfma_f32_32x32x16_bf16 a[48:63], a[92:95], v[236:239], a[48:63]
    ds_read_b64_tr_b16 a[88:89], v11 offset:36864
    s_waitcnt lgkmcnt(9)
    ds_read_b64_tr_b16 a[90:91], v11 offset:37376
    buffer_load_dwordx4 v8, s[12:15], s30 offen offset:2048 lds
    s_waitcnt lgkmcnt(7)
    v_mfma_f32_32x32x16_bf16 a[0:15], a[64:67], v[240:243], a[0:15]
    ds_read_b64_tr_b16 a[92:93], v12 offset:36864
    ds_read_b64_tr_b16 a[94:95], v12 offset:37376
    ds_read_b64_tr_b16 a[162:163], v56 offset:9216
    v_cvt_pk_bf16_f32 v255, v110, v111
    v_mfma_f32_32x32x16_bf16 a[16:31], a[68:71], v[240:243], a[16:31]
    ds_read_b64_tr_b16 a[64:65], v9 offset:40960
    ds_read_b64_tr_b16 a[66:67], v9 offset:41472
    buffer_load_dwordx4 v37, s[12:15], s30 offen offset:3072 lds
    v_mfma_f32_32x32x16_bf16 a[32:47], a[72:75], v[240:243], a[32:47]
    ds_read_b64_tr_b16 a[68:69], v10 offset:40960
    ds_read_b64_tr_b16 a[70:71], v10 offset:41472
    v_mfma_f32_32x32x16_bf16 a[48:63], a[76:79], v[240:243], a[48:63]
    s_add_u32 m0, s46, 18432
    ds_read_b64_tr_b16 a[72:73], v11 offset:40960
    s_waitcnt lgkmcnt(9)
    ds_read_b64_tr_b16 a[74:75], v11 offset:41472
    buffer_load_dwordx4 v14, s[16:19], s89 offen offset:1024 lds
    s_waitcnt lgkmcnt(7)
    v_mfma_f32_32x32x16_bf16 a[0:15], a[80:83], v[244:247], a[0:15]
    ds_read_b64_tr_b16 a[76:77], v12 offset:40960
    ds_read_b64_tr_b16 a[78:79], v12 offset:41472
    ds_read_b64_tr_b16 a[164:165], v57 offset:8192
    v_mfma_f32_32x32x16_bf16 a[16:31], a[84:87], v[244:247], a[16:31]
    s_add_u32 m0, s46, 0
    ds_read_b64_tr_b16 a[80:81], v9 offset:45056
    ds_read_b64_tr_b16 a[82:83], v9 offset:45568
    buffer_load_dwordx4 v13, s[16:19], s90 offen offset:0 lds
    v_mfma_f32_32x32x16_bf16 a[32:47], a[88:91], v[244:247], a[32:47]
    ds_read_b64_tr_b16 a[84:85], v10 offset:45056
    ds_read_b64_tr_b16 a[86:87], v10 offset:45568
    v_mfma_f32_32x32x16_bf16 a[48:63], a[92:95], v[244:247], a[48:63]
    ds_read_b64_tr_b16 a[88:89], v11 offset:45056
    s_waitcnt lgkmcnt(9)
    ds_read_b64_tr_b16 a[90:91], v11 offset:45568
    buffer_load_dwordx4 v14, s[16:19], s90 offen offset:1024 lds
    s_waitcnt lgkmcnt(7)
    v_mfma_f32_32x32x16_bf16 a[0:15], a[64:67], v[248:251], a[0:15]
    ds_read_b64_tr_b16 a[92:93], v12 offset:45056
    ds_read_b64_tr_b16 a[94:95], v12 offset:45568
    ds_read_b64_tr_b16 a[166:167], v57 offset:9216
    v_mfma_f32_32x32x16_bf16 a[16:31], a[68:71], v[248:251], a[16:31]
    s_waitcnt vmcnt(18)
    s_barrier
    s_mov_b32 s79, 60000
    s_waitcnt vmcnt(14)
L_tag_2:
    v_readfirstlane_b32 s75, v63
    s_nop 0
    s_cmp_lg_u32 s75, 0
    s_cbranch_scc1 L_tagd_3
    s_sub_u32 s79, s79, 1
    s_cbranch_scc1 L_tagd_3
    s_sleep 8
    buffer_load_dword v63, off, s[36:39], 0 sc1
    s_waitcnt vmcnt(0)
    s_branch L_tag_2
L_tagd_3:
    ds_read_b64_tr_b16 a[64:65], v9 offset:49152
    ds_read_b64_tr_b16 a[66:67], v9 offset:49664
    v_mfma_f32_32x32x16_bf16 a[32:47], a[72:75], v[248:251], a[32:47]
    ds_read_b64_tr_b16 a[68:69], v10 offset:49152
    ds_read_b64_tr_b16 a[70:71], v10 offset:49664
    v_mfma_f32_32x32x16_bf16 a[48:63], a[76:79], v[248:251], a[48:63]
    s_add_u32 m0, s45, 16384
    ds_read_b64_tr_b16 a[72:73], v11 offset:49152
    s_waitcnt lgkmcnt(9)
    ds_read_b64_tr_b16 a[74:75], v11 offset:49664
    buffer_load_dwordx4 v7, s[8:11], s31 offen offset:0 lds
    s_waitcnt lgkmcnt(7)
    v_mfma_f32_32x32x16_bf16 a[0:15], a[80:83], v[252:255], a[0:15]
    ds_read_b64_tr_b16 a[76:77], v12 offset:49152
    ds_read_b64_tr_b16 a[78:79], v12 offset:49664
    ds_read_b64_tr_b16 a[168:169], v15 offset:8192
    v_mfma_f32_32x32x16_bf16 a[16:31], a[84:87], v[252:255], a[16:31]
    ds_read_b64_tr_b16 a[80:81], v9 offset:53248
    ds_read_b64_tr_b16 a[82:83], v9 offset:53760
    buffer_load_dwordx4 v36, s[8:11], s31 offen offset:1024 lds
    v_mfma_f32_32x32x16_bf16 a[32:47], a[88:91], v[252:255], a[32:47]
    ds_read_b64_tr_b16 a[84:85], v10 offset:53248
    ds_read_b64_tr_b16 a[86:87], v10 offset:53760
    v_mfma_f32_32x32x16_bf16 a[48:63], a[92:95], v[252:255], a[48:63]
    ds_read_b64_tr_b16 a[88:89], v11 offset:53248
    s_waitcnt lgkmcnt(9)
    ds_read_b64_tr_b16 a[90:91], v11 offset:53760
    buffer_load_dwordx4 v8, s[12:15], s31 offen offset:2048 lds
    s_waitcnt lgkmcnt(7)
    v_mfma_f32_32x32x16_bf16 v[64:79], a[64:67], v[128:131], 0
    ds_read_b64_tr_b16 a[92:93], v12 offset:53248
    ds_read_b64_tr_b16 a[94:95], v12 offset:53760
    ds_read_b64_tr_b16 a[170:171], v15 offset:9216
    v_mfma_f32_32x32x16_bf16 v[80:95], a[68:71], v[128:131], 0
    ds_read_b64_tr_b16 a[64:65], v9 offset:57344
    ds_read_b64_tr_b16 a[66:67], v9 offset:57856
    buffer_load_dwordx4 v37, s[12:15], s31 offen offset:3072 lds
    v_mfma_f32_32x32x16_bf16 v[96:111], a[72:75], v[128:131], 0
    ds_read_b64_tr_b16 a[68:69], v10 offset:57344
    ds_read_b64_tr_b16 a[70:71], v10 offset:57856
    s_add_u32 m0, s46, 2048
    v_accvgpr_read_b32 v24, a0
    buffer_load_dwordx4 v13, s[16:19], s91 offen offset:0 lds
    v_accvgpr_read_b32 v25, a1
    v_accvgpr_read_b32 v26, a2
    v_accvgpr_read_b32 v27, a3
    v_pk_mul_f32 v[24:25], v[24:25], v[20:21]
    v_pk_mul_f32 v[26:27], v[26:27], v[20:21]
    v_exp_f32 v24, v24
    v_accvgpr_read_b32 v28, a8
    v_exp_f32 v25, v25
    v_accvgpr_read_b32 v29, a9
    v_exp_f32 v26, v26
    v_accvgpr_read_b32 v30, a10
    v_exp_f32 v27, v27
    v_accvgpr_read_b32 v31, a11
    v_pk_add_f32 v[24:25], v[24:25], s[64:65]
    v_pk_add_f32 v[26:27], v[26:27], s[64:65]
    v_rcp_f32 v24, v24
    v_rcp_f32 v25, v25
    v_pk_mul_f32 v[28:29], v[28:29], v[18:19]
    v_rcp_f32 v26, v26
    v_rcp_f32 v27, v27
    v_pk_mul_f32 v[30:31], v[30:31], v[18:19]
    v_pk_mul_f32 v[28:29], v[28:29], v[24:25]
    v_pk_mul_f32 v[30:31], v[30:31], v[26:27]
    v_cvt_pk_bf16_f32 v40, v28, v29
    v_cvt_pk_bf16_f32 v41, v30, v31
    v_accvgpr_read_b32 v24, a4
    v_accvgpr_read_b32 v25, a5
    v_accvgpr_read_b32 v26, a6
    v_accvgpr_read_b32 v27, a7
    v_pk_mul_f32 v[24:25], v[24:25], v[20:21]
    v_pk_mul_f32 v[26:27], v[26:27], v[20:21]
    buffer_load_dwordx4 v14, s[16:19], s91 offen offset:1024 lds
    v_exp_f32 v24, v24
    v_accvgpr_read_b32 v28, a12
    v_exp_f32 v25, v25
    v_accvgpr_read_b32 v29, a13
    v_exp_f32 v26, v26
    v_accvgpr_read_b32 v30, a14
    v_exp_f32 v27, v27
    v_accvgpr_read_b32 v31, a15
    v_pk_add_f32 v[24:25], v[24:25], s[64:65]
    v_pk_add_f32 v[26:27], v[26:27], s[64:65]
    v_rcp_f32 v24, v24
    v_rcp_f32 v25, v25
    v_pk_mul_f32 v[28:29], v[28:29], v[18:19]
    v_rcp_f32 v26, v26
    v_rcp_f32 v27, v27
    v_pk_mul_f32 v[30:31], v[30:31], v[18:19]
    v_pk_mul_f32 v[28:29], v[28:29], v[24:25]
    v_pk_mul_f32 v[30:31], v[30:31], v[26:27]
    v_cvt_pk_bf16_f32 v42, v28, v29
    v_cvt_pk_bf16_f32 v43, v30, v31
    buffer_store_dwordx4 v[40:43], v62, s[20:23], s52 offen offset:0 sc1
    v_accvgpr_read_b32 v24, a16
    v_accvgpr_read_b32 v25, a17
    v_accvgpr_read_b32 v26, a18
    v_accvgpr_read_b32 v27, a19
    v_pk_mul_f32 v[24:25], v[24:25], v[20:21]
    v_pk_mul_f32 v[26:27], v[26:27], v[20:21]
    v_exp_f32 v24, v24
    v_accvgpr_read_b32 v28, a24
    v_exp_f32 v25, v25
    v_accvgpr_read_b32 v29, a25
    s_add_u32 m0, s46, 4096
    v_exp_f32 v26, v26
    buffer_load_dwordx4 v13, s[16:19], s92 offen offset:0 lds
    v_accvgpr_read_b32 v30, a26
    v_exp_f32 v27, v27
    v_accvgpr_read_b32 v31, a27
    v_pk_add_f32 v[24:25], v[24:25], s[64:65]
    v_pk_add_f32 v[26:27], v[26:27], s[64:65]
    v_rcp_f32 v24, v24
    v_rcp_f32 v25, v25
    v_pk_mul_f32 v[28:29], v[28:29], v[18:19]
    v_rcp_f32 v26, v26
    v_rcp_f32 v27, v27
    v_pk_mul_f32 v[30:31], v[30:31], v[18:19]
    v_pk_mul_f32 v[28:29], v[28:29], v[24:25]
    v_pk_mul_f32 v[30:31], v[30:31], v[26:27]
    v_cvt_pk_bf16_f32 v44, v28, v29
    v_cvt_pk_bf16_f32 v45, v30, v31
    v_accvgpr_read_b32 v24, a20
    v_accvgpr_read_b32 v25, a21
    v_accvgpr_read_b32 v26, a22
    v_accvgpr_read_b32 v27, a23
    v_pk_mul_f32 v[24:25], v[24:25], v[20:21]
    v_pk_mul_f32 v[26:27], v[26:27], v[20:21]
    v_exp_f32 v24, v24
    v_accvgpr_read_b32 v28, a28
    v_exp_f32 v25, v25
    v_accvgpr_read_b32 v29, a29
    v_exp_f32 v26, v26
    v_accvgpr_read_b32 v30, a30
    v_exp_f32 v27, v27
    v_accvgpr_read_b32 v31, a31
    v_pk_add_f32 v[24:25], v[24:25], s[64:65]
    v_pk_add_f32 v[26:27], v[26:27], s[64:65]
    v_rcp_f32 v24, v24
    buffer_load_dwordx4 v14, s[16:19], s92 offen offset:1024 lds
    v_rcp_f32 v25, v25
    v_pk_mul_f32 v[28:29], v[28:29], v[18:19]
    v_rcp_f32 v26, v26
    v_rcp_f32 v27, v27
    v_pk_mul_f32 v[30:31], v[30:31], v[18:19]
    v_pk_mul_f32 v[28:29], v[28:29], v[24:25]
    v_pk_mul_f32 v[30:31], v[30:31], v[26:27]
    v_cvt_pk_bf16_f32 v46, v28, v29
    v_cvt_pk_bf16_f32 v47, v30, v31
    buffer_store_dwordx4 v[44:47], v62, s[20:23], s52 offen offset:1024 sc1
    v_accvgpr_read_b32 v24, a32
    v_accvgpr_read_b32 v25, a33
    v_accvgpr_read_b32 v26, a34
    v_accvgpr_read_b32 v27, a35
    v_pk_mul_f32 v[24:25], v[24:25], v[20:21]
    v_pk_mul_f32 v[26:27], v[26:27], v[20:21]
    v_exp_f32 v24, v24
    v_accvgpr_read_b32 v28, a40
    v_exp_f32 v25, v25
    v_accvgpr_read_b32 v29, a41
    v_exp_f32 v26, v26
    v_accvgpr_read_b32 v30, a42
    v_exp_f32 v27, v27
    v_accvgpr_read_b32 v31, a43
    v_pk_add_f32 v[24:25], v[24:25], s[64:65]
    v_pk_add_f32 v[26:27], v[26:27], s[64:65]
    v_rcp_f32 v24, v24
    v_rcp_f32 v25, v25
    v_pk_mul_f32 v[28:29], v[28:29], v[18:19]
    v_rcp_f32 v26, v26
    v_rcp_f32 v27, v27
    s_add_u32 m0, s46, 6144
    v_pk_mul_f32 v[30:31], v[30:31], v[18:19]
    buffer_load_dwordx4 v13, s[16:19], s93 offen offset:0 lds
    v_pk_mul_f32 v[28:29], v[28:29], v[24:25]
    v_pk_mul_f32 v[30:31], v[30:31], v[26:27]
    v_cvt_pk_bf16_f32 v40, v28, v29
    v_cvt_pk_bf16_f32 v41, v30, v31
    v_accvgpr_read_b32 v24, a36
    v_accvgpr_read_b32 v25, a37
    v_accvgpr_read_b32 v26, a38
    v_accvgpr_read_b32 v27, a39
    v_pk_mul_f32 v[24:25], v[24:25], v[20:21]
    v_pk_mul_f32 v[26:27], v[26:27], v[20:21]
    v_exp_f32 v24, v24
    v_accvgpr_read_b32 v28, a44
    v_exp_f32 v25, v25
    v_accvgpr_read_b32 v29, a45
    v_exp_f32 v26, v26
    v_accvgpr_read_b32 v30, a46
    v_exp_f32 v27, v27
    v_accvgpr_read_b32 v31, a47
    v_pk_add_f32 v[24:25], v[24:25], s[64:65]
    v_pk_add_f32 v[26:27], v[26:27], s[64:65]
    v_rcp_f32 v24, v24
    v_rcp_f32 v25, v25
    v_pk_mul_f32 v[28:29], v[28:29], v[18:19]
    v_rcp_f32 v26, v26
    v_rcp_f32 v27, v27
    v_pk_mul_f32 v[30:31], v[30:31], v[18:19]
    v_pk_mul_f32 v[28:29], v[28:29], v[24:25]
    v_pk_mul_f32 v[30:31], v[30:31], v[26:27]
    v_cvt_pk_bf16_f32 v42, v28, v29
    v_cvt_pk_bf16_f32 v43, v30, v31
    buffer_store_dwordx4 v[40:43], v62, s[20:23], s52 offen offset:2048 sc1
    v_accvgpr_read_b32 v24, a48
    buffer_load_dwordx4 v14, s[16:19], s93 offen offset:1024 lds
    v_accvgpr_read_b32 v25, a49
    v_accvgpr_read_b32 v26, a50
    v_accvgpr_read_b32 v27, a51
    v_pk_mul_f32 v[24:25], v[24:25], v[20:21]
    v_pk_mul_f32 v[26:27], v[26:27], v[20:21]
    v_exp_f32 v24, v24
    v_accvgpr_read_b32 v28, a56
    v_exp_f32 v25, v25
    v_accvgpr_read_b32 v29, a57
    v_exp_f32 v26, v26
    v_accvgpr_read_b32 v30, a58
    v_exp_f32 v27, v27
    v_accvgpr_read_b32 v31, a59
    v_pk_add_f32 v[24:25], v[24:25], s[64:65]
    v_pk_add_f32 v[26:27], v[26:27], s[64:65]
    v_rcp_f32 v24, v24
    v_rcp_f32 v25, v25
    v_pk_mul_f32 v[28:29], v[28:29], v[18:19]
    v_rcp_f32 v26, v26
    v_rcp_f32 v27, v27
    v_pk_mul_f32 v[30:31], v[30:31], v[18:19]
    v_pk_mul_f32 v[28:29], v[28:29], v[24:25]
    v_pk_mul_f32 v[30:31], v[30:31], v[26:27]
    v_cvt_pk_bf16_f32 v44, v28, v29
    v_cvt_pk_bf16_f32 v45, v30, v31
    v_accvgpr_read_b32 v24, a52
    v_accvgpr_read_b32 v25, a53
    v_accvgpr_read_b32 v26, a54
    v_accvgpr_read_b32 v27, a55
    v_pk_mul_f32 v[24:25], v[24:25], v[20:21]
    v_pk_mul_f32 v[26:27], v[26:27], v[20:21]
    v_exp_f32 v24, v24
    v_accvgpr_read_b32 v28, a60
    v_exp_f32 v25, v25
    v_accvgpr_read_b32 v29, a61
    v_exp_f32 v26, v26
    v_accvgpr_read_b32 v30, a62
    v_exp_f32 v27, v27
    v_accvgpr_read_b32 v31, a63
    v_pk_add_f32 v[24:25], v[24:25], s[64:65]
    v_pk_add_f32 v[26:27], v[26:27], s[64:65]
    v_rcp_f32 v24, v24
    v_rcp_f32 v25, v25
    v_pk_mul_f32 v[28:29], v[28:29], v[18:19]
    v_rcp_f32 v26, v26
    v_rcp_f32 v27, v27
    v_pk_mul_f32 v[30:31], v[30:31], v[18:19]
    v_pk_mul_f32 v[28:29], v[28:29], v[24:25]
    v_pk_mul_f32 v[30:31], v[30:31], v[26:27]
    v_cvt_pk_bf16_f32 v46, v28, v29
    v_cvt_pk_bf16_f32 v47, v30, v31
    buffer_store_dwordx4 v[44:47], v62, s[20:23], s52 offen offset:3072 sc1
    v_mfma_f32_32x32x16_bf16 v[112:127], a[76:79], v[128:131], 0
    ds_read_b64_tr_b16 a[72:73], v11 offset:57344
    s_waitcnt lgkmcnt(9)
    ds_read_b64_tr_b16 a[74:75], v11 offset:57856
    s_waitcnt lgkmcnt(7)
    v_mfma_f32_32x32x16_bf16 v[64:79], a[80:83], v[132:135], v[64:79]
    ds_read_b64_tr_b16 a[76:77], v12 offset:57344
    ds_read_b64_tr_b16 a[78:79], v12 offset:57856
    ds_read_b64_tr_b16 a[172:173], v35 offset:8192
    v_mfma_f32_32x32x16_bf16 v[80:95], a[84:87], v[132:135], v[80:95]
    ds_read_b64_tr_b16 a[80:81], v9 offset:61440
    ds_read_b64_tr_b16 a[82:83], v9 offset:61952
    v_mfma_f32_32x32x16_bf16 v[96:111], a[88:91], v[132:135], v[96:111]
    ds_read_b64_tr_b16 a[84:85], v10 offset:61440
    ds_read_b64_tr_b16 a[86:87], v10 offset:61952
    ds_read_b64_tr_b16 a[174:175], v35 offset:9216
    v_mfma_f32_32x32x16_bf16 v[112:127], a[92:95], v[132:135], v[112:127]
    s_waitcnt lgkmcnt(9)
    ds_read_b64_tr_b16 a[88:89], v11 offset:61440
    ds_read_b64_tr_b16 a[90:91], v11 offset:61952
    s_waitcnt lgkmcnt(8)
    v_mfma_f32_32x32x16_bf16 v[64:79], a[64:67], v[136:139], v[64:79]
    ds_read_b64_tr_b16 a[92:93], v12 offset:61440
    ds_read_b64_tr_b16 a[94:95], v12 offset:61952
    ds_read_b64_tr_b16 a[176:177], v56 offset:12288
    v_mfma_f32_32x32x16_bf16 v[80:95], a[68:71], v[136:139], v[80:95]
    s_waitcnt vmcnt(24)
    s_barrier
    ds_read_b64_tr_b16 a[64:65], v3 offset:0
    ds_read_b64_tr_b16 a[66:67], v3 offset:512
    v_mfma_f32_32x32x16_bf16 v[96:111], a[72:75], v[136:139], v[96:111]
    ds_read_b64_tr_b16 a[68:69], v4 offset:0
    ds_read_b64_tr_b16 a[70:71], v4 offset:512
    s_waitcnt lgkmcnt(9)
    ds_read_b64_tr_b16 a[178:179], v56 offset:13312
    v_mfma_f32_32x32x16_bf16 v[112:127], a[76:79], v[136:139], v[112:127]
    s_add_u32 m0, s45, 32768
    ds_read_b64_tr_b16 a[72:73], v5 offset:0
    ds_read_b64_tr_b16 a[74:75], v5 offset:512
    buffer_load_dwordx4 v7, s[8:11], s32 offen offset:0 lds
    s_waitcnt lgkmcnt(8)
    v_mfma_f32_32x32x16_bf16 v[64:79], a[80:83], v[140:143], v[64:79]
    ds_read_b64_tr_b16 a[76:77], v6 offset:0
    ds_read_b64_tr_b16 a[78:79], v6 offset:512
    ds_read_b64_tr_b16 a[180:181], v57 offset:12288
    v_mfma_f32_32x32x16_bf16 v[80:95], a[84:87], v[140:143], v[80:95]
    ds_read_b64_tr_b16 a[80:81], v3 offset:4096
    ds_read_b64_tr_b16 a[82:83], v3 offset:4608
    buffer_load_dwordx4 v36, s[8:11], s32 offen offset:1024 lds
    v_mfma_f32_32x32x16_bf16 v[96:111], a[88:91], v[140:143], v[96:111]
    ds_read_b64_tr_b16 a[84:85], v4 offset:4096
    ds_read_b64_tr_b16 a[86:87], v4 offset:4608
    s_waitcnt lgkmcnt(9)
    ds_read_b64_tr_b16 a[182:183], v57 offset:13312
    v_mfma_f32_32x32x16_bf16 v[112:127], a[92:95], v[140:143], v[112:127]
    ds_read_b64_tr_b16 a[88:89], v5 offset:4096
    ds_read_b64_tr_b16 a[90:91], v5 offset:4608
    buffer_load_dwordx4 v8, s[12:15], s32 offen offset:2048 lds
    s_waitcnt lgkmcnt(8)
    v_mfma_f32_32x32x16_bf16 v[64:79], a[64:67], v[144:147], v[64:79]
    ds_read_b64_tr_b16 a[92:93], v6 offset:4096
    ds_read_b64_tr_b16 a[94:95], v6 offset:4608
    ds_read_b64_tr_b16 a[184:185], v15 offset:12288
    v_mfma_f32_32x32x16_bf16 v[80:95], a[68:71], v[144:147], v[80:95]
    ds_read_b64_tr_b16 a[64:65], v3 offset:8192
    ds_read_b64_tr_b16 a[66:67], v3 offset:8704
    buffer_load_dwordx4 v37, s[12:15], s32 offen offset:3072 lds
    v_mfma_f32_32x32x16_bf16 v[96:111], a[72:75], v[144:147], v[96:111]
    ds_read_b64_tr_b16 a[68:69], v4 offset:8192
    ds_read_b64_tr_b16 a[70:71], v4 offset:8704
    s_waitcnt lgkmcnt(9)
    ds_read_b64_tr_b16 a[186:187], v15 offset:13312
    v_mfma_f32_32x32x16_bf16 v[112:127], a[76:79], v[144:147], v[112:127]
    v_add_u32 v13, 0x10000, v13
    v_add_u32 v14, 0x10000, v14
    s_add_u32 m0, s46, 8192
    ds_read_b64_tr_b16 a[72:73], v5 offset:8192
    ds_read_b64_tr_b16 a[74:75], v5 offset:8704
    buffer_load_dwordx4 v13, s[16:19], s80 offen offset:0 lds
    s_waitcnt lgkmcnt(8)
    v_mfma_f32_32x32x16_bf16 v[64:79], a[80:83], v[148:151], v[64:79]
    ds_read_b64_tr_b16 a[76:77], v6 offset:8192
    ds_read_b64_tr_b16 a[78:79], v6 offset:8704
    ds_read_b64_tr_b16 a[188:189], v35 offset:12288
    v_mfma_f32_32x32x16_bf16 v[80:95], a[84:87], v[148:151], v[80:95]
    ds_read_b64_tr_b16 a[80:81], v3 offset:12288
    ds_read_b64_tr_b16 a[82:83], v3 offset:12800
    buffer_load_dwordx4 v14, s[16:19], s80 offen offset:1024 lds
    v_mfma_f32_32x32x16_bf16 v[96:111], a[88:91], v[148:151], v[96:111]
    ds_read_b64_tr_b16 a[84:85], v4 offset:12288
    ds_read_b64_tr_b16 a[86:87], v4 offset:12800
    s_waitcnt lgkmcnt(9)
    ds_read_b64_tr_b16 a[190:191], v35 offset:13312
    v_mfma_f32_32x32x16_bf16 v[112:127], a[92:95], v[148:151], v[112:127]
    s_add_u32 m0, s46, 10240
    ds_read_b64_tr_b16 a[88:89], v5 offset:12288
    ds_read_b64_tr_b16 a[90:91], v5 offset:12800
    buffer_load_dwordx4 v13, s[16:19], s81 offen offset:0 lds
    s_waitcnt lgkmcnt(8)
    v_mfma_f32_32x32x16_bf16 v[64:79], a[64:67], v[152:155], v[64:79]
    ds_read_b64_tr_b16 a[92:93], v6 offset:12288
    ds_read_b64_tr_b16 a[94:95], v6 offset:12800
    s_waitcnt vmcnt(23)
    ds_read_b64_tr_b16 a[192:193], v56 offset:16384
    v_mfma_f32_32x32x16_bf16 v[80:95], a[68:71], v[152:155], v[80:95]
    s_barrier
    ds_read_b64_tr_b16 a[64:65], v9 offset:0
    ds_read_b64_tr_b16 a[66:67], v9 offset:512
    v_mfma_f32_32x32x16_bf16 v[96:111], a[72:75], v[152:155], v[96:111]
    ds_read_b64_tr_b16 a[68:69], v10 offset:0
    ds_read_b64_tr_b16 a[70:71], v10 offset:512
    s_waitcnt lgkmcnt(9)
    ds_read_b64_tr_b16 a[194:195], v56 offset:17408
    v_mfma_f32_32x32x16_bf16 v[112:127], a[76:79], v[152:155], v[112:127]
    s_add_u32 m0, s45, 49152
    ds_read_b64_tr_b16 a[72:73], v11 offset:0
    ds_read_b64_tr_b16 a[74:75], v11 offset:512
    buffer_load_dwordx4 v7, s[8:11], s33 offen offset:0 lds
    s_waitcnt lgkmcnt(8)
    v_mfma_f32_32x32x16_bf16 v[64:79], a[80:83], v[156:159], v[64:79]
    ds_read_b64_tr_b16 a[76:77], v12 offset:0
    ds_read_b64_tr_b16 a[78:79], v12 offset:512
    ds_read_b64_tr_b16 a[196:197], v57 offset:16384
    v_mfma_f32_32x32x16_bf16 v[80:95], a[84:87], v[156:159], v[80:95]
    ds_read_b64_tr_b16 a[80:81], v9 offset:4096
    ds_read_b64_tr_b16 a[82:83], v9 offset:4608
    buffer_load_dwordx4 v36, s[8:11], s33 offen offset:1024 lds
    v_mfma_f32_32x32x16_bf16 v[96:111], a[88:91], v[156:159], v[96:111]
    ds_read_b64_tr_b16 a[84:85], v10 offset:4096
    ds_read_b64_tr_b16 a[86:87], v10 offset:4608
    s_waitcnt lgkmcnt(9)
    ds_read_b64_tr_b16 a[198:199], v57 offset:17408
    v_mfma_f32_32x32x16_bf16 v[112:127], a[92:95], v[156:159], v[112:127]
    ds_read_b64_tr_b16 a[88:89], v11 offset:4096
    ds_read_b64_tr_b16 a[90:91], v11 offset:4608
    buffer_load_dwordx4 v8, s[12:15], s33 offen offset:2048 lds
    s_waitcnt lgkmcnt(8)
    v_mfma_f32_32x32x16_bf16 v[64:79], a[64:67], v[160:163], v[64:79]
    ds_read_b64_tr_b16 a[92:93], v12 offset:4096
    ds_read_b64_tr_b16 a[94:95], v12 offset:4608
    ds_read_b64_tr_b16 a[200:201], v15 offset:16384
    v_mfma_f32_32x32x16_bf16 v[80:95], a[68:71], v[160:163], v[80:95]
    ds_read_b64_tr_b16 a[64:65], v9 offset:8192
    ds_read_b64_tr_b16 a[66:67], v9 offset:8704
    buffer_load_dwordx4 v37, s[12:15], s33 offen offset:3072 lds
    v_mfma_f32_32x32x16_bf16 v[96:111], a[72:75], v[160:163], v[96:111]
    ds_read_b64_tr_b16 a[68:69], v10 offset:8192
    ds_read_b64_tr_b16 a[70:71], v10 offset:8704
    s_waitcnt lgkmcnt(9)
    ds_read_b64_tr_b16 a[202:203], v15 offset:17408
    v_mfma_f32_32x32x16_bf16 v[112:127], a[76:79], v[160:163], v[112:127]
    s_add_u32 m0, s46, 10240
    ds_read_b64_tr_b16 a[72:73], v11 offset:8192
    ds_read_b64_tr_b16 a[74:75], v11 offset:8704
    buffer_load_dwordx4 v14, s[16:19], s81 offen offset:1024 lds
    s_waitcnt lgkmcnt(8)
    v_mfma_f32_32x32x16_bf16 v[64:79], a[80:83], v[164:167], v[64:79]
    ds_read_b64_tr_b16 a[76:77], v12 offset:8192
    ds_read_b64_tr_b16 a[78:79], v12 offset:8704
    ds_read_b64_tr_b16 a[204:205], v35 offset:16384
    v_mfma_f32_32x32x16_bf16 v[80:95], a[84:87], v[164:167], v[80:95]
    s_add_u32 m0, s46, 12288
    ds_read_b64_tr_b16 a[80:81], v9 offset:12288
    ds_read_b64_tr_b16 a[82:83], v9 offset:12800
    buffer_load_dwordx4 v13, s[16:19], s82 offen offset:0 lds
    v_mfma_f32_32x32x16_bf16 v[96:111], a[88:91], v[164:167], v[96:111]
    ds_read_b64_tr_b16 a[84:85], v10 offset:12288
    ds_read_b64_tr_b16 a[86:87], v10 offset:12800
    s_waitcnt lgkmcnt(9)
    ds_read_b64_tr_b16 a[206:207], v35 offset:17408
    v_mfma_f32_32x32x16_bf16 v[112:127], a[92:95], v[164:167], v[112:127]
    ds_read_b64_tr_b16 a[88:89], v11 offset:12288
    ds_read_b64_tr_b16 a[90:91], v11 offset:12800
    buffer_load_dwordx4 v14, s[16:19], s82 offen offset:1024 lds
    s_waitcnt lgkmcnt(8)
    v_mfma_f32_32x32x16_bf16 v[64:79], a[64:67], v[168:171], v[64:79]
    ds_read_b64_tr_b16 a[92:93], v12 offset:12288
    ds_read_b64_tr_b16 a[94:95], v12 offset:12800
    s_waitcnt vmcnt(22)
    ds_read_b64_tr_b16 a[208:209], v56 offset:0
    v_mfma_f32_32x32x16_bf16 v[80:95], a[68:71], v[168:171], v[80:95]
    s_waitcnt vmcnt(14)
    s_barrier
    s_cmp_lg_u32 s68, 0
    s_cbranch_scc1 L_nf_4
    v_mov_b32 v38, s75
    s_mov_b64 exec, 1
    buffer_store_dword v38, off, s[20:23], s53 sc1
    s_mov_b64 exec, -1
L_nf_4:
    ds_read_b64_tr_b16 a[64:65], v9 offset:16384
    ds_read_b64_tr_b16 a[66:67], v9 offset:16896
    v_mfma_f32_32x32x16_bf16 v[96:111], a[72:75], v[168:171], v[96:111]
    ds_read_b64_tr_b16 a[68:69], v10 offset:16384
    ds_read_b64_tr_b16 a[70:71], v10 offset:16896
    s_waitcnt lgkmcnt(9)
    ds_read_b64_tr_b16 a[210:211], v56 offset:1024
    v_mfma_f32_32x32x16_bf16 v[112:127], a[76:79], v[168:171], v[112:127]
    s_add_u32 m0, s45, 65536
    ds_read_b64_tr_b16 a[72:73], v11 offset:16384
    ds_read_b64_tr_b16 a[74:75], v11 offset:16896
    buffer_load_dwordx4 v7, s[8:11], s34 offen offset:0 lds
    s_waitcnt lgkmcnt(8)
    v_mfma_f32_32x32x16_bf16 v[64:79], a[80:83], v[172:175], v[64:79]
    ds_read_b64_tr_b16 a[76:77], v12 offset:16384
    ds_read_b64_tr_b16 a[78:79], v12 offset:16896
    ds_read_b64_tr_b16 a[212:213], v57 offset:0
    v_mfma_f32_32x32x16_bf16 v[80:95], a[84:87], v[172:175], v[80:95]
    ds_read_b64_tr_b16 a[80:81], v9 offset:20480
    ds_read_b64_tr_b16 a[82:83], v9 offset:20992
    buffer_load_dwordx4 v36, s[8:11], s34 offen offset:1024 lds
    v_mfma_f32_32x32x16_bf16 v[96:111], a[88:91], v[172:175], v[96:111]
    ds_read_b64_tr_b16 a[84:85], v10 offset:20480
    ds_read_b64_tr_b16 a[86:87], v10 offset:20992
    s_waitcnt lgkmcnt(9)
    ds_read_b64_tr_b16 a[214:215], v57 offset:1024
    v_mfma_f32_32x32x16_bf16 v[112:127], a[92:95], v[172:175], v[112:127]
    ds_read_b64_tr_b16 a[88:89], v11 offset:20480
    ds_read_b64_tr_b16 a[90:91], v11 offset:20992
    buffer_load_dwordx4 v8, s[12:15], s34 offen offset:2048 lds
    s_waitcnt lgkmcnt(8)
    v_mfma_f32_32x32x16_bf16 v[64:79], a[64:67], v[176:179], v[64:79]
    ds_read_b64_tr_b16 a[92:93], v12 offset:20480
    ds_read_b64_tr_b16 a[94:95], v12 offset:20992
    ds_read_b64_tr_b16 a[216:217], v15 offset:0
    v_mfma_f32_32x32x16_bf16 v[80:95], a[68:71], v[176:179], v[80:95]
    ds_read_b64_tr_b16 a[64:65], v9 offset:24576
    ds_read_b64_tr_b16 a[66:67], v9 offset:25088
    buffer_load_dwordx4 v37, s[12:15], s34 offen offset:3072 lds
    v_mfma_f32_32x32x16_bf16 v[96:111], a[72:75], v[176:179], v[96:111]
    ds_read_b64_tr_b16 a[68:69], v10 offset:24576
    ds_read_b64_tr_b16 a[70:71], v10 offset:25088
    s_waitcnt lgkmcnt(9)
    ds_read_b64_tr_b16 a[218:219], v15 offset:1024
    v_mfma_f32_32x32x16_bf16 v[112:127], a[76:79], v[176:179], v[112:127]
    s_add_u32 m0, s46, 14336
    ds_read_b64_tr_b16 a[72:73], v11 offset:24576
    ds_read_b64_tr_b16 a[74:75], v11 offset:25088
    buffer_load_dwordx4 v13, s[16:19], s83 offen offset:0 lds
    s_waitcnt lgkmcnt(8)
    v_mfma_f32_32x32x16_bf16 v[64:79], a[80:83], v[180:183], v[64:79]
    ds_read_b64_tr_b16 a[76:77], v12 offset:24576
    ds_read_b64_tr_b16 a[78:79], v12 offset:25088
    ds_read_b64_tr_b16 a[220:221], v35 offset:0
    v_mfma_f32_32x32x16_bf16 v[80:95], a[84:87], v[180:183], v[80:95]
    ds_read_b64_tr_b16 a[80:81], v9 offset:28672
    ds_read_b64_tr_b16 a[82:83], v9 offset:29184
    buffer_load_dwordx4 v14, s[16:19], s83 offen offset:1024 lds
    v_mfma_f32_32x32x16_bf16 v[96:111], a[88:91], v[180:183], v[96:111]
    ds_read_b64_tr_b16 a[84:85], v10 offset:28672
    ds_read_b64_tr_b16 a[86:87], v10 offset:29184
    s_waitcnt lgkmcnt(9)
    ds_read_b64_tr_b16 a[222:223], v35 offset:1024
    v_mfma_f32_32x32x16_bf16 v[112:127], a[92:95], v[180:183], v[112:127]
    s_add_u32 m0, s46, 16384
    ds_read_b64_tr_b16 a[88:89], v11 offset:28672
    ds_read_b64_tr_b16 a[90:91], v11 offset:29184
    buffer_load_dwordx4 v13, s[16:19], s84 offen offset:0 lds
    s_waitcnt lgkmcnt(8)
    v_mfma_f32_32x32x16_bf16 v[64:79], a[64:67], v[184:187], v[64:79]
    ds_read_b64_tr_b16 a[92:93], v12 offset:28672
    ds_read_b64_tr_b16 a[94:95], v12 offset:29184
    ds_read_b64_tr_b16 a[224:225], v56 offset:4096
    v_mfma_f32_32x32x16_bf16 v[80:95], a[68:71], v[184:187], v[80:95]
    s_waitcnt vmcnt(17)
    s_barrier
    ds_read_b64_tr_b16 a[64:65], v9 offset:32768
    ds_read_b64_tr_b16 a[66:67], v9 offset:33280
    v_mfma_f32_32x32x16_bf16 v[96:111], a[72:75], v[184:187], v[96:111]
    ds_read_b64_tr_b16 a[68:69], v10 offset:32768
    ds_read_b64_tr_b16 a[70:71], v10 offset:33280
    s_waitcnt lgkmcnt(9)
    ds_read_b64_tr_b16 a[226:227], v56 offset:5120
    v_mfma_f32_32x32x16_bf16 v[112:127], a[76:79], v[184:187], v[112:127]
    s_add_u32 m0, s45, 0
    ds_read_b64_tr_b16 a[72:73], v11 offset:32768
    ds_read_b64_tr_b16 a[74:75], v11 offset:33280
    buffer_load_dwordx4 v7, s[8:11], s35 offen offset:0 lds
    s_waitcnt lgkmcnt(8)
    v_mfma_f32_32x32x16_bf16 v[64:79], a[80:83], v[188:191], v[64:79]
    ds_read_b64_tr_b16 a[76:77], v12 offset:32768
    ds_read_b64_tr_b16 a[78:79], v12 offset:33280
    ds_read_b64_tr_b16 a[228:229], v57 offset:4096
    v_mfma_f32_32x32x16_bf16 v[80:95], a[84:87], v[188:191], v[80:95]
    ds_read_b64_tr_b16 a[80:81], v9 offset:36864
    ds_read_b64_tr_b16 a[82:83], v9 offset:37376
    buffer_load_dwordx4 v36, s[8:11], s35 offen offset:1024 lds
    v_mfma_f32_32x32x16_bf16 v[96:111], a[88:91], v[188:191], v[96:111]
    ds_read_b64_tr_b16 a[84:85], v10 offset:36864
    ds_read_b64_tr_b16 a[86:87], v10 offset:37376
    s_waitcnt lgkmcnt(9)
    ds_read_b64_tr_b16 a[230:231], v57 offset:5120
    v_mfma_f32_32x32x16_bf16 v[112:127], a[92:95], v[188:191], v[112:127]
    ds_read_b64_tr_b16 a[88:89], v11 offset:36864
    ds_read_b64_tr_b16 a[90:91], v11 offset:37376
    buffer_load_dwordx4 v8, s[12:15], s35 offen offset:2048 lds
    s_waitcnt lgkmcnt(8)
    v_mfma_f32_32x32x16_bf16 v[64:79], a[64:67], v[192:195], v[64:79]
    ds_read_b64_tr_b16 a[92:93], v12 offset:36864
    ds_read_b64_tr_b16 a[94:95], v12 offset:37376
    ds_read_b64_tr_b16 a[232:233], v15 offset:4096
    v_mfma_f32_32x32x16_bf16 v[80:95], a[68:71], v[192:195], v[80:95]
    ds_read_b64_tr_b16 a[64:65], v9 offset:40960
    ds_read_b64_tr_b16 a[66:67], v9 offset:41472
    buffer_load_dwordx4 v37, s[12:15], s35 offen offset:3072 lds
    v_mfma_f32_32x32x16_bf16 v[96:111], a[72:75], v[192:195], v[96:111]
    ds_read_b64_tr_b16 a[68:69], v10 offset:40960
    ds_read_b64_tr_b16 a[70:71], v10 offset:41472
    s_waitcnt lgkmcnt(9)
    ds_read_b64_tr_b16 a[234:235], v15 offset:5120
    v_mfma_f32_32x32x16_bf16 v[112:127], a[76:79], v[192:195], v[112:127]
    s_add_u32 m0, s46, 16384
    ds_read_b64_tr_b16 a[72:73], v11 offset:40960
    ds_read_b64_tr_b16 a[74:75], v11 offset:41472
    buffer_load_dwordx4 v14, s[16:19], s84 offen offset:1024 lds
    s_waitcnt lgkmcnt(8)
    v_mfma_f32_32x32x16_bf16 v[64:79], a[80:83], v[196:199], v[64:79]
    ds_read_b64_tr_b16 a[76:77], v12 offset:40960
    ds_read_b64_tr_b16 a[78:79], v12 offset:41472
    ds_read_b64_tr_b16 a[236:237], v35 offset:4096
    v_mfma_f32_32x32x16_bf16 v[80:95], a[84:87], v[196:199], v[80:95]
    s_add_u32 m0, s46, 18432
    ds_read_b64_tr_b16 a[80:81], v9 offset:45056
    ds_read_b64_tr_b16 a[82:83], v9 offset:45568
    buffer_load_dwordx4 v13, s[16:19], s85 offen offset:0 lds
    v_mfma_f32_32x32x16_bf16 v[96:111], a[88:91], v[196:199], v[96:111]
    ds_read_b64_tr_b16 a[84:85], v10 offset:45056
    ds_read_b64_tr_b16 a[86:87], v10 offset:45568
    s_waitcnt lgkmcnt(9)
    ds_read_b64_tr_b16 a[238:239], v35 offset:5120
    v_mfma_f32_32x32x16_bf16 v[112:127], a[92:95], v[196:199], v[112:127]
    ds_read_b64_tr_b16 a[88:89], v11 offset:45056
    ds_read_b64_tr_b16 a[90:91], v11 offset:45568
    buffer_load_dwordx4 v14, s[16:19], s85 offen offset:1024 lds
    s_waitcnt lgkmcnt(8)
    v_mfma_f32_32x32x16_bf16 v[64:79], a[64:67], v[200:203], v[64:79]
    ds_read_b64_tr_b16 a[92:93], v12 offset:45056
    ds_read_b64_tr_b16 a[94:95], v12 offset:45568
    s_waitcnt vmcnt(16)
    ds_read_b64_tr_b16 a[0:1], v56 offset:8192
    v_mfma_f32_32x32x16_bf16 v[80:95], a[68:71], v[200:203], v[80:95]
    s_barrier
    ds_read_b64_tr_b16 a[64:65], v9 offset:49152
    ds_read_b64_tr_b16 a[66:67], v9 offset:49664
    v_mfma_f32_32x32x16_bf16 v[96:111], a[72:75], v[200:203], v[96:111]
    ds_read_b64_tr_b16 a[68:69], v10 offset:49152
    ds_read_b64_tr_b16 a[70:71], v10 offset:49664
    s_waitcnt lgkmcnt(9)
    ds_read_b64_tr_b16 a[2:3], v56 offset:9216
    v_mfma_f32_32x32x16_bf16 v[112:127], a[76:79], v[200:203], v[112:127]
    s_add_u32 m0, s46, 0
    ds_read_b64_tr_b16 a[72:73], v11 offset:49152
    ds_read_b64_tr_b16 a[74:75], v11 offset:49664
    buffer_load_dwordx4 v13, s[16:19], s86 offen offset:0 lds
    s_waitcnt lgkmcnt(8)
    v_mfma_f32_32x32x16_bf16 v[64:79], a[80:83], v[204:207], v[64:79]
    ds_read_b64_tr_b16 a[76:77], v12 offset:49152
    ds_read_b64_tr_b16 a[78:79], v12 offset:49664
    ds_read_b64_tr_b16 a[4:5], v57 offset:8192
    v_mfma_f32_32x32x16_bf16 v[80:95], a[84:87], v[204:207], v[80:95]
    ds_read_b64_tr_b16 a[80:81], v9 offset:53248
    ds_read_b64_tr_b16 a[82:83], v9 offset:53760
    buffer_load_dwordx4 v14, s[16:19], s86 offen offset:1024 lds
    v_mfma_f32_32x32x16_bf16 v[96:111], a[88:91], v[204:207], v[96:111]
    ds_read_b64_tr_b16 a[84:85], v10 offset:53248
    ds_read_b64_tr_b16 a[86:87], v10 offset:53760
    s_waitcnt lgkmcnt(9)
    ds_read_b64_tr_b16 a[6:7], v57 offset:9216
    v_mfma_f32_32x32x16_bf16 v[112:127], a[92:95], v[204:207], v[112:127]
    s_add_u32 m0, s46, 2048
    ds_read_b64_tr_b16 a[88:89], v11 offset:53248
    ds_read_b64_tr_b16 a[90:91], v11 offset:53760
    buffer_load_dwordx4 v13, s[16:19], s87 offen offset:0 lds
    s_waitcnt lgkmcnt(8)
    v_mfma_f32_32x32x16_bf16 v[64:79], a[64:67], v[208:211], v[64:79]
    ds_read_b64_tr_b16 a[92:93], v12 offset:53248
    ds_read_b64_tr_b16 a[94:95], v12 offset:53760
    ds_read_b64_tr_b16 a[8:9], v15 offset:8192
    v_mfma_f32_32x32x16_bf16 v[80:95], a[68:71], v[208:211], v[80:95]
    ds_read_b64_tr_b16 a[64:65], v9 offset:57344
    ds_read_b64_tr_b16 a[66:67], v9 offset:57856
    buffer_load_dwordx4 v14, s[16:19], s87 offen offset:1024 lds
    v_mfma_f32_32x32x16_bf16 v[96:111], a[72:75], v[208:211], v[96:111]
    ds_read_b64_tr_b16 a[68:69], v10 offset:57344
    ds_read_b64_tr_b16 a[70:71], v10 offset:57856
    s_waitcnt lgkmcnt(9)
    ds_read_b64_tr_b16 a[10:11], v15 offset:9216
    v_mfma_f32_32x32x16_bf16 v[112:127], a[76:79], v[208:211], v[112:127]
    ds_read_b64_tr_b16 a[72:73], v11 offset:57344
    ds_read_b64_tr_b16 a[74:75], v11 offset:57856
    s_waitcnt lgkmcnt(8)
    v_mfma_f32_32x32x16_bf16 v[64:79], a[80:83], v[212:215], v[64:79]
    ds_read_b64_tr_b16 a[76:77], v12 offset:57344
    ds_read_b64_tr_b16 a[78:79], v12 offset:57856
    ds_read_b64_tr_b16 a[12:13], v35 offset:8192
    v_mfma_f32_32x32x16_bf16 v[80:95], a[84:87], v[212:215], v[80:95]
    ds_read_b64_tr_b16 a[80:81], v9 offset:61440
    ds_read_b64_tr_b16 a[82:83], v9 offset:61952
    v_mfma_f32_32x32x16_bf16 v[96:111], a[88:91], v[212:215], v[96:111]
    ds_read_b64_tr_b16 a[84:85], v10 offset:61440
    ds_read_b64_tr_b16 a[86:87], v10 offset:61952
    s_waitcnt lgkmcnt(9)
    ds_read_b64_tr_b16 a[14:15], v35 offset:9216
    v_mfma_f32_32x32x16_bf16 v[112:127], a[92:95], v[212:215], v[112:127]
    ds_read_b64_tr_b16 a[88:89], v11 offset:61440
    ds_read_b64_tr_b16 a[90:91], v11 offset:61952
    s_waitcnt lgkmcnt(8)
    v_mfma_f32_32x32x16_bf16 v[64:79], a[64:67], v[216:219], v[64:79]
    ds_read_b64_tr_b16 a[92:93], v12 offset:61440
    ds_read_b64_tr_b16 a[94:95], v12 offset:61952
    s_waitcnt vmcnt(12)
    ds_read_b64_tr_b16 a[16:17], v56 offset:12288
    v_mfma_f32_32x32x16_bf16 v[80:95], a[68:71], v[216:219], v[80:95]
    s_barrier
    ds_read_b64_tr_b16 a[64:65], v3 offset:0
    ds_read_b64_tr_b16 a[66:67], v3 offset:512
    v_mfma_f32_32x32x16_bf16 v[96:111], a[72:75], v[216:219], v[96:111]
    ds_read_b64_tr_b16 a[68:69], v4 offset:0
    ds_read_b64_tr_b16 a[70:71], v4 offset:512
    s_waitcnt lgkmcnt(9)
    ds_read_b64_tr_b16 a[18:19], v56 offset:13312
    v_mfma_f32_32x32x16_bf16 v[112:127], a[76:79], v[216:219], v[112:127]
    s_add_u32 m0, s46, 4096
    ds_read_b64_tr_b16 a[72:73], v5 offset:0
    ds_read_b64_tr_b16 a[74:75], v5 offset:512
    buffer_load_dwordx4 v13, s[16:19], s88 offen offset:0 lds
    s_waitcnt lgkmcnt(8)
    v_mfma_f32_32x32x16_bf16 v[64:79], a[80:83], v[220:223], v[64:79]
    ds_read_b64_tr_b16 a[76:77], v6 offset:0
    ds_read_b64_tr_b16 a[78:79], v6 offset:512
    ds_read_b64_tr_b16 a[20:21], v57 offset:12288
    v_mfma_f32_32x32x16_bf16 v[80:95], a[84:87], v[220:223], v[80:95]
    ds_read_b64_tr_b16 a[80:81], v3 offset:4096
    ds_read_b64_tr_b16 a[82:83], v3 offset:4608
    buffer_load_dwordx4 v14, s[16:19], s88 offen offset:1024 lds
    v_mfma_f32_32x32x16_bf16 v[96:111], a[88:91], v[220:223], v[96:111]
    ds_read_b64_tr_b16 a[84:85], v4 offset:4096
    ds_read_b64_tr_b16 a[86:87], v4 offset:4608
    s_waitcnt lgkmcnt(9)
    ds_read_b64_tr_b16 a[22:23], v57 offset:13312
    v_mfma_f32_32x32x16_bf16 v[112:127], a[92:95], v[220:223], v[112:127]
    s_add_u32 m0, s46, 6144
    ds_read_b64_tr_b16 a[88:89], v5 offset:4096
    ds_read_b64_tr_b16 a[90:91], v5 offset:4608
    buffer_load_dwordx4 v13, s[16:19], s89 offen offset:0 lds
    s_waitcnt lgkmcnt(8)
    v_mfma_f32_32x32x16_bf16 v[64:79], a[64:67], v[224:227], v[64:79]
    ds_read_b64_tr_b16 a[92:93], v6 offset:4096
    ds_read_b64_tr_b16 a[94:95], v6 offset:4608
    ds_read_b64_tr_b16 a[24:25], v15 offset:12288
    v_mfma_f32_32x32x16_bf16 v[80:95], a[68:71], v[224:227], v[80:95]
    ds_read_b64_tr_b16 a[64:65], v3 offset:8192
    ds_read_b64_tr_b16 a[66:67], v3 offset:8704
    buffer_load_dwordx4 v14, s[16:19], s89 offen offset:1024 lds
    v_mfma_f32_32x32x16_bf16 v[96:111], a[72:75], v[224:227], v[96:111]
    ds_read_b64_tr_b16 a[68:69], v4 offset:8192
    ds_read_b64_tr_b16 a[70:71], v4 offset:8704
    s_waitcnt lgkmcnt(9)
    ds_read_b64_tr_b16 a[26:27], v15 offset:13312
    v_mfma_f32_32x32x16_bf16 v[112:127], a[76:79], v[224:227], v[112:127]
    ds_read_b64_tr_b16 a[72:73], v5 offset:8192
    ds_read_b64_tr_b16 a[74:75], v5 offset:8704
    s_waitcnt lgkmcnt(8)
    v_mfma_f32_32x32x16_bf16 v[64:79], a[80:83], v[228:231], v[64:79]
    ds_read_b64_tr_b16 a[76:77], v6 offset:8192
    ds_read_b64_tr_b16 a[78:79], v6 offset:8704
    buffer_load_dword v63, v59, s[20:23], s61 offen sc1
    ds_read_b64_tr_b16 a[28:29], v35 offset:12288
    v_mfma_f32_32x32x16_bf16 v[80:95], a[84:87], v[228:231], v[80:95]
    ds_read_b64_tr_b16 a[80:81], v3 offset:12288
    ds_read_b64_tr_b16 a[82:83], v3 offset:12800
    v_mfma_f32_32x32x16_bf16 v[96:111], a[88:91], v[228:231], v[96:111]
    ds_read_b64_tr_b16 a[84:85], v4 offset:12288
    ds_read_b64_tr_b16 a[86:87], v4 offset:12800
    s_waitcnt lgkmcnt(9)
    ds_read_b64_tr_b16 a[30:31], v35 offset:13312
    v_mfma_f32_32x32x16_bf16 v[112:127], a[92:95], v[228:231], v[112:127]
    ds_read_b64_tr_b16 a[88:89], v5 offset:12288
    ds_read_b64_tr_b16 a[90:91], v5 offset:12800
    s_waitcnt lgkmcnt(8)
    v_mfma_f32_32x32x16_bf16 v[64:79], a[64:67], v[232:235], v[64:79]
    ds_read_b64_tr_b16 a[92:93], v6 offset:12288
    ds_read_b64_tr_b16 a[94:95], v6 offset:12800
    s_waitcnt vmcnt(9)
    ds_read_b64_tr_b16 a[32:33], v56 offset:16384
    v_mfma_f32_32x32x16_bf16 v[80:95], a[68:71], v[232:235], v[80:95]
    s_barrier
    ds_read_b64_tr_b16 a[64:65], v9 offset:0
    ds_read_b64_tr_b16 a[66:67], v9 offset:512
    v_mfma_f32_32x32x16_bf16 v[96:111], a[72:75], v[232:235], v[96:111]
    ds_read_b64_tr_b16 a[68:69], v10 offset:0
    ds_read_b64_tr_b16 a[70:71], v10 offset:512
    s_waitcnt lgkmcnt(9)
    ds_read_b64_tr_b16 a[34:35], v56 offset:17408
    v_mfma_f32_32x32x16_bf16 v[112:127], a[76:79], v[232:235], v[112:127]
    s_add_u32 m0, s46, 8192
    ds_read_b64_tr_b16 a[72:73], v11 offset:0
    ds_read_b64_tr_b16 a[74:75], v11 offset:512
    buffer_load_dwordx4 v13, s[16:19], s90 offen offset:0 lds
    s_waitcnt lgkmcnt(8)
    v_mfma_f32_32x32x16_bf16 v[64:79], a[80:83], v[236:239], v[64:79]
    ds_read_b64_tr_b16 a[76:77], v12 offset:0
    ds_read_b64_tr_b16 a[78:79], v12 offset:512
    ds_read_b64_tr_b16 a[36:37], v57 offset:16384
    v_mfma_f32_32x32x16_bf16 v[80:95], a[84:87], v[236:239], v[80:95]
    ds_read_b64_tr_b16 a[80:81], v9 offset:4096
    ds_read_b64_tr_b16 a[82:83], v9 offset:4608
    buffer_load_dwordx4 v14, s[16:19], s90 offen offset:1024 lds
    v_mfma_f32_32x32x16_bf16 v[96:111], a[88:91], v[236:239], v[96:111]
    ds_read_b64_tr_b16 a[84:85], v10 offset:4096
    ds_read_b64_tr_b16 a[86:87], v10 offset:4608
    s_waitcnt lgkmcnt(9)
    ds_read_b64_tr_b16 a[38:39], v57 offset:17408
    v_mfma_f32_32x32x16_bf16 v[112:127], a[92:95], v[236:239], v[112:127]
    s_add_u32 m0, s46, 10240
    ds_read_b64_tr_b16 a[88:89], v11 offset:4096
    ds_read_b64_tr_b16 a[90:91], v11 offset:4608
    buffer_load_dwordx4 v13, s[16:19], s91 offen offset:0 lds
    s_waitcnt lgkmcnt(8)
    v_mfma_f32_32x32x16_bf16 v[64:79], a[64:67], v[240:243], v[64:79]
    ds_read_b64_tr_b16 a[92:93], v12 offset:4096
    ds_read_b64_tr_b16 a[94:95], v12 offset:4608
    ds_read_b64_tr_b16 a[40:41], v15 offset:16384
    v_mfma_f32_32x32x16_bf16 v[80:95], a[68:71], v[240:243], v[80:95]
    ds_read_b64_tr_b16 a[64:65], v9 offset:8192
    ds_read_b64_tr_b16 a[66:67], v9 offset:8704
    buffer_load_dwordx4 v14, s[16:19], s91 offen offset:1024 lds
    v_mfma_f32_32x32x16_bf16 v[96:111], a[72:75], v[240:243], v[96:111]
    ds_read_b64_tr_b16 a[68:69], v10 offset:8192
    ds_read_b64_tr_b16 a[70:71], v10 offset:8704
    s_waitcnt lgkmcnt(9)
    ds_read_b64_tr_b16 a[42:43], v15 offset:17408
    ds_read_b64_tr_b16 a[44:45], v35 offset:16384
    ds_read_b64_tr_b16 a[46:47], v35 offset:17408
    s_waitcnt vmcnt(4)
    v_cmp_ne_u32 vcc, s75, v63
    s_cbranch_vccnz L_slow_5
    v_mfma_f32_32x32x16_bf16 v[112:127], a[76:79], v[240:243], v[112:127]
    s_lshr_b32 s98, s80, 4
    s_add_u32 s98, s98, s59
    s_add_u32 m0, s47, 16384
    ds_read_b64_tr_b16 a[72:73], v11 offset:8192
    ds_read_b64_tr_b16 a[74:75], v11 offset:8704
    buffer_load_dwordx4 v62, s[20:23], s98 offen offset:0 sc1 lds
    s_waitcnt lgkmcnt(10)
    v_mfma_f32_32x32x16_bf16 v[64:79], a[80:83], v[244:247], v[64:79]
    ds_read_b64_tr_b16 a[76:77], v12 offset:8192
    ds_read_b64_tr_b16 a[78:79], v12 offset:8704
    buffer_load_dwordx4 v16, s[20:23], s98 offen offset:1024 sc1 lds
    v_mfma_f32_32x32x16_bf16 v[80:95], a[84:87], v[244:247], v[80:95]
    s_lshr_b32 s98, s81, 4
    s_add_u32 s98, s98, s59
    s_add_u32 m0, s47, 18432
    ds_read_b64_tr_b16 a[80:81], v9 offset:12288
    ds_read_b64_tr_b16 a[82:83], v9 offset:12800
    buffer_load_dwordx4 v62, s[20:23], s98 offen offset:0 sc1 lds
    v_mfma_f32_32x32x16_bf16 v[96:111], a[88:91], v[244:247], v[96:111]
    ds_read_b64_tr_b16 a[84:85], v10 offset:12288
    s_waitcnt lgkmcnt(9)
    ds_read_b64_tr_b16 a[86:87], v10 offset:12800
    buffer_load_dwordx4 v16, s[20:23], s98 offen offset:1024 sc1 lds
    v_mfma_f32_32x32x16_bf16 v[112:127], a[92:95], v[244:247], v[112:127]
    s_lshr_b32 s98, s82, 4
    s_add_u32 s98, s98, s59
    s_add_u32 m0, s47, 32768
    ds_read_b64_tr_b16 a[88:89], v11 offset:12288
    ds_read_b64_tr_b16 a[90:91], v11 offset:12800
    buffer_load_dwordx4 v62, s[20:23], s98 offen offset:0 sc1 lds
    s_waitcnt lgkmcnt(6)
    v_mfma_f32_32x32x16_bf16 v[64:79], a[64:67], v[248:251], v[64:79]
    ds_read_b64_tr_b16 a[92:93], v12 offset:12288
    ds_read_b64_tr_b16 a[94:95], v12 offset:12800
    buffer_load_dwordx4 v16, s[20:23], s98 offen offset:1024 sc1 lds
    v_mfma_f32_32x32x16_bf16 v[80:95], a[68:71], v[248:251], v[80:95]
    s_lshr_b32 s98, s83, 4
    s_add_u32 s98, s98, s59
    s_add_u32 m0, s47, 34816
    s_add_u32 s52, s52, 0x1000
    buffer_load_dwordx4 v62, s[20:23], s98 offen offset:0 sc1 lds
    v_mfma_f32_32x32x16_bf16 v[96:111], a[72:75], v[248:251], v[96:111]
    buffer_load_dwordx4 v16, s[20:23], s98 offen offset:1024 sc1 lds
    v_mfma_f32_32x32x16_bf16 v[112:127], a[76:79], v[248:251], v[112:127]
    s_lshr_b32 s98, s84, 4
    s_add_u32 s98, s98, s59
    s_add_u32 m0, s47, 49152
    s_lshl_b32 s53, s69, 8
    buffer_load_dwordx4 v62, s[20:23], s98 offen offset:0 sc1 lds
    s_waitcnt lgkmcnt(0)
    v_mfma_f32_32x32x16_bf16 v[64:79], a[80:83], v[252:255], v[64:79]
    buffer_load_dwordx4 v16, s[20:23], s98 offen offset:1024 sc1 lds
    v_mfma_f32_32x32x16_bf16 v[80:95], a[84:87], v[252:255], v[80:95]
    s_lshr_b32 s98, s85, 4
    s_add_u32 s98, s98, s59
    s_add_u32 m0, s47, 51200
    s_lshl_b32 s94, s70, 3
    buffer_load_dwordx4 v62, s[20:23], s98 offen offset:0 sc1 lds
    v_mfma_f32_32x32x16_bf16 v[96:111], a[88:91], v[252:255], v[96:111]
    buffer_load_dwordx4 v16, s[20:23], s98 offen offset:1024 sc1 lds
    v_mfma_f32_32x32x16_bf16 v[112:127], a[92:95], v[252:255], v[112:127]
    s_add_u32 s53, s53, s94
    s_and_b32 s94, s68, 1
    s_lshl_b32 s94, s94, 2
    s_add_u32 s53, s53, s94
    s_lshr_b32 s94, s68, 1
    s_lshl_b32 s94, s94, 7
    s_add_u32 s53, s53, s94
    s_add_u32 s53, s53, 0x4000
    v_mov_b32 v38, s75
    s_barrier
    s_nop 1
    v_pk_mul_f32 v[64:65], v[64:65], v[20:21]
    v_pk_mul_f32 v[66:67], v[66:67], v[20:21]
    v_pk_mul_f32 v[68:69], v[68:69], v[20:21]
    v_pk_mul_f32 v[70:71], v[70:71], v[20:21]
    v_exp_f32 v64, v64
    v_exp_f32 v65, v65
    v_exp_f32 v66, v66
    v_exp_f32 v67, v67
    v_exp_f32 v68, v68
    v_exp_f32 v69, v69
    v_exp_f32 v70, v70
    v_exp_f32 v71, v71
    v_pk_add_f32 v[64:65], v[64:65], s[64:65]
    v_pk_add_f32 v[66:67], v[66:67], s[64:65]
    v_pk_add_f32 v[68:69], v[68:69], s[64:65]
    v_pk_add_f32 v[70:71], v[70:71], s[64:65]
    v_rcp_f32 v64, v64
    v_rcp_f32 v65, v65
    v_pk_mul_f32 v[72:73], v[72:73], v[18:19]
    v_rcp_f32 v66, v66
    v_rcp_f32 v67, v67
    v_pk_mul_f32 v[74:75], v[74:75], v[18:19]
    v_rcp_f32 v68, v68
    v_rcp_f32 v69, v69
    v_pk_mul_f32 v[76:77], v[76:77], v[18:19]
    v_rcp_f32 v70, v70
    v_rcp_f32 v71, v71
    v_pk_mul_f32 v[78:79], v[78:79], v[18:19]
    v_pk_mul_f32 v[72:73], v[72:73], v[64:65]
    v_pk_mul_f32 v[74:75], v[74:75], v[66:67]
    v_pk_mul_f32 v[76:77], v[76:77], v[68:69]
    v_pk_mul_f32 v[78:79], v[78:79], v[70:71]
    v_cvt_pk_bf16_f32 v40, v72, v73
    v_cvt_pk_bf16_f32 v41, v74, v75
    v_cvt_pk_bf16_f32 v42, v76, v77
    v_cvt_pk_bf16_f32 v43, v78, v79
    buffer_store_dwordx4 v[40:43], v62, s[20:23], s52 offen offset:0 sc1
    v_pk_mul_f32 v[80:81], v[80:81], v[20:21]
    v_pk_mul_f32 v[82:83], v[82:83], v[20:21]
    v_pk_mul_f32 v[84:85], v[84:85], v[20:21]
    v_pk_mul_f32 v[86:87], v[86:87], v[20:21]
    v_exp_f32 v80, v80
    v_exp_f32 v81, v81
    v_exp_f32 v82, v82
    v_exp_f32 v83, v83
    v_exp_f32 v84, v84
    v_exp_f32 v85, v85
    v_exp_f32 v86, v86
    v_exp_f32 v87, v87
    v_pk_add_f32 v[80:81], v[80:81], s[64:65]
    v_pk_add_f32 v[82:83], v[82:83], s[64:65]
    v_pk_add_f32 v[84:85], v[84:85], s[64:65]
    v_pk_add_f32 v[86:87], v[86:87], s[64:65]
    v_rcp_f32 v80, v80
    v_rcp_f32 v81, v81
    v_pk_mul_f32 v[88:89], v[88:89], v[18:19]
    v_rcp_f32 v82, v82
    v_rcp_f32 v83, v83
    v_pk_mul_f32 v[90:91], v[90:91], v[18:19]
    v_rcp_f32 v84, v84
    v_rcp_f32 v85, v85
    v_pk_mul_f32 v[92:93], v[92:93], v[18:19]
    v_rcp_f32 v86, v86
    v_rcp_f32 v87, v87
    v_pk_mul_f32 v[94:95], v[94:95], v[18:19]
    v_pk_mul_f32 v[88:89], v[88:89], v[80:81]
    v_pk_mul_f32 v[90:91], v[90:91], v[82:83]
    v_pk_mul_f32 v[92:93], v[92:93], v[84:85]
    v_pk_mul_f32 v[94:95], v[94:95], v[86:87]
    v_cvt_pk_bf16_f32 v44, v88, v89
    v_cvt_pk_bf16_f32 v45, v90, v91
    v_cvt_pk_bf16_f32 v46, v92, v93
    v_cvt_pk_bf16_f32 v47, v94, v95
    buffer_store_dwordx4 v[44:47], v62, s[20:23], s52 offen offset:1024 sc1
    v_pk_mul_f32 v[96:97], v[96:97], v[20:21]
    v_pk_mul_f32 v[98:99], v[98:99], v[20:21]
    v_pk_mul_f32 v[100:101], v[100:101], v[20:21]
    v_pk_mul_f32 v[102:103], v[102:103], v[20:21]
    v_exp_f32 v96, v96
    v_exp_f32 v97, v97
    v_exp_f32 v98, v98
    v_exp_f32 v99, v99
    v_exp_f32 v100, v100
    v_exp_f32 v101, v101
    v_exp_f32 v102, v102
    v_exp_f32 v103, v103
    v_pk_add_f32 v[96:97], v[96:97], s[64:65]
    v_pk_add_f32 v[98:99], v[98:99], s[64:65]
    v_pk_add_f32 v[100:101], v[100:101], s[64:65]
    v_pk_add_f32 v[102:103], v[102:103], s[64:65]
    v_rcp_f32 v96, v96
    v_rcp_f32 v97, v97
    v_pk_mul_f32 v[104:105], v[104:105], v[18:19]
    v_rcp_f32 v98, v98
    v_rcp_f32 v99, v99
    v_pk_mul_f32 v[106:107], v[106:107], v[18:19]
    v_rcp_f32 v100, v100
    v_rcp_f32 v101, v101
    v_pk_mul_f32 v[108:109], v[108:109], v[18:19]
    v_rcp_f32 v102, v102
    v_rcp_f32 v103, v103
    v_pk_mul_f32 v[110:111], v[110:111], v[18:19]
    v_pk_mul_f32 v[104:105], v[104:105], v[96:97]
    v_pk_mul_f32 v[106:107], v[106:107], v[98:99]
    v_pk_mul_f32 v[108:109], v[108:109], v[100:101]
    v_pk_mul_f32 v[110:111], v[110:111], v[102:103]
    v_cvt_pk_bf16_f32 v40, v104, v105
    v_cvt_pk_bf16_f32 v41, v106, v107
    v_cvt_pk_bf16_f32 v42, v108, v109
    v_cvt_pk_bf16_f32 v43, v110, v111
    buffer_store_dwordx4 v[40:43], v62, s[20:23], s52 offen offset:2048 sc1
    v_pk_mul_f32 v[112:113], v[112:113], v[20:21]
    v_pk_mul_f32 v[114:115], v[114:115], v[20:21]
    v_pk_mul_f32 v[116:117], v[116:117], v[20:21]
    v_pk_mul_f32 v[118:119], v[118:119], v[20:21]
    v_exp_f32 v112, v112
    v_exp_f32 v113, v113
    v_exp_f32 v114, v114
    v_exp_f32 v115, v115
    v_exp_f32 v116, v116
    v_exp_f32 v117, v117
    v_exp_f32 v118, v118
    v_exp_f32 v119, v119
    v_pk_add_f32 v[112:113], v[112:113], s[64:65]
    v_pk_add_f32 v[114:115], v[114:115], s[64:65]
    v_pk_add_f32 v[116:117], v[116:117], s[64:65]
    v_pk_add_f32 v[118:119], v[118:119], s[64:65]
    v_rcp_f32 v112, v112
    v_rcp_f32 v113, v113
    v_pk_mul_f32 v[120:121], v[120:121], v[18:19]
    v_rcp_f32 v114, v114
    v_rcp_f32 v115, v115
    v_pk_mul_f32 v[122:123], v[122:123], v[18:19]
    v_rcp_f32 v116, v116
    v_rcp_f32 v117, v117
    v_pk_mul_f32 v[124:125], v[124:125], v[18:19]
    v_rcp_f32 v118, v118
    v_rcp_f32 v119, v119
    v_pk_mul_f32 v[126:127], v[126:127], v[18:19]
    v_pk_mul_f32 v[120:121], v[120:121], v[112:113]
    v_pk_mul_f32 v[122:123], v[122:123], v[114:115]
    v_pk_mul_f32 v[124:125], v[124:125], v[116:117]
    v_pk_mul_f32 v[126:127], v[126:127], v[118:119]
    v_cvt_pk_bf16_f32 v44, v120, v121
    v_cvt_pk_bf16_f32 v45, v122, v123
    v_cvt_pk_bf16_f32 v46, v124, v125
    v_cvt_pk_bf16_f32 v47, v126, v127
    buffer_store_dwordx4 v[44:47], v62, s[20:23], s52 offen offset:3072 sc1
    s_lshr_b32 s98, s86, 4
    s_add_u32 s98, s98, s59
    s_add_u32 m0, s47, 65536
    s_nop 0
    buffer_load_dwordx4 v62, s[20:23], s98 offen offset:0 sc1 lds
    buffer_load_dwordx4 v16, s[20:23], s98 offen offset:1024 sc1 lds
    s_lshr_b32 s98, s87, 4
    s_add_u32 s98, s98, s59
    s_add_u32 m0, s47, 67584
    s_nop 0
    buffer_load_dwordx4 v62, s[20:23], s98 offen offset:0 sc1 lds
    buffer_load_dwordx4 v16, s[20:23], s98 offen offset:1024 sc1 lds
L_join_6:
    s_waitcnt vmcnt(16)
    ds_read_b128 v[128:131], v58 offset:0
    ds_read_b128 v[132:135], v58 offset:256
    ds_read_b128 v[136:139], v58 offset:1024
    ds_read_b128 v[140:143], v58 offset:1280
    s_waitcnt lgkmcnt(0)
    v_mfma_f32_16x16x32_bf16 v[64:67], a[128:131], v[128:131], 0
    s_lshr_b32 s98, s88, 4
    s_add_u32 s98, s98, s59
    v_mfma_f32_16x16x32_bf16 v[68:71], a[132:135], v[128:131], 0
    v_add_u32 v233, 0x100000, v60
    v_lshrrev_b32 v24, 5, v0
    v_mfma_f32_16x16x32_bf16 v[72:75], a[136:139], v[128:131], 0
    v_lshl_add_u32 v24, v24, 2, v0
    v_lshrrev_b32 v25, 4, v0
    v_mfma_f32_16x16x32_bf16 v[76:79], a[140:143], v[128:131], 0
    v_lshlrev_b32 v25, 8, v25
    s_add_u32 s94, s47, 0x4000
    v_mfma_f32_16x16x32_bf16 v[80:83], a[128:131], v[132:135], 0
    v_add_u32 v25, s94, v25
    v_add_u32 v26, 0, v24
    v_mfma_f32_16x16x32_bf16 v[84:87], a[132:135], v[132:135], 0
    v_and_b32 v26, 15, v26
    v_lshl_add_u32 v225, v26, 4, v25
    s_waitcnt vmcnt(4)
    s_mov_b64 exec, 1
    buffer_store_dword v38, off, s[20:23], s53 sc1
    s_mov_b64 exec, -1
    v_mfma_f32_16x16x32_bf16 v[88:91], a[136:139], v[132:135], 0
    s_add_u32 m0, s47, 16384
    v_add_u32 v26, 8, v24
    v_mfma_f32_16x16x32_bf16 v[92:95], a[140:143], v[132:135], 0
    buffer_load_dwordx4 v62, s[20:23], s98 offen offset:0 sc1 lds
    v_mfma_f32_16x16x32_bf16 v[96:99], a[128:131], v[136:139], 0
    buffer_load_dwordx4 v16, s[20:23], s98 offen offset:1024 sc1 lds
    v_mfma_f32_16x16x32_bf16 v[100:103], a[132:135], v[136:139], 0
    s_lshr_b32 s98, s89, 4
    s_add_u32 s98, s98, s59
    s_add_u32 m0, s47, 18432
    v_mfma_f32_16x16x32_bf16 v[104:107], a[136:139], v[136:139], 0
    buffer_load_dwordx4 v62, s[20:23], s98 offen offset:0 sc1 lds
    v_mfma_f32_16x16x32_bf16 v[108:111], a[140:143], v[136:139], 0
    buffer_load_dwordx4 v16, s[20:23], s98 offen offset:1024 sc1 lds
    v_mfma_f32_16x16x32_bf16 v[112:115], a[128:131], v[140:143], 0
    s_add_u32 m0, s46, 12288
    ds_read_b128 v[144:147], v58 offset:16384
    v_mfma_f32_16x16x32_bf16 v[116:119], a[132:135], v[140:143], 0
    buffer_load_dwordx4 v13, s[16:19], s92 offen offset:0 lds
    v_mfma_f32_16x16x32_bf16 v[120:123], a[136:139], v[140:143], 0
    buffer_load_dwordx4 v14, s[16:19], s92 offen offset:1024 lds
    v_mfma_f32_16x16x32_bf16 v[124:127], a[140:143], v[140:143], 0
    ds_read_b128 v[148:151], v58 offset:16640
    ds_read_b128 v[152:155], v58 offset:17408
    ds_read_b128 v[156:159], v58 offset:17664
    v_and_b32 v26, 15, v26
    v_lshl_add_u32 v226, v26, 4, v25
    v_mad_u32_u24 v216, v2, 0, v1
    v_mad_u32_u24 v217, v2, 1, v1
    v_mad_u32_u24 v218, v2, 2, v1
    v_mad_u32_u24 v219, v2, 3, v1
    v_mad_u32_u24 v220, v2, 8, v1
    v_mad_u32_u24 v221, v2, 9, v1
    v_mad_u32_u24 v222, v2, 10, v1
    v_mad_u32_u24 v223, v2, 11, v1
    s_waitcnt lgkmcnt(0)
    v_mfma_f32_16x16x32_bf16 v[64:67], a[144:147], v[144:147], v[64:67]
    s_lshr_b32 s98, s90, 4
    s_add_u32 s98, s98, s59
    s_add_u32 m0, s47, 32768
    v_mfma_f32_16x16x32_bf16 v[68:71], a[148:151], v[144:147], v[68:71]
    buffer_load_dwordx4 v62, s[20:23], s98 offen offset:0 sc1 lds
    v_mfma_f32_16x16x32_bf16 v[72:75], a[152:155], v[144:147], v[72:75]
    buffer_load_dwordx4 v16, s[20:23], s98 offen offset:1024 sc1 lds
    v_mfma_f32_16x16x32_bf16 v[76:79], a[156:159], v[144:147], v[76:79]
    s_lshr_b32 s98, s91, 4
    s_add_u32 s98, s98, s59
    s_add_u32 m0, s47, 34816
    v_mfma_f32_16x16x32_bf16 v[80:83], a[144:147], v[148:151], v[80:83]
    buffer_load_dwordx4 v62, s[20:23], s98 offen offset:0 sc1 lds
    v_mfma_f32_16x16x32_bf16 v[84:87], a[148:151], v[148:151], v[84:87]
    buffer_load_dwordx4 v16, s[20:23], s98 offen offset:1024 sc1 lds
    v_mfma_f32_16x16x32_bf16 v[88:91], a[152:155], v[148:151], v[88:91]
    s_add_u32 m0, s46, 14336
    ds_read_b64_tr_b16 a[128:129], v56 offset:0
    v_mfma_f32_16x16x32_bf16 v[92:95], a[156:159], v[148:151], v[92:95]
    buffer_load_dwordx4 v13, s[16:19], s93 offen offset:0 lds
    v_mfma_f32_16x16x32_bf16 v[96:99], a[144:147], v[152:155], v[96:99]
    buffer_load_dwordx4 v14, s[16:19], s93 offen offset:1024 lds
    v_mfma_f32_16x16x32_bf16 v[100:103], a[148:151], v[152:155], v[100:103]
    ds_read_b64_tr_b16 a[130:131], v56 offset:1024
    ds_read_b64_tr_b16 a[132:133], v57 offset:0
    v_mfma_f32_16x16x32_bf16 v[104:107], a[152:155], v[152:155], v[104:107]
    ds_read_b64_tr_b16 a[134:135], v57 offset:1024
    ds_read_b64_tr_b16 a[136:137], v15 offset:0
    v_mfma_f32_16x16x32_bf16 v[108:111], a[156:159], v[152:155], v[108:111]
    ds_read_b64_tr_b16 a[138:139], v15 offset:1024
    ds_read_b64_tr_b16 a[140:141], v35 offset:0
    v_mfma_f32_16x16x32_bf16 v[112:115], a[144:147], v[156:159], v[112:115]
    ds_read_b128 v[160:163], v58 offset:32768
    ds_read_b128 v[164:167], v58 offset:33024
    v_mfma_f32_16x16x32_bf16 v[116:119], a[148:151], v[156:159], v[116:119]
    ds_read_b128 v[168:171], v58 offset:33792
    ds_read_b128 v[172:175], v58 offset:34048
    v_mfma_f32_16x16x32_bf16 v[120:123], a[152:155], v[156:159], v[120:123]
    ds_read_b64_tr_b16 a[142:143], v35 offset:1024
    s_lshr_b32 s98, s92, 4
    s_add_u32 s98, s98, s59
    v_mfma_f32_16x16x32_bf16 v[124:127], a[156:159], v[156:159], v[124:127]
    s_waitcnt lgkmcnt(1)
    v_mfma_f32_16x16x32_bf16 v[64:67], a[160:163], v[160:163], v[64:67]
    s_add_u32 m0, s47, 49152
    ds_read_b64_tr_b16 a[144:145], v56 offset:4096
    v_mfma_f32_16x16x32_bf16 v[68:71], a[164:167], v[160:163], v[68:71]
    buffer_load_dwordx4 v62, s[20:23], s98 offen offset:0 sc1 lds
    v_mfma_f32_16x16x32_bf16 v[72:75], a[168:171], v[160:163], v[72:75]
    buffer_load_dwordx4 v16, s[20:23], s98 offen offset:1024 sc1 lds
    v_mfma_f32_16x16x32_bf16 v[76:79], a[172:175], v[160:163], v[76:79]
    s_lshr_b32 s98, s93, 4
    s_add_u32 s98, s98, s59
    s_add_u32 m0, s47, 51200
    v_mfma_f32_16x16x32_bf16 v[80:83], a[160:163], v[164:167], v[80:83]
    buffer_load_dwordx4 v62, s[20:23], s98 offen offset:0 sc1 lds
    v_mfma_f32_16x16x32_bf16 v[84:87], a[164:167], v[164:167], v[84:87]
    buffer_load_dwordx4 v16, s[20:23], s98 offen offset:1024 sc1 lds
    v_mfma_f32_16x16x32_bf16 v[88:91], a[168:171], v[164:167], v[88:91]
    ds_read_b64_tr_b16 a[146:147], v56 offset:5120
    ds_read_b64_tr_b16 a[148:149], v57 offset:4096
    v_mfma_f32_16x16x32_bf16 v[92:95], a[172:175], v[164:167], v[92:95]
    ds_read_b64_tr_b16 a[150:151], v57 offset:5120
    ds_read_b64_tr_b16 a[152:153], v15 offset:4096
    v_mfma_f32_16x16x32_bf16 v[96:99], a[160:163], v[168:171], v[96:99]
    ds_read_b64_tr_b16 a[154:155], v15 offset:5120
    ds_read_b64_tr_b16 a[156:157], v35 offset:4096
    v_mfma_f32_16x16x32_bf16 v[100:103], a[164:167], v[168:171], v[100:103]
    ds_read_b64_tr_b16 a[158:159], v35 offset:5120
    s_add_u32 s59, s59, 0x1000
    s_lshr_b32 s98, s80, 4
    s_add_u32 s98, s98, s59
    v_mfma_f32_16x16x32_bf16 v[104:107], a[168:171], v[168:171], v[104:107]
    v_mfma_f32_16x16x32_bf16 v[108:111], a[172:175], v[168:171], v[108:111]
    v_mfma_f32_16x16x32_bf16 v[112:115], a[160:163], v[172:175], v[112:115]
    s_waitcnt vmcnt(17)
    ds_read_b128 v[128:131], v58 offset:49152
    ds_read_b128 v[132:135], v58 offset:49408
    v_mfma_f32_16x16x32_bf16 v[116:119], a[164:167], v[172:175], v[116:119]
    ds_read_b128 v[136:139], v58 offset:50176
    ds_read_b128 v[140:143], v58 offset:50432
    v_mfma_f32_16x16x32_bf16 v[120:123], a[168:171], v[172:175], v[120:123]
    v_mfma_f32_16x16x32_bf16 v[124:127], a[172:175], v[172:175], v[124:127]
    s_waitcnt lgkmcnt(0)
    v_mfma_f32_16x16x32_bf16 v[64:67], a[176:179], v[128:131], v[64:67]
    ds_read_b64_tr_b16 a[160:161], v56 offset:8192
    ds_read_b64_tr_b16 a[162:163], v56 offset:9216
    v_mfma_f32_16x16x32_bf16 v[68:71], a[180:183], v[128:131], v[68:71]
    ds_read_b64_tr_b16 a[164:165], v57 offset:8192
    ds_read_b64_tr_b16 a[166:167], v57 offset:9216
    v_mfma_f32_16x16x32_bf16 v[72:75], a[184:187], v[128:131], v[72:75]
    ds_read_b64_tr_b16 a[168:169], v15 offset:8192
    ds_read_b64_tr_b16 a[170:171], v15 offset:9216
    v_mfma_f32_16x16x32_bf16 v[76:79], a[188:191], v[128:131], v[76:79]
    ds_read_b64_tr_b16 a[172:173], v35 offset:8192
    ds_read_b64_tr_b16 a[174:175], v35 offset:9216
    v_mfma_f32_16x16x32_bf16 v[80:83], a[176:179], v[132:135], v[80:83]
    v_mfma_f32_16x16x32_bf16 v[84:87], a[180:183], v[132:135], v[84:87]
    v_mfma_f32_16x16x32_bf16 v[88:91], a[184:187], v[132:135], v[88:91]
    v_mfma_f32_16x16x32_bf16 v[92:95], a[188:191], v[132:135], v[92:95]
    v_mfma_f32_16x16x32_bf16 v[96:99], a[176:179], v[136:139], v[96:99]
    s_cmp_lg_u32 s68, 0
    s_cbranch_scc1 L_np_9
    buffer_load_dword v63, v23, s[20:23], 0 offen sc1
L_np_9:
    buffer_load_dwordx4 v[192:195], v60, s[4:7], s48 offen
    buffer_load_dwordx4 v[196:199], v233, s[4:7], s48 offen
    v_mfma_f32_16x16x32_bf16 v[100:103], a[180:183], v[136:139], v[100:103]
    v_mfma_f32_16x16x32_bf16 v[104:107], a[184:187], v[136:139], v[104:107]
    v_mfma_f32_16x16x32_bf16 v[108:111], a[188:191], v[136:139], v[108:111]
    v_mfma_f32_16x16x32_bf16 v[112:115], a[176:179], v[140:143], v[112:115]
    s_waitcnt vmcnt(14)
    ds_read_b128 v[144:147], v58 offset:0
    ds_read_b128 v[148:151], v58 offset:256
    v_mfma_f32_16x16x32_bf16 v[116:119], a[180:183], v[140:143], v[116:119]
    ds_read_b128 v[152:155], v58 offset:1024
    ds_read_b128 v[156:159], v58 offset:1280
    v_mfma_f32_16x16x32_bf16 v[120:123], a[184:187], v[140:143], v[120:123]
    v_mfma_f32_16x16x32_bf16 v[124:127], a[188:191], v[140:143], v[124:127]
    s_waitcnt lgkmcnt(0)
    v_mfma_f32_16x16x32_bf16 v[64:67], a[192:195], v[144:147], v[64:67]
    s_waitcnt vmcnt(6)
    ds_read_b64_tr_b16 a[176:177], v56 offset:12288
    ds_read_b64_tr_b16 a[178:179], v56 offset:13312
    v_mfma_f32_16x16x32_bf16 v[68:71], a[196:199], v[144:147], v[68:71]
    ds_read_b64_tr_b16 a[180:181], v57 offset:12288
    ds_read_b64_tr_b16 a[182:183], v57 offset:13312
    v_mfma_f32_16x16x32_bf16 v[72:75], a[200:203], v[144:147], v[72:75]
    ds_read_b64_tr_b16 a[184:185], v15 offset:12288
    ds_read_b64_tr_b16 a[186:187], v15 offset:13312
    v_mfma_f32_16x16x32_bf16 v[76:79], a[204:207], v[144:147], v[76:79]
    ds_read_b64_tr_b16 a[188:189], v35 offset:12288
    ds_read_b64_tr_b16 a[190:191], v35 offset:13312
    v_mfma_f32_16x16x32_bf16 v[80:83], a[192:195], v[148:151], v[80:83]
    v_mfma_f32_16x16x32_bf16 v[84:87], a[196:199], v[148:151], v[84:87]
    v_mfma_f32_16x16x32_bf16 v[88:91], a[200:203], v[148:151], v[88:91]
    v_mfma_f32_16x16x32_bf16 v[92:95], a[204:207], v[148:151], v[92:95]
    s_cmp_lg_u32 s68, 0
    s_cbranch_scc1 L_pj_10
    s_waitcnt vmcnt(2)
    v_cmp_ne_u32 vcc, s75, v63
    s_cbranch_vccz L_pj_10
    s_mov_b32 s79, 60000
    buffer_load_dword v63, v23, s[20:23], 0 offen sc1
    s_sleep 3
    buffer_load_dword v253, v23, s[20:23], 0 offen sc1
    s_sleep 3
    buffer_load_dword v254, v23, s[20:23], 0 offen sc1
L_pl_11:
    s_waitcnt vmcnt(2)
    v_cmp_ne_u32 vcc, s75, v63
    s_cbranch_vccz L_pj_10
    buffer_load_dword v63, v23, s[20:23], 0 offen sc1
    s_waitcnt vmcnt(2)
    v_cmp_ne_u32 vcc, s75, v253
    s_cbranch_vccz L_pj_10
    buffer_load_dword v253, v23, s[20:23], 0 offen sc1
    s_waitcnt vmcnt(2)
    v_cmp_ne_u32 vcc, s75, v254
    s_cbranch_vccz L_pj_10
    buffer_load_dword v254, v23, s[20:23], 0 offen sc1
    s_sub_u32 s79, s79, 1
    s_cbranch_scc0 L_pl_11
L_pj_10:
    s_barrier
    s_add_u32 m0, s47, 65536
    s_nop 0
    buffer_load_dwordx4 v62, s[20:23], s98 offen offset:0 sc1 lds
    buffer_load_dwordx4 v16, s[20:23], s98 offen offset:1024 sc1 lds
    v_mfma_f32_16x16x32_bf16 v[96:99], a[192:195], v[152:155], v[96:99]
    s_lshr_b32 s98, s81, 4
    s_add_u32 s98, s98, s59
    s_add_u32 m0, s47, 67584
    v_mfma_f32_16x16x32_bf16 v[100:103], a[196:199], v[152:155], v[100:103]
    buffer_load_dwordx4 v62, s[20:23], s98 offen offset:0 sc1 lds
    v_mfma_f32_16x16x32_bf16 v[104:107], a[200:203], v[152:155], v[104:107]
    buffer_load_dwordx4 v16, s[20:23], s98 offen offset:1024 sc1 lds
    v_mfma_f32_16x16x32_bf16 v[108:111], a[204:207], v[152:155], v[108:111]
    s_lshr_b32 s98, s82, 4
    s_add_u32 s98, s98, s59
    s_add_u32 m0, s47, 16384
    v_mfma_f32_16x16x32_bf16 v[112:115], a[192:195], v[156:159], v[112:115]
    buffer_load_dwordx4 v62, s[20:23], s98 offen offset:0 sc1 lds
    v_mfma_f32_16x16x32_bf16 v[116:119], a[196:199], v[156:159], v[116:119]
    buffer_load_dwordx4 v16, s[20:23], s98 offen offset:1024 sc1 lds
    v_mfma_f32_16x16x32_bf16 v[120:123], a[200:203], v[156:159], v[120:123]
    s_lshr_b32 s98, s83, 4
    s_add_u32 s98, s98, s59
    s_add_u32 m0, s47, 18432
    v_mfma_f32_16x16x32_bf16 v[124:127], a[204:207], v[156:159], v[124:127]
    buffer_load_dwordx4 v62, s[20:23], s98 offen offset:0 sc1 lds
    buffer_load_dwordx4 v16, s[20:23], s98 offen offset:1024 sc1 lds
    ds_read_b128 v[160:163], v58 offset:16384
    ds_read_b128 v[164:167], v58 offset:16640
    ds_read_b128 v[168:171], v58 offset:17408
    ds_read_b128 v[172:175], v58 offset:17664
    s_waitcnt lgkmcnt(0)
    v_mfma_f32_16x16x32_bf16 v[64:67], a[208:211], v[160:163], v[64:67]
    s_lshr_b32 s98, s84, 4
    s_add_u32 s98, s98, s59
    s_add_u32 m0, s47, 32768
    v_mfma_f32_16x16x32_bf16 v[68:71], a[212:215], v[160:163], v[68:71]
    buffer_load_dwordx4 v62, s[20:23], s98 offen offset:0 sc1 lds
    v_mfma_f32_16x16x32_bf16 v[72:75], a[216:219], v[160:163], v[72:75]
    buffer_load_dwordx4 v16, s[20:23], s98 offen offset:1024 sc1 lds
    v_mfma_f32_16x16x32_bf16 v[76:79], a[220:223], v[160:163], v[76:79]
    s_lshr_b32 s98, s85, 4
    s_add_u32 s98, s98, s59
    s_add_u32 m0, s47, 34816
    v_mfma_f32_16x16x32_bf16 v[80:83], a[208:211], v[164:167], v[80:83]
    buffer_load_dwordx4 v62, s[20:23], s98 offen offset:0 sc1 lds
    v_mfma_f32_16x16x32_bf16 v[84:87], a[212:215], v[164:167], v[84:87]
    buffer_load_dwordx4 v16, s[20:23], s98 offen offset:1024 sc1 lds
    v_mfma_f32_16x16x32_bf16 v[88:91], a[216:219], v[164:167], v[88:91]
    s_lshr_b32 s98, s86, 4
    s_add_u32 s98, s98, s59
    v_mfma_f32_16x16x32_bf16 v[92:95], a[220:223], v[164:167], v[92:95]
    v_mfma_f32_16x16x32_bf16 v[96:99], a[208:211], v[168:171], v[96:99]
    v_mfma_f32_16x16x32_bf16 v[100:103], a[212:215], v[168:171], v[100:103]
    v_mfma_f32_16x16x32_bf16 v[104:107], a[216:219], v[168:171], v[104:107]
    v_mfma_f32_16x16x32_bf16 v[108:111], a[220:223], v[168:171], v[108:111]
    v_mfma_f32_16x16x32_bf16 v[112:115], a[208:211], v[172:175], v[112:115]
    s_waitcnt vmcnt(14)
    ds_read_b128 v[128:131], v58 offset:32768
    ds_read_b128 v[132:135], v58 offset:33024
    v_mfma_f32_16x16x32_bf16 v[116:119], a[212:215], v[172:175], v[116:119]
    ds_read_b128 v[136:139], v58 offset:33792
    ds_read_b128 v[140:143], v58 offset:34048
    v_mfma_f32_16x16x32_bf16 v[120:123], a[216:219], v[172:175], v[120:123]
    v_mfma_f32_16x16x32_bf16 v[124:127], a[220:223], v[172:175], v[124:127]
    s_cmp_lg_u32 s68, 0
    s_cbranch_scc1 L_np_12
    buffer_load_dword v252, v22, s[20:23], 0 offen sc1
L_np_12:
    s_waitcnt lgkmcnt(0)
    v_mfma_f32_16x16x32_bf16 v[64:67], a[224:227], v[128:131], v[64:67]
    s_add_u32 m0, s47, 49152
    v_mfma_f32_16x16x32_bf16 v[68:71], a[228:231], v[128:131], v[68:71]
    buffer_load_dwordx4 v62, s[20:23], s98 offen offset:0 sc1 lds
    v_mfma_f32_16x16x32_bf16 v[72:75], a[232:235], v[128:131], v[72:75]
    buffer_load_dwordx4 v16, s[20:23], s98 offen offset:1024 sc1 lds
    v_mfma_f32_16x16x32_bf16 v[76:79], a[236:239], v[128:131], v[76:79]
    s_lshr_b32 s98, s87, 4
    s_add_u32 s98, s98, s59
    s_add_u32 m0, s47, 51200
    v_mfma_f32_16x16x32_bf16 v[80:83], a[224:227], v[132:135], v[80:83]
    buffer_load_dwordx4 v62, s[20:23], s98 offen offset:0 sc1 lds
    v_mfma_f32_16x16x32_bf16 v[84:87], a[228:231], v[132:135], v[84:87]
    buffer_load_dwordx4 v16, s[20:23], s98 offen offset:1024 sc1 lds
    v_mfma_f32_16x16x32_bf16 v[88:91], a[232:235], v[132:135], v[88:91]
    s_lshr_b32 s98, s88, 4
    s_add_u32 s98, s98, s59
    v_mfma_f32_16x16x32_bf16 v[92:95], a[236:239], v[132:135], v[92:95]
    v_mfma_f32_16x16x32_bf16 v[96:99], a[224:227], v[136:139], v[96:99]
    v_mfma_f32_16x16x32_bf16 v[100:103], a[228:231], v[136:139], v[100:103]
    v_mfma_f32_16x16x32_bf16 v[104:107], a[232:235], v[136:139], v[104:107]
    v_mfma_f32_16x16x32_bf16 v[108:111], a[236:239], v[136:139], v[108:111]
    v_mfma_f32_16x16x32_bf16 v[112:115], a[224:227], v[140:143], v[112:115]
    s_waitcnt vmcnt(12)
    ds_read_b128 v[144:147], v58 offset:49152
    ds_read_b128 v[148:151], v58 offset:49408
    v_mfma_f32_16x16x32_bf16 v[116:119], a[228:231], v[140:143], v[116:119]
    ds_read_b128 v[152:155], v58 offset:50176
    ds_read_b128 v[156:159], v58 offset:50432
    v_mfma_f32_16x16x32_bf16 v[120:123], a[232:235], v[140:143], v[120:123]
    v_mfma_f32_16x16x32_bf16 v[124:127], a[236:239], v[140:143], v[124:127]
    s_waitcnt lgkmcnt(0)
    v_mfma_f32_16x16x32_bf16 v[64:67], a[0:3], v[144:147], v[64:67]
    s_add_u32 m0, s47, 65536
    v_mfma_f32_16x16x32_bf16 v[68:71], a[4:7], v[144:147], v[68:71]
    buffer_load_dwordx4 v62, s[20:23], s98 offen offset:0 sc1 lds
    v_mfma_f32_16x16x32_bf16 v[72:75], a[8:11], v[144:147], v[72:75]
    buffer_load_dwordx4 v16, s[20:23], s98 offen offset:1024 sc1 lds
    v_mfma_f32_16x16x32_bf16 v[76:79], a[12:15], v[144:147], v[76:79]
    s_lshr_b32 s98, s89, 4
    s_add_u32 s98, s98, s59
    s_add_u32 m0, s47, 67584
    v_mfma_f32_16x16x32_bf16 v[80:83], a[0:3], v[148:151], v[80:83]
    buffer_load_dwordx4 v62, s[20:23], s98 offen offset:0 sc1 lds
    v_mfma_f32_16x16x32_bf16 v[84:87], a[4:7], v[148:151], v[84:87]
    buffer_load_dwordx4 v16, s[20:23], s98 offen offset:1024 sc1 lds
    v_mfma_f32_16x16x32_bf16 v[88:91], a[8:11], v[148:151], v[88:91]
    s_lshr_b32 s98, s90, 4
    s_add_u32 s98, s98, s59
    v_mfma_f32_16x16x32_bf16 v[92:95], a[12:15], v[148:151], v[92:95]
    v_mfma_f32_16x16x32_bf16 v[96:99], a[0:3], v[152:155], v[96:99]
    v_mfma_f32_16x16x32_bf16 v[100:103], a[4:7], v[152:155], v[100:103]
    v_mfma_f32_16x16x32_bf16 v[104:107], a[8:11], v[152:155], v[104:107]
    v_mfma_f32_16x16x32_bf16 v[108:111], a[12:15], v[152:155], v[108:111]
    v_mfma_f32_16x16x32_bf16 v[112:115], a[0:3], v[156:159], v[112:115]
    s_waitcnt vmcnt(12)
    ds_read_b128 v[160:163], v58 offset:0
    ds_read_b128 v[164:167], v58 offset:256
    v_mfma_f32_16x16x32_bf16 v[116:119], a[4:7], v[156:159], v[116:119]
    ds_read_b128 v[168:171], v58 offset:1024
    ds_read_b128 v[172:175], v58 offset:1280
    v_mfma_f32_16x16x32_bf16 v[120:123], a[8:11], v[156:159], v[120:123]
    v_mfma_f32_16x16x32_bf16 v[124:127], a[12:15], v[156:159], v[124:127]
    s_cmp_lg_u32 s68, 0
    s_cbranch_scc1 L_pj_13
    s_waitcnt vmcnt(8)
    v_cmp_ne_u32 vcc, s75, v252
    s_cbranch_vccz L_pj_13
    s_mov_b32 s79, 60000
    buffer_load_dword v252, v22, s[20:23], 0 offen sc1
    s_sleep 12
    buffer_load_dword v253, v22, s[20:23], 0 offen sc1
    s_sleep 12
    buffer_load_dword v254, v22, s[20:23], 0 offen sc1
L_pl_14:
    s_waitcnt vmcnt(2)
    v_cmp_ne_u32 vcc, s75, v252
    s_cbranch_vccz L_pj_13
    buffer_load_dword v252, v22, s[20:23], 0 offen sc1
    s_waitcnt vmcnt(2)
    v_cmp_ne_u32 vcc, s75, v253
    s_cbranch_vccz L_pj_13
    buffer_load_dword v253, v22, s[20:23], 0 offen sc1
    s_waitcnt vmcnt(2)
    v_cmp_ne_u32 vcc, s75, v254
    s_cbranch_vccz L_pj_13
    buffer_load_dword v254, v22, s[20:23], 0 offen sc1
    s_sub_u32 s79, s79, 1
    s_cbranch_scc0 L_pl_14
L_pj_13:
    s_barrier
    s_waitcnt lgkmcnt(0)
    v_mfma_f32_16x16x32_bf16 v[64:67], a[16:19], v[160:163], v[64:67]
    s_add_u32 m0, s47, 16384
    v_mfma_f32_16x16x32_bf16 v[68:71], a[20:23], v[160:163], v[68:71]
    buffer_load_dwordx4 v62, s[20:23], s98 offen offset:0 sc1 lds
    v_mfma_f32_16x16x32_bf16 v[72:75], a[24:27], v[160:163], v[72:75]
    buffer_load_dwordx4 v16, s[20:23], s98 offen offset:1024 sc1 lds
    v_mfma_f32_16x16x32_bf16 v[76:79], a[28:31], v[160:163], v[76:79]
    s_lshr_b32 s98, s91, 4
    s_add_u32 s98, s98, s59
    s_add_u32 m0, s47, 18432
    v_mfma_f32_16x16x32_bf16 v[80:83], a[16:19], v[164:167], v[80:83]
    buffer_load_dwordx4 v62, s[20:23], s98 offen offset:0 sc1 lds
    v_mfma_f32_16x16x32_bf16 v[84:87], a[20:23], v[164:167], v[84:87]
    buffer_load_dwordx4 v16, s[20:23], s98 offen offset:1024 sc1 lds
    v_mfma_f32_16x16x32_bf16 v[88:91], a[24:27], v[164:167], v[88:91]
    s_add_u32 s99, s49, 0x0
    s_mov_b32 m0, s47
    v_mfma_f32_16x16x32_bf16 v[92:95], a[28:31], v[164:167], v[92:95]
    buffer_load_dwordx4 v54, s[20:23], s99 offen offset:0 sc1 lds
    v_mfma_f32_16x16x32_bf16 v[96:99], a[16:19], v[168:171], v[96:99]
    s_add_u32 s99, s49, 0x7fc00
    v_mfma_f32_16x16x32_bf16 v[100:103], a[20:23], v[168:171], v[100:103]
    buffer_load_dwordx4 v54, s[20:23], s99 offen offset:1024 sc1 lds
    v_mfma_f32_16x16x32_bf16 v[104:107], a[24:27], v[168:171], v[104:107]
    s_add_u32 s99, s49, 0xff800
    v_mfma_f32_16x16x32_bf16 v[108:111], a[28:31], v[168:171], v[108:111]
    buffer_load_dwordx4 v54, s[20:23], s99 offen offset:2048 sc1 lds
    v_mfma_f32_16x16x32_bf16 v[112:115], a[16:19], v[172:175], v[112:115]
    s_add_u32 s99, s49, 0x17f400
    s_waitcnt vmcnt(15)
    ds_read_b128 v[128:131], v58 offset:16384
    v_mfma_f32_16x16x32_bf16 v[116:119], a[20:23], v[172:175], v[116:119]
    buffer_load_dwordx4 v54, s[20:23], s99 offen offset:3072 sc1 lds
    v_mfma_f32_16x16x32_bf16 v[120:123], a[24:27], v[172:175], v[120:123]
    s_add_u32 m0, s46, 16384
    ds_read_b128 v[132:135], v58 offset:16640
    v_mfma_f32_16x16x32_bf16 v[124:127], a[28:31], v[172:175], v[124:127]
    s_mov_b64 exec, 0xffff
    buffer_load_dwordx4 v55, s[20:23], s50 offen sc1 lds
    s_mov_b64 exec, -1
    ds_read_b128 v[136:139], v58 offset:17408
    ds_read_b128 v[140:143], v58 offset:17664
    s_waitcnt lgkmcnt(0)
    v_mfma_f32_16x16x32_bf16 v[64:67], a[32:35], v[128:131], v[64:67]
    s_lshr_b32 s98, s92, 4
    s_add_u32 s98, s98, s59
    s_add_u32 m0, s47, 32768
    v_mfma_f32_16x16x32_bf16 v[68:71], a[36:39], v[128:131], v[68:71]
    buffer_load_dwordx4 v62, s[20:23], s98 offen offset:0 sc1 lds
    v_mfma_f32_16x16x32_bf16 v[72:75], a[40:43], v[128:131], v[72:75]
    buffer_load_dwordx4 v16, s[20:23], s98 offen offset:1024 sc1 lds
    v_mfma_f32_16x16x32_bf16 v[76:79], a[44:47], v[128:131], v[76:79]
    s_lshr_b32 s98, s93, 4
    s_add_u32 s98, s98, s59
    s_add_u32 m0, s47, 34816
    v_mfma_f32_16x16x32_bf16 v[80:83], a[32:35], v[132:135], v[80:83]
    buffer_load_dwordx4 v62, s[20:23], s98 offen offset:0 sc1 lds
    v_mfma_f32_16x16x32_bf16 v[84:87], a[36:39], v[132:135], v[84:87]
    buffer_load_dwordx4 v16, s[20:23], s98 offen offset:1024 sc1 lds
    v_mfma_f32_16x16x32_bf16 v[88:91], a[40:43], v[132:135], v[88:91]
    v_lshlrev_b32 v234, 16, v192
    v_and_b32 v235, s76, v192
    v_mfma_f32_16x16x32_bf16 v[92:95], a[44:47], v[132:135], v[92:95]
    v_lshlrev_b32 v236, 16, v193
    v_and_b32 v237, s76, v193
    v_mfma_f32_16x16x32_bf16 v[96:99], a[32:35], v[136:139], v[96:99]
    v_lshlrev_b32 v238, 16, v194
    v_and_b32 v239, s76, v194
    v_mfma_f32_16x16x32_bf16 v[100:103], a[36:39], v[136:139], v[100:103]
    v_lshlrev_b32 v240, 16, v195
    v_and_b32 v241, s76, v195
    v_mfma_f32_16x16x32_bf16 v[104:107], a[40:43], v[136:139], v[104:107]
    v_lshlrev_b32 v242, 16, v196
    v_and_b32 v243, s76, v196
    v_mfma_f32_16x16x32_bf16 v[108:111], a[44:47], v[136:139], v[108:111]
    v_lshlrev_b32 v244, 16, v197
    v_and_b32 v245, s76, v197
    v_mfma_f32_16x16x32_bf16 v[112:115], a[32:35], v[140:143], v[112:115]
    s_waitcnt vmcnt(17)
    ds_read_b128 v[144:147], v58 offset:32768
    ds_read_b128 v[148:151], v58 offset:33024
    v_mfma_f32_16x16x32_bf16 v[116:119], a[36:39], v[140:143], v[116:119]
    ds_read_b128 v[152:155], v58 offset:33792
    ds_read_b128 v[156:159], v58 offset:34048
    v_mfma_f32_16x16x32_bf16 v[120:123], a[40:43], v[140:143], v[120:123]
    v_lshlrev_b32 v246, 16, v198
    v_and_b32 v247, s76, v198
    v_mfma_f32_16x16x32_bf16 v[124:127], a[44:47], v[140:143], v[124:127]
    v_lshlrev_b32 v248, 16, v199
    v_and_b32 v249, s76, v199
    s_waitcnt lgkmcnt(0)
    v_mfma_f32_16x16x32_bf16 v[64:67], a[128:131], v[144:147], v[64:67]
    v_mfma_f32_16x16x32_bf16 v[68:71], a[132:135], v[144:147], v[68:71]
    v_mfma_f32_16x16x32_bf16 v[72:75], a[136:139], v[144:147], v[72:75]
    v_mfma_f32_16x16x32_bf16 v[76:79], a[140:143], v[144:147], v[76:79]
    v_mfma_f32_16x16x32_bf16 v[80:83], a[128:131], v[148:151], v[80:83]
    v_mfma_f32_16x16x32_bf16 v[84:87], a[132:135], v[148:151], v[84:87]
    v_mfma_f32_16x16x32_bf16 v[88:91], a[136:139], v[148:151], v[88:91]
    v_mfma_f32_16x16x32_bf16 v[92:95], a[140:143], v[148:151], v[92:95]
    v_mfma_f32_16x16x32_bf16 v[96:99], a[128:131], v[152:155], v[96:99]
    v_mfma_f32_16x16x32_bf16 v[100:103], a[132:135], v[152:155], v[100:103]
    v_mfma_f32_16x16x32_bf16 v[104:107], a[136:139], v[152:155], v[104:107]
    v_mfma_f32_16x16x32_bf16 v[108:111], a[140:143], v[152:155], v[108:111]
    v_mfma_f32_16x16x32_bf16 v[112:115], a[128:131], v[156:159], v[112:115]
    s_waitcnt vmcnt(13)
    ds_read_b128 v[160:163], v58 offset:49152
    ds_read_b128 v[164:167], v58 offset:49408
    v_mfma_f32_16x16x32_bf16 v[116:119], a[132:135], v[156:159], v[116:119]
    ds_read_b128 v[168:171], v58 offset:50176
    ds_read_b128 v[172:175], v58 offset:50432
    v_mfma_f32_16x16x32_bf16 v[120:123], a[136:139], v[156:159], v[120:123]
    v_mfma_f32_16x16x32_bf16 v[124:127], a[140:143], v[156:159], v[124:127]
    s_waitcnt lgkmcnt(0)
    v_mfma_f32_16x16x32_bf16 v[64:67], a[144:147], v[160:163], v[64:67]
    s_waitcnt vmcnt(4)
    ds_read_b32 v176, v216
    v_mfma_f32_16x16x32_bf16 v[68:71], a[148:151], v[160:163], v[68:71]
    ds_read_b32 v177, v217
    ds_read_b32 v178, v218
    v_mfma_f32_16x16x32_bf16 v[72:75], a[152:155], v[160:163], v[72:75]
    ds_read_b32 v179, v219
    ds_read_b32 v180, v220
    v_mfma_f32_16x16x32_bf16 v[76:79], a[156:159], v[160:163], v[76:79]
    ds_read_b32 v181, v221
    ds_read_b32 v182, v222
    v_mfma_f32_16x16x32_bf16 v[80:83], a[144:147], v[164:167], v[80:83]
    ds_read_b32 v183, v223
    ds_read_b32 v184, v61 offset:0
    v_mfma_f32_16x16x32_bf16 v[84:87], a[148:151], v[164:167], v[84:87]
    ds_read_b32 v185, v61 offset:256
    ds_read_b32 v186, v61 offset:512
    v_mfma_f32_16x16x32_bf16 v[88:91], a[152:155], v[164:167], v[88:91]
    ds_read_b32 v187, v61 offset:768
    ds_read_b32 v188, v61 offset:2048
    v_mfma_f32_16x16x32_bf16 v[92:95], a[156:159], v[164:167], v[92:95]
    ds_read_b32 v189, v61 offset:2304
    ds_read_b32 v190, v61 offset:2560
    v_mfma_f32_16x16x32_bf16 v[96:99], a[144:147], v[168:171], v[96:99]
    s_waitcnt lgkmcnt(9)
    ds_read_b32 v191, v61 offset:2816
    v_mfma_f32_16x16x32_bf16 v[100:103], a[148:151], v[168:171], v[100:103]
    v_mfma_f32_16x16x32_bf16 v[104:107], a[152:155], v[168:171], v[104:107]
    v_mfma_f32_16x16x32_bf16 v[108:111], a[156:159], v[168:171], v[108:111]
    v_mfma_f32_16x16x32_bf16 v[112:115], a[144:147], v[172:175], v[112:115]
    ds_read_b128 v[128:131], v58 offset:0
    ds_read_b128 v[132:135], v58 offset:256
    v_mfma_f32_16x16x32_bf16 v[116:119], a[148:151], v[172:175], v[116:119]
    ds_read_b128 v[136:139], v58 offset:1024
    ds_read_b128 v[140:143], v58 offset:1280
    v_mfma_f32_16x16x32_bf16 v[120:123], a[152:155], v[172:175], v[120:123]
    v_mfma_f32_16x16x32_bf16 v[124:127], a[156:159], v[172:175], v[124:127]
    s_waitcnt lgkmcnt(4)
    v_mfma_f32_32x32x16_bf16 v[200:215], v[176:179], a[240:243], 0
    s_waitcnt vmcnt(0)
    ds_read_b128 v[144:147], v58 offset:16384
    ds_read_b128 v[148:151], v58 offset:16640
    ds_read_b128 v[152:155], v58 offset:17408
    ds_read_b128 v[156:159], v58 offset:17664
    v_mfma_f32_32x32x16_bf16 v[200:215], v[180:183], a[244:247], v[200:215]
    v_mfma_f32_32x32x16_bf16 v[200:215], v[184:187], a[248:251], v[200:215]
    v_mfma_f32_32x32x16_bf16 v[200:215], v[188:191], a[252:255], v[200:215]
    s_waitcnt lgkmcnt(0)
    v_mfma_f32_16x16x32_bf16 v[64:67], a[160:163], v[128:131], v[64:67]
    s_nop 1
    v_mfma_f32_16x16x32_bf16 v[68:71], a[164:167], v[128:131], v[68:71]
    s_nop 1
    v_mfma_f32_16x16x32_bf16 v[72:75], a[168:171], v[128:131], v[72:75]
    s_nop 1
    v_mfma_f32_16x16x32_bf16 v[76:79], a[172:175], v[128:131], v[76:79]
    s_nop 1
    v_mfma_f32_16x16x32_bf16 v[64:67], a[176:179], v[144:147], v[64:67]
    s_nop 1
    v_mfma_f32_16x16x32_bf16 v[68:71], a[180:183], v[144:147], v[68:71]
    s_nop 1
    v_mfma_f32_16x16x32_bf16 v[72:75], a[184:187], v[144:147], v[72:75]
    s_nop 1
    v_mfma_f32_16x16x32_bf16 v[76:79], a[188:191], v[144:147], v[76:79]
    s_nop 1
    v_mfma_f32_16x16x32_bf16 v[80:83], a[160:163], v[132:135], v[80:83]
    s_nop 1
    v_mfma_f32_16x16x32_bf16 v[84:87], a[164:167], v[132:135], v[84:87]
    s_nop 1
    v_mfma_f32_16x16x32_bf16 v[88:91], a[168:171], v[132:135], v[88:91]
    s_nop 1
    v_mfma_f32_16x16x32_bf16 v[92:95], a[172:175], v[132:135], v[92:95]
    ds_write_b128 v52, v[200:203] offset:0
    v_mfma_f32_16x16x32_bf16 v[80:83], a[176:179], v[148:151], v[80:83]
    ds_write_b128 v52, v[204:207] offset:1024
    v_mfma_f32_16x16x32_bf16 v[84:87], a[180:183], v[148:151], v[84:87]
    ds_write_b128 v53, v[208:211] offset:2048
    v_mfma_f32_16x16x32_bf16 v[88:91], a[184:187], v[148:151], v[88:91]
    ds_write_b128 v53, v[212:215] offset:3072
    v_mfma_f32_16x16x32_bf16 v[92:95], a[188:191], v[148:151], v[92:95]
    ds_write_b128 v225, v[64:67] offset:0
    v_mfma_f32_16x16x32_bf16 v[96:99], a[160:163], v[136:139], v[96:99]
    s_nop 1
    v_mfma_f32_16x16x32_bf16 v[100:103], a[164:167], v[136:139], v[100:103]
    s_nop 1
    v_mfma_f32_16x16x32_bf16 v[104:107], a[168:171], v[136:139], v[104:107]
    s_nop 1
    v_mfma_f32_16x16x32_bf16 v[108:111], a[172:175], v[136:139], v[108:111]
    ds_write_b128 v226, v[68:71] offset:1024
    v_mfma_f32_16x16x32_bf16 v[96:99], a[176:179], v[152:155], v[96:99]
    ds_write_b128 v225, v[72:75] offset:2048
    v_mfma_f32_16x16x32_bf16 v[100:103], a[180:183], v[152:155], v[100:103]
    ds_write_b128 v226, v[76:79] offset:3072
    v_mfma_f32_16x16x32_bf16 v[104:107], a[184:187], v[152:155], v[104:107]
    ds_write_b128 v225, v[80:83] offset:16384
    v_mfma_f32_16x16x32_bf16 v[108:111], a[188:191], v[152:155], v[108:111]
    ds_write_b128 v226, v[84:87] offset:17408
    v_mfma_f32_16x16x32_bf16 v[112:115], a[160:163], v[140:143], v[112:115]
    s_nop 1
    v_mfma_f32_16x16x32_bf16 v[116:119], a[164:167], v[140:143], v[116:119]
    s_nop 1
    v_mfma_f32_16x16x32_bf16 v[120:123], a[168:171], v[140:143], v[120:123]
    s_nop 1
    v_mfma_f32_16x16x32_bf16 v[124:127], a[172:175], v[140:143], v[124:127]
    ds_write_b128 v225, v[88:91] offset:18432
    v_mfma_f32_16x16x32_bf16 v[112:115], a[176:179], v[156:159], v[112:115]
    ds_write_b128 v226, v[92:95] offset:19456
    v_mfma_f32_16x16x32_bf16 v[116:119], a[180:183], v[156:159], v[116:119]
    ds_write_b128 v225, v[96:99] offset:32768
    v_mfma_f32_16x16x32_bf16 v[120:123], a[184:187], v[156:159], v[120:123]
    ds_write_b128 v226, v[100:103] offset:33792
    v_mfma_f32_16x16x32_bf16 v[124:127], a[188:191], v[156:159], v[124:127]
    ds_write_b128 v225, v[104:107] offset:34816
    s_nop 3
    s_waitcnt lgkmcnt(9)
    ds_write_b128 v226, v[108:111] offset:35840
    ds_write_b128 v225, v[112:115] offset:49152
    ds_write_b128 v226, v[116:119] offset:50176
    ds_write_b128 v225, v[120:123] offset:51200
    ds_write_b128 v226, v[124:127] offset:52224
    s_waitcnt lgkmcnt(0)
    s_barrier
    ds_read_b128 v[64:67], v48 offset:0
    ds_read_b128 v[68:71], v48 offset:4096
    ds_read_b128 v[72:75], v48 offset:8192
    ds_read_b128 v[76:79], v48 offset:12288
    ds_read_b128 v[128:131], v50 offset:0
    ds_read_b128 v[80:83], v48 offset:256
    ds_read_b128 v[84:87], v48 offset:4352
    ds_read_b128 v[88:91], v48 offset:8448
    ds_read_b128 v[92:95], v48 offset:12544
    ds_read_b128 v[132:135], v50 offset:1024
    ds_read_b128 v[96:99], v49 offset:0
    ds_read_b128 v[100:103], v49 offset:4096
    ds_read_b128 v[104:107], v49 offset:8192
    ds_read_b128 v[108:111], v49 offset:12288
    ds_read_b128 v[136:139], v51 offset:0
    s_waitcnt lgkmcnt(9)
    ds_read_b128 v[112:115], v49 offset:256
    ds_read_b128 v[116:119], v49 offset:4352
    ds_read_b128 v[120:123], v49 offset:8448
    ds_read_b128 v[124:127], v49 offset:12544
    ds_read_b128 v[140:143], v51 offset:1024
    v_pk_add_f32 v[64:65], v[64:65], v[68:69]
    v_pk_add_f32 v[72:73], v[72:73], v[76:77]
    v_pk_add_f32 v[66:67], v[66:67], v[70:71]
    v_pk_add_f32 v[74:75], v[74:75], v[78:79]
    v_pk_add_f32 v[64:65], v[64:65], v[72:73]
    v_pk_add_f32 v[66:67], v[66:67], v[74:75]
    v_pk_mul_f32 v[28:29], v[64:65], s[66:67]
    v_pk_mul_f32 v[30:31], v[66:67], s[66:67]
    v_exp_f32 v28, v28
    v_exp_f32 v29, v29
    v_exp_f32 v30, v30
    v_exp_f32 v31, v31
    v_pk_mul_f32 v[64:65], v[64:65], v[128:129]
    v_pk_mul_f32 v[66:67], v[66:67], v[130:131]
    v_pk_add_f32 v[28:29], v[28:29], s[64:65]
    v_pk_add_f32 v[30:31], v[30:31], s[64:65]
    v_rcp_f32 v28, v28
    v_rcp_f32 v29, v29
    v_rcp_f32 v30, v30
    v_rcp_f32 v31, v31
    s_nop 0
    v_pk_fma_f32 v[64:65], v[64:65], v[28:29], v[234:235]
    v_pk_fma_f32 v[66:67], v[66:67], v[30:31], v[236:237]
    v_cvt_pk_bf16_f32 v144, v64, v65
    v_cvt_pk_bf16_f32 v145, v66, v67
    s_waitcnt lgkmcnt(10)
    v_pk_add_f32 v[80:81], v[80:81], v[84:85]
    v_pk_add_f32 v[88:89], v[88:89], v[92:93]
    v_pk_add_f32 v[82:83], v[82:83], v[86:87]
    v_pk_add_f32 v[90:91], v[90:91], v[94:95]
    v_pk_add_f32 v[80:81], v[80:81], v[88:89]
    v_pk_add_f32 v[82:83], v[82:83], v[90:91]
    v_pk_mul_f32 v[28:29], v[80:81], s[66:67]
    v_pk_mul_f32 v[30:31], v[82:83], s[66:67]
    v_exp_f32 v28, v28
    v_exp_f32 v29, v29
    v_exp_f32 v30, v30
    v_exp_f32 v31, v31
    v_pk_mul_f32 v[80:81], v[80:81], v[132:133]
    v_pk_mul_f32 v[82:83], v[82:83], v[134:135]
    v_pk_add_f32 v[28:29], v[28:29], s[64:65]
    v_pk_add_f32 v[30:31], v[30:31], s[64:65]
    v_rcp_f32 v28, v28
    v_rcp_f32 v29, v29
    v_rcp_f32 v30, v30
    v_rcp_f32 v31, v31
    s_nop 0
    v_pk_fma_f32 v[80:81], v[80:81], v[28:29], v[238:239]
    v_pk_fma_f32 v[82:83], v[82:83], v[30:31], v[240:241]
    v_cvt_pk_bf16_f32 v146, v80, v81
    v_cvt_pk_bf16_f32 v147, v82, v83
    buffer_store_dwordx4 v[144:147], v60, s[24:27], s48 offen sc1
    s_waitcnt lgkmcnt(5)
    v_pk_add_f32 v[96:97], v[96:97], v[100:101]
    v_pk_add_f32 v[104:105], v[104:105], v[108:109]
    v_pk_add_f32 v[98:99], v[98:99], v[102:103]
    v_pk_add_f32 v[106:107], v[106:107], v[110:111]
    v_pk_add_f32 v[96:97], v[96:97], v[104:105]
    v_pk_add_f32 v[98:99], v[98:99], v[106:107]
    v_pk_mul_f32 v[28:29], v[96:97], s[66:67]
    v_pk_mul_f32 v[30:31], v[98:99], s[66:67]
    v_exp_f32 v28, v28
    v_exp_f32 v29, v29
    v_exp_f32 v30, v30
    v_exp_f32 v31, v31
    v_pk_mul_f32 v[96:97], v[96:97], v[136:137]
    v_pk_mul_f32 v[98:99], v[98:99], v[138:139]
    v_pk_add_f32 v[28:29], v[28:29], s[64:65]
    v_pk_add_f32 v[30:31], v[30:31], s[64:65]
    v_rcp_f32 v28, v28
    v_rcp_f32 v29, v29
    v_rcp_f32 v30, v30
    v_rcp_f32 v31, v31
    s_nop 0
    v_pk_fma_f32 v[96:97], v[96:97], v[28:29], v[242:243]
    v_pk_fma_f32 v[98:99], v[98:99], v[30:31], v[244:245]
    v_cvt_pk_bf16_f32 v148, v96, v97
    v_cvt_pk_bf16_f32 v149, v98, v99
    s_waitcnt lgkmcnt(0)
    v_pk_add_f32 v[112:113], v[112:113], v[116:117]
    v_pk_add_f32 v[120:121], v[120:121], v[124:125]
    v_pk_add_f32 v[114:115], v[114:115], v[118:119]
    v_pk_add_f32 v[122:123], v[122:123], v[126:127]
    v_pk_add_f32 v[112:113], v[112:113], v[120:121]
    v_pk_add_f32 v[114:115], v[114:115], v[122:123]
    v_pk_mul_f32 v[28:29], v[112:113], s[66:67]
    v_pk_mul_f32 v[30:31], v[114:115], s[66:67]
    v_exp_f32 v28, v28
    v_exp_f32 v29, v29
    v_exp_f32 v30, v30
    v_exp_f32 v31, v31
    v_pk_mul_f32 v[112:113], v[112:113], v[140:141]
    v_pk_mul_f32 v[114:115], v[114:115], v[142:143]
    v_pk_add_f32 v[28:29], v[28:29], s[64:65]
    v_pk_add_f32 v[30:31], v[30:31], s[64:65]
    v_rcp_f32 v28, v28
    v_rcp_f32 v29, v29
    v_rcp_f32 v30, v30
    v_rcp_f32 v31, v31
    s_nop 0
    v_pk_fma_f32 v[112:113], v[112:113], v[28:29], v[246:247]
    v_pk_fma_f32 v[114:115], v[114:115], v[30:31], v[248:249]
    v_cvt_pk_bf16_f32 v150, v112, v113
    v_cvt_pk_bf16_f32 v151, v114, v115
    buffer_store_dwordx4 v[148:151], v233, s[24:27], s48 offen sc1
    s_endpgm
L_dft:
    s_mov_b32 s8, s50
    s_mov_b32 s9, s51
    s_mov_b32 s10, 0x80000
    s_mov_b32 s11, 0x20000
    s_mov_b32 s12, s52
    s_mov_b32 s13, s53
    s_mov_b32 s14, 0x80000
    s_mov_b32 s15, 0x20000
    s_sub_u32 s51, s70, 14
    v_lshrrev_b32 v24, 3, v0
    v_and_b32 v25, 7, v0
    v_lshrrev_b32 v26, 1, v24
    v_xor_b32 v26, v25, v26
    v_lshlrev_b32 v26, 4, v26
    v_lshl_add_u32 v7, v24, 11, v26
    v_xor_b32 v8, 64, v7
    s_or_b32 s94, s51, s68
    s_cmp_eq_u32 s94, 0
    s_cselect_b32 s94, 0x40000, 0
    s_cselect_b32 s40, 0xff, 0
    s_mov_b32 s41, 0
    s_cmp_eq_u32 s51, 0
    s_cselect_b32 s42, 1, 0
    s_mov_b32 s43, s42
    v_lshlrev_b32 v62, 4, v0
    v_mov_b32 v44, s77
    v_mov_b32 v45, s77
    v_mov_b32 v46, s77
    v_mov_b32 v47, s77
    v_mov_b32 v26, s94
    v_cmp_eq_u32 vcc, 0, v24
    s_lshl_b32 s60, s68, 6
    s_add_u32 s60, s60, s51
    v_cndmask_b32 v26, 0, v26, vcc
    v_add_u32 v36, v26, v7
    s_lshl_b32 s60, s60, 10
    s_lshl_b32 s45, s68, 12
    v_and_b32 v24, 3, v35
    v_lshlrev_b32 v24, 7, v24
    v_add_u32 v24, s60, v24
    s_nop 0
    v_readlane_b32 s28, v24, 0
    v_readlane_b32 s29, v24, 1
    v_readlane_b32 s30, v24, 2
    v_readlane_b32 s31, v24, 3
    s_mov_b32 s44, s101
    s_and_b32 s78, s2, 7
    s_lshl_b32 s78, s78, 1
    s_and_b32 s94, s100, 1
    s_add_u32 s78, s78, s94
    s_bfe_u32 s72, s100, 0x10001
    s_lshr_b32 s73, s100, 2
    s_mov_b32 s95, s73
    s_lshr_b32 s74, s73, 2
    s_mul_i32 s74, s74, 7
    s_and_b32 s94, s2, 7
    s_add_u32 s74, s74, s94
    s_cmp_ge_u32 s74, 14
    s_cselect_b32 s94, 14, 0
    s_sub_u32 s74, s74, s94
    s_mov_b32 s66, 0xbfb8aa3b
    s_mov_b32 s67, 0xbfb8aa3b
    s_mul_i32 s46, s68, 20480
    s_add_u32 s46, s46, 81920
    v_lshlrev_b32 v62, 4, v0
    v_lshrrev_b32 v24, 3, v0
    v_and_b32 v25, 7, v0
    v_and_b32 v26, 6, v24
    v_xor_b32 v25, v25, v26
    v_lshlrev_b32 v25, 4, v25
    v_lshl_add_u32 v13, v24, 10, v25
    v_add_u32 v14, 0x1c00, v13
    v_lshrrev_b32 v24, 5, v0
    v_bfe_u32 v25, v0, 2, 3
    v_lshlrev_b32 v26, 7, v25
    v_lshl_add_u32 v26, v24, 11, v26
    v_lshrrev_b32 v25, 1, v25
    v_lshl_add_u32 v26, v25, 5, v26
    v_and_b32 v25, 3, v0
    v_lshl_add_u32 v26, v25, 3, v26
    v_add_u32 v56, s46, v26
    v_xor_b32 v57, 32, v56
    v_xor_b32 v15, 64, v56
    v_xor_b32 v35, 96, v56
    s_lshl_b32 s94, s69, 1
    s_add_u32 s94, s94, s51
    s_lshl_b32 s95, s94, 2
    s_add_u32 s53, s95, 0x3000
    s_lshl_b32 s94, s94, 7
    s_lshr_b32 s95, s68, 1
    s_lshl_b32 s95, s95, 6
    s_and_b32 s96, s68, 1
    s_add_u32 s32, s95, s96
    s_add_u32 s94, s94, s32
    s_lshl_b32 s94, s94, 9
    s_add_u32 s52, s94, 0x800000
    v_lshrrev_b32 v24, 5, v0
    s_lshl_b32 s94, s68, 11
    v_add_u32 v23, s94, v62
    v_and_b32 v25, 31, v0
    v_lshlrev_b32 v26, 2, v25
    v_lshl_add_u32 v37, v24, 12, v26
    v_lshlrev_b32 v25, 1, v25
    v_add_u32 v25, s32, v25
    v_cvt_f32_u32 v26, v25
    v_cvt_f32_u32 v28, v24
    v_mul_f32 v29, 0x3d800000, v26
    v_mul_f32 v28, 4.0, v28
    v_mul_f32 v30, v28, v29
    v_cvt_f32_u32 v28, s69
    v_mul_f32 v31, 0x3a000000, v26
    v_mul_f32 v32, v28, v31
    v_mul_f32 v31, 0x41800000, v31
    v_cos_f32 v64, v30
    v_sin_f32 v68, v30
    v_add_f32 v30, v30, v29
    v_cos_f32 v65, v30
    v_sin_f32 v69, v30
    v_add_f32 v30, v30, v29
    v_cos_f32 v66, v30
    v_sin_f32 v70, v30
    v_add_f32 v30, v30, v29
    v_cos_f32 v67, v30
    v_sin_f32 v71, v30
    v_add_f32 v30, v30, v29
    v_cos_f32 v72, v32
    v_sin_f32 v73, v32
    v_add_f32 v32, v32, v31
    v_pk_mul_f32 v[74:75], v[64:65], v[72:73] op_sel:[0,0] op_sel_hi:[1,0]
    v_pk_mul_f32 v[78:79], v[64:65], v[72:73] op_sel:[0,1] op_sel_hi:[1,1] neg_lo:[0,1] neg_hi:[0,1]
    v_pk_mul_f32 v[76:77], v[66:67], v[72:73] op_sel:[0,0] op_sel_hi:[1,0]
    v_pk_mul_f32 v[80:81], v[66:67], v[72:73] op_sel:[0,1] op_sel_hi:[1,1] neg_lo:[0,1] neg_hi:[0,1]
    v_pk_fma_f32 v[74:75], v[68:69], v[72:73], v[74:75] op_sel:[0,1,0] op_sel_hi:[1,1,1] neg_lo:[0,1,0] neg_hi:[0,1,0]
    v_pk_fma_f32 v[78:79], v[68:69], v[72:73], v[78:79] op_sel:[0,0,0] op_sel_hi:[1,0,1] neg_lo:[0,1,0] neg_hi:[0,1,0]
    v_pk_fma_f32 v[76:77], v[70:71], v[72:73], v[76:77] op_sel:[0,1,0] op_sel_hi:[1,1,1] neg_lo:[0,1,0] neg_hi:[0,1,0]
    v_pk_fma_f32 v[80:81], v[70:71], v[72:73], v[80:81] op_sel:[0,0,0] op_sel_hi:[1,0,1] neg_lo:[0,1,0] neg_hi:[0,1,0]
    v_cvt_pk_bf16_f32 v82, v74, v75
    v_cvt_pk_bf16_f32 v83, v76, v77
    v_cvt_pk_bf16_f32 v84, v78, v79
    v_cvt_pk_bf16_f32 v85, v80, v81
    v_accvgpr_write_b32 a96, v82
    v_accvgpr_write_b32 a97, v83
    v_accvgpr_write_b32 a208, v84
    v_accvgpr_write_b32 a209, v85
    v_cos_f32 v72, v32
    v_sin_f32 v73, v32
    v_add_f32 v32, v32, v31
    v_pk_mul_f32 v[74:75], v[64:65], v[72:73] op_sel:[0,0] op_sel_hi:[1,0]
    v_pk_mul_f32 v[78:79], v[64:65], v[72:73] op_sel:[0,1] op_sel_hi:[1,1] neg_lo:[0,1] neg_hi:[0,1]
    v_pk_mul_f32 v[76:77], v[66:67], v[72:73] op_sel:[0,0] op_sel_hi:[1,0]
    v_pk_mul_f32 v[80:81], v[66:67], v[72:73] op_sel:[0,1] op_sel_hi:[1,1] neg_lo:[0,1] neg_hi:[0,1]
    v_pk_fma_f32 v[74:75], v[68:69], v[72:73], v[74:75] op_sel:[0,1,0] op_sel_hi:[1,1,1] neg_lo:[0,1,0] neg_hi:[0,1,0]
    v_pk_fma_f32 v[78:79], v[68:69], v[72:73], v[78:79] op_sel:[0,0,0] op_sel_hi:[1,0,1] neg_lo:[0,1,0] neg_hi:[0,1,0]
    v_pk_fma_f32 v[76:77], v[70:71], v[72:73], v[76:77] op_sel:[0,1,0] op_sel_hi:[1,1,1] neg_lo:[0,1,0] neg_hi:[0,1,0]
    v_pk_fma_f32 v[80:81], v[70:71], v[72:73], v[80:81] op_sel:[0,0,0] op_sel_hi:[1,0,1] neg_lo:[0,1,0] neg_hi:[0,1,0]
    v_cvt_pk_bf16_f32 v82, v74, v75
    v_cvt_pk_bf16_f32 v83, v76, v77
    v_cvt_pk_bf16_f32 v84, v78, v79
    v_cvt_pk_bf16_f32 v85, v80, v81
    v_accvgpr_write_b32 a98, v82
    v_accvgpr_write_b32 a99, v83
    v_accvgpr_write_b32 a210, v84
    v_accvgpr_write_b32 a211, v85
    v_cos_f32 v72, v32
    v_sin_f32 v73, v32
    v_add_f32 v32, v32, v31
    v_pk_mul_f32 v[74:75], v[64:65], v[72:73] op_sel:[0,0] op_sel_hi:[1,0]
    v_pk_mul_f32 v[78:79], v[64:65], v[72:73] op_sel:[0,1] op_sel_hi:[1,1] neg_lo:[0,1] neg_hi:[0,1]
    v_pk_mul_f32 v[76:77], v[66:67], v[72:73] op_sel:[0,0] op_sel_hi:[1,0]
    v_pk_mul_f32 v[80:81], v[66:67], v[72:73] op_sel:[0,1] op_sel_hi:[1,1] neg_lo:[0,1] neg_hi:[0,1]
    v_pk_fma_f32 v[74:75], v[68:69], v[72:73], v[74:75] op_sel:[0,1,0] op_sel_hi:[1,1,1] neg_lo:[0,1,0] neg_hi:[0,1,0]
    v_pk_fma_f32 v[78:79], v[68:69], v[72:73], v[78:79] op_sel:[0,0,0] op_sel_hi:[1,0,1] neg_lo:[0,1,0] neg_hi:[0,1,0]
    v_pk_fma_f32 v[76:77], v[70:71], v[72:73], v[76:77] op_sel:[0,1,0] op_sel_hi:[1,1,1] neg_lo:[0,1,0] neg_hi:[0,1,0]
    v_pk_fma_f32 v[80:81], v[70:71], v[72:73], v[80:81] op_sel:[0,0,0] op_sel_hi:[1,0,1] neg_lo:[0,1,0] neg_hi:[0,1,0]
    v_cvt_pk_bf16_f32 v82, v74, v75
    v_cvt_pk_bf16_f32 v83, v76, v77
    v_cvt_pk_bf16_f32 v84, v78, v79
    v_cvt_pk_bf16_f32 v85, v80, v81
    v_accvgpr_write_b32 a100, v82
    v_accvgpr_write_b32 a101, v83
    v_accvgpr_write_b32 a212, v84
    v_accvgpr_write_b32 a213, v85
    v_cos_f32 v72, v32
    v_sin_f32 v73, v32
    v_add_f32 v32, v32, v31
    v_pk_mul_f32 v[74:75], v[64:65], v[72:73] op_sel:[0,0] op_sel_hi:[1,0]
    v_pk_mul_f32 v[78:79], v[64:65], v[72:73] op_sel:[0,1] op_sel_hi:[1,1] neg_lo:[0,1] neg_hi:[0,1]
    v_pk_mul_f32 v[76:77], v[66:67], v[72:73] op_sel:[0,0] op_sel_hi:[1,0]
    v_pk_mul_f32 v[80:81], v[66:67], v[72:73] op_sel:[0,1] op_sel_hi:[1,1] neg_lo:[0,1] neg_hi:[0,1]
    v_pk_fma_f32 v[74:75], v[68:69], v[72:73], v[74:75] op_sel:[0,1,0] op_sel_hi:[1,1,1] neg_lo:[0,1,0] neg_hi:[0,1,0]
    v_pk_fma_f32 v[78:79], v[68:69], v[72:73], v[78:79] op_sel:[0,0,0] op_sel_hi:[1,0,1] neg_lo:[0,1,0] neg_hi:[0,1,0]
    v_pk_fma_f32 v[76:77], v[70:71], v[72:73], v[76:77] op_sel:[0,1,0] op_sel_hi:[1,1,1] neg_lo:[0,1,0] neg_hi:[0,1,0]
    v_pk_fma_f32 v[80:81], v[70:71], v[72:73], v[80:81] op_sel:[0,0,0] op_sel_hi:[1,0,1] neg_lo:[0,1,0] neg_hi:[0,1,0]
    v_cvt_pk_bf16_f32 v82, v74, v75
    v_cvt_pk_bf16_f32 v83, v76, v77
    v_cvt_pk_bf16_f32 v84, v78, v79
    v_cvt_pk_bf16_f32 v85, v80, v81
    v_accvgpr_write_b32 a102, v82
    v_accvgpr_write_b32 a103, v83
    v_accvgpr_write_b32 a214, v84
    v_accvgpr_write_b32 a215, v85
    v_cos_f32 v72, v32
    s_add_u32 m0, s101, 4096
    s_nop 0
    buffer_load_dwordx4 v1, s[4:7], s81 offen offset:0 lds
    buffer_load_dwordx4 v2, s[4:7], s81 offen offset:1024 lds
    buffer_load_dwordx4 v40, s[4:7], s81 offen offset:2048 lds
    buffer_load_dwordx4 v41, s[4:7], s81 offen offset:3072 lds
    s_add_u32 m0, s101, 8192
    s_nop 0
    buffer_load_dwordx4 v1, s[4:7], s82 offen offset:0 lds
    buffer_load_dwordx4 v2, s[4:7], s82 offen offset:1024 lds
    buffer_load_dwordx4 v40, s[4:7], s82 offen offset:2048 lds
    buffer_load_dwordx4 v41, s[4:7], s82 offen offset:3072 lds
    s_add_u32 m0, s101, 12288
    s_nop 0
    buffer_load_dwordx4 v1, s[4:7], s83 offen offset:0 lds
    buffer_load_dwordx4 v2, s[4:7], s83 offen offset:1024 lds
    buffer_load_dwordx4 v40, s[4:7], s83 offen offset:2048 lds
    buffer_load_dwordx4 v41, s[4:7], s83 offen offset:3072 lds
    s_waitcnt vmcnt(12)
    ds_read_b128 v[128:131], v3 offset:0
    ds_read_b128 v[132:135], v4 offset:0
    ds_read_b128 v[136:139], v5 offset:0
    ds_read_b128 v[140:143], v6 offset:0
    v_sin_f32 v73, v32
    v_add_f32 v32, v32, v31
    v_pk_mul_f32 v[74:75], v[64:65], v[72:73] op_sel:[0,0] op_sel_hi:[1,0]
    v_pk_mul_f32 v[78:79], v[64:65], v[72:73] op_sel:[0,1] op_sel_hi:[1,1] neg_lo:[0,1] neg_hi:[0,1]
    v_pk_mul_f32 v[76:77], v[66:67], v[72:73] op_sel:[0,0] op_sel_hi:[1,0]
    v_pk_mul_f32 v[80:81], v[66:67], v[72:73] op_sel:[0,1] op_sel_hi:[1,1] neg_lo:[0,1] neg_hi:[0,1]
    v_pk_fma_f32 v[74:75], v[68:69], v[72:73], v[74:75] op_sel:[0,1,0] op_sel_hi:[1,1,1] neg_lo:[0,1,0] neg_hi:[0,1,0]
    v_pk_fma_f32 v[78:79], v[68:69], v[72:73], v[78:79] op_sel:[0,0,0] op_sel_hi:[1,0,1] neg_lo:[0,1,0] neg_hi:[0,1,0]
    v_pk_fma_f32 v[76:77], v[70:71], v[72:73], v[76:77] op_sel:[0,1,0] op_sel_hi:[1,1,1] neg_lo:[0,1,0] neg_hi:[0,1,0]
    v_pk_fma_f32 v[80:81], v[70:71], v[72:73], v[80:81] op_sel:[0,0,0] op_sel_hi:[1,0,1] neg_lo:[0,1,0] neg_hi:[0,1,0]
    s_waitcnt vmcnt(8)
    ds_read_b128 v[144:147], v3 offset:4096
    ds_read_b128 v[148:151], v4 offset:4096
    ds_read_b128 v[152:155], v5 offset:4096
    ds_read_b128 v[156:159], v6 offset:4096
    s_waitcnt lgkmcnt(4)
    s_add_u32 m0, s101, 16384
    s_nop 0
    buffer_load_dwordx4 v1, s[4:7], s84 offen offset:0 lds
    v_dot2c_f32_bf16 v18, s77, v128
    v_dot2c_f32_bf16 v20, v128, v128
    v_dot2c_f32_bf16 v19, s77, v129
    v_dot2c_f32_bf16 v21, v129, v129
    v_dot2c_f32_bf16 v18, s77, v130
    v_dot2c_f32_bf16 v20, v130, v130
    v_dot2c_f32_bf16 v19, s77, v131
    v_dot2c_f32_bf16 v21, v131, v131
    buffer_load_dwordx4 v2, s[4:7], s84 offen offset:1024 lds
    v_dot2c_f32_bf16 v18, s77, v132
    v_dot2c_f32_bf16 v20, v132, v132
    v_dot2c_f32_bf16 v19, s77, v133
    v_dot2c_f32_bf16 v21, v133, v133
    v_dot2c_f32_bf16 v18, s77, v134
    v_dot2c_f32_bf16 v20, v134, v134
    v_dot2c_f32_bf16 v19, s77, v135
    v_dot2c_f32_bf16 v21, v135, v135
    buffer_load_dwordx4 v40, s[4:7], s84 offen offset:2048 lds
    v_dot2c_f32_bf16 v18, s77, v136
    v_dot2c_f32_bf16 v20, v136, v136
    v_dot2c_f32_bf16 v19, s77, v137
    v_dot2c_f32_bf16 v21, v137, v137
    v_dot2c_f32_bf16 v18, s77, v138
    v_dot2c_f32_bf16 v20, v138, v138
    v_dot2c_f32_bf16 v19, s77, v139
    v_dot2c_f32_bf16 v21, v139, v139
    buffer_load_dwordx4 v41, s[4:7], s84 offen offset:3072 lds
    v_dot2c_f32_bf16 v18, s77, v140
    v_dot2c_f32_bf16 v20, v140, v140
    v_dot2c_f32_bf16 v19, s77, v141
    v_dot2c_f32_bf16 v21, v141, v141
    v_dot2c_f32_bf16 v18, s77, v142
    v_dot2c_f32_bf16 v20, v142, v142
    v_dot2c_f32_bf16 v19, s77, v143
    v_dot2c_f32_bf16 v21, v143, v143
    s_or_b32 s94, s2, s68
    s_cmp_lg_u32 s94, 0
    s_cbranch_scc1 L_notag_15
    s_waitcnt vmcnt(16)
    v_add_u32 v63, 1, v63
    v_max_u32 v63, 1, v63
    buffer_store_dword v63, off, s[20:23], 0 sc1
    buffer_store_dword v63, off, s[36:39], 0 sc1
L_notag_15:
    s_nop 1
    v_cvt_pk_bf16_f32 v82, v74, v75
    v_cvt_pk_bf16_f32 v83, v76, v77
    v_cvt_pk_bf16_f32 v84, v78, v79
    v_cvt_pk_bf16_f32 v85, v80, v81
    v_accvgpr_write_b32 a104, v82
    v_accvgpr_write_b32 a105, v83
    v_accvgpr_write_b32 a216, v84
    v_accvgpr_write_b32 a217, v85
    v_cos_f32 v72, v32
    v_sin_f32 v73, v32
    s_waitcnt vmcnt(8)
    ds_read_b128 v[160:163], v3 offset:8192
    ds_read_b128 v[164:167], v4 offset:8192
    ds_read_b128 v[168:171], v5 offset:8192
    ds_read_b128 v[172:175], v6 offset:8192
    s_waitcnt lgkmcnt(4)
    s_add_u32 m0, s101, 20480
    s_nop 0
    buffer_load_dwordx4 v1, s[4:7], s85 offen offset:0 lds
    v_dot2c_f32_bf16 v18, s77, v144
    v_dot2c_f32_bf16 v20, v144, v144
    v_dot2c_f32_bf16 v19, s77, v145
    v_dot2c_f32_bf16 v21, v145, v145
    v_dot2c_f32_bf16 v18, s77, v146
    v_dot2c_f32_bf16 v20, v146, v146
    v_dot2c_f32_bf16 v19, s77, v147
    v_dot2c_f32_bf16 v21, v147, v147
    buffer_load_dwordx4 v2, s[4:7], s85 offen offset:1024 lds
    v_dot2c_f32_bf16 v18, s77, v148
    v_dot2c_f32_bf16 v20, v148, v148
    v_dot2c_f32_bf16 v19, s77, v149
    v_dot2c_f32_bf16 v21, v149, v149
    v_dot2c_f32_bf16 v18, s77, v150
    v_dot2c_f32_bf16 v20, v150, v150
    v_dot2c_f32_bf16 v19, s77, v151
    v_dot2c_f32_bf16 v21, v151, v151
    buffer_load_dwordx4 v40, s[4:7], s85 offen offset:2048 lds
    v_dot2c_f32_bf16 v18, s77, v152
    v_dot2c_f32_bf16 v20, v152, v152
    v_dot2c_f32_bf16 v19, s77, v153
    v_dot2c_f32_bf16 v21, v153, v153
    v_dot2c_f32_bf16 v18, s77, v154
    v_dot2c_f32_bf16 v20, v154, v154
    v_dot2c_f32_bf16 v19, s77, v155
    v_dot2c_f32_bf16 v21, v155, v155
    buffer_load_dwordx4 v41, s[4:7], s85 offen offset:3072 lds
    v_dot2c_f32_bf16 v18, s77, v156
    v_dot2c_f32_bf16 v20, v156, v156
    v_dot2c_f32_bf16 v19, s77, v157
    v_dot2c_f32_bf16 v21, v157, v157
    v_dot2c_f32_bf16 v18, s77, v158
    v_dot2c_f32_bf16 v20, v158, v158
    v_dot2c_f32_bf16 v19, s77, v159
    v_dot2c_f32_bf16 v21, v159, v159
    s_nop 1
    v_add_f32 v32, v32, v31
    v_pk_mul_f32 v[74:75], v[64:65], v[72:73] op_sel:[0,0] op_sel_hi:[1,0]
    v_pk_mul_f32 v[78:79], v[64:65], v[72:73] op_sel:[0,1] op_sel_hi:[1,1] neg_lo:[0,1] neg_hi:[0,1]
    v_pk_mul_f32 v[76:77], v[66:67], v[72:73] op_sel:[0,0] op_sel_hi:[1,0]
    v_pk_mul_f32 v[80:81], v[66:67], v[72:73] op_sel:[0,1] op_sel_hi:[1,1] neg_lo:[0,1] neg_hi:[0,1]
    v_pk_fma_f32 v[74:75], v[68:69], v[72:73], v[74:75] op_sel:[0,1,0] op_sel_hi:[1,1,1] neg_lo:[0,1,0] neg_hi:[0,1,0]
    v_pk_fma_f32 v[78:79], v[68:69], v[72:73], v[78:79] op_sel:[0,0,0] op_sel_hi:[1,0,1] neg_lo:[0,1,0] neg_hi:[0,1,0]
    v_pk_fma_f32 v[76:77], v[70:71], v[72:73], v[76:77] op_sel:[0,1,0] op_sel_hi:[1,1,1] neg_lo:[0,1,0] neg_hi:[0,1,0]
    v_pk_fma_f32 v[80:81], v[70:71], v[72:73], v[80:81] op_sel:[0,0,0] op_sel_hi:[1,0,1] neg_lo:[0,1,0] neg_hi:[0,1,0]
    v_cvt_pk_bf16_f32 v82, v74, v75
    s_waitcnt vmcnt(8)
    ds_read_b128 v[176:179], v3 offset:12288
    ds_read_b128 v[180:183], v4 offset:12288
    ds_read_b128 v[184:187], v5 offset:12288
    ds_read_b128 v[188:191], v6 offset:12288
    s_waitcnt lgkmcnt(4)
    s_add_u32 m0, s101, 24576
    s_nop 0
    buffer_load_dwordx4 v1, s[4:7], s86 offen offset:0 lds
    v_dot2c_f32_bf16 v18, s77, v160
    v_dot2c_f32_bf16 v20, v160, v160
    v_dot2c_f32_bf16 v19, s77, v161
    v_dot2c_f32_bf16 v21, v161, v161
    v_dot2c_f32_bf16 v18, s77, v162
    v_dot2c_f32_bf16 v20, v162, v162
    v_dot2c_f32_bf16 v19, s77, v163
    v_dot2c_f32_bf16 v21, v163, v163
    buffer_load_dwordx4 v2, s[4:7], s86 offen offset:1024 lds
    v_dot2c_f32_bf16 v18, s77, v164
    v_dot2c_f32_bf16 v20, v164, v164
    v_dot2c_f32_bf16 v19, s77, v165
    v_dot2c_f32_bf16 v21, v165, v165
    v_dot2c_f32_bf16 v18, s77, v166
    v_dot2c_f32_bf16 v20, v166, v166
    v_dot2c_f32_bf16 v19, s77, v167
    v_dot2c_f32_bf16 v21, v167, v167
    buffer_load_dwordx4 v40, s[4:7], s86 offen offset:2048 lds
    v_dot2c_f32_bf16 v18, s77, v168
    v_dot2c_f32_bf16 v20, v168, v168
    v_dot2c_f32_bf16 v19, s77, v169
    v_dot2c_f32_bf16 v21, v169, v169
    v_dot2c_f32_bf16 v18, s77, v170
    v_dot2c_f32_bf16 v20, v170, v170
    v_dot2c_f32_bf16 v19, s77, v171
    v_dot2c_f32_bf16 v21, v171, v171
    buffer_load_dwordx4 v41, s[4:7], s86 offen offset:3072 lds
    v_dot2c_f32_bf16 v18, s77, v172
    v_dot2c_f32_bf16 v20, v172, v172
    v_dot2c_f32_bf16 v19, s77, v173
    v_dot2c_f32_bf16 v21, v173, v173
    v_dot2c_f32_bf16 v18, s77, v174
    v_dot2c_f32_bf16 v20, v174, v174
    v_dot2c_f32_bf16 v19, s77, v175
    v_dot2c_f32_bf16 v21, v175, v175
    s_nop 1
    v_cvt_pk_bf16_f32 v83, v76, v77
    v_cvt_pk_bf16_f32 v84, v78, v79
    v_cvt_pk_bf16_f32 v85, v80, v81
    v_accvgpr_write_b32 a106, v82
    v_accvgpr_write_b32 a107, v83
    v_accvgpr_write_b32 a218, v84
    v_accvgpr_write_b32 a219, v85
    v_cos_f32 v72, v32
    v_sin_f32 v73, v32
    s_waitcnt vmcnt(8)
    ds_read_b128 v[192:195], v3 offset:16384
    ds_read_b128 v[196:199], v4 offset:16384
    ds_read_b128 v[200:203], v5 offset:16384
    ds_read_b128 v[204:207], v6 offset:16384
    s_waitcnt lgkmcnt(4)
    s_add_u32 m0, s101, 28672
    s_nop 0
    buffer_load_dwordx4 v1, s[4:7], s87 offen offset:0 lds
    v_dot2c_f32_bf16 v18, s77, v176
    v_dot2c_f32_bf16 v20, v176, v176
    v_dot2c_f32_bf16 v19, s77, v177
    v_dot2c_f32_bf16 v21, v177, v177
    v_dot2c_f32_bf16 v18, s77, v178
    v_dot2c_f32_bf16 v20, v178, v178
    v_dot2c_f32_bf16 v19, s77, v179
    v_dot2c_f32_bf16 v21, v179, v179
    buffer_load_dwordx4 v2, s[4:7], s87 offen offset:1024 lds
    v_dot2c_f32_bf16 v18, s77, v180
    v_dot2c_f32_bf16 v20, v180, v180
    v_dot2c_f32_bf16 v19, s77, v181
    v_dot2c_f32_bf16 v21, v181, v181
    v_dot2c_f32_bf16 v18, s77, v182
    v_dot2c_f32_bf16 v20, v182, v182
    v_dot2c_f32_bf16 v19, s77, v183
    v_dot2c_f32_bf16 v21, v183, v183
    buffer_load_dwordx4 v40, s[4:7], s87 offen offset:2048 lds
    v_dot2c_f32_bf16 v18, s77, v184
    v_dot2c_f32_bf16 v20, v184, v184
    v_dot2c_f32_bf16 v19, s77, v185
    v_dot2c_f32_bf16 v21, v185, v185
    v_dot2c_f32_bf16 v18, s77, v186
    v_dot2c_f32_bf16 v20, v186, v186
    v_dot2c_f32_bf16 v19, s77, v187
    v_dot2c_f32_bf16 v21, v187, v187
    buffer_load_dwordx4 v41, s[4:7], s87 offen offset:3072 lds
    v_dot2c_f32_bf16 v18, s77, v188
    v_dot2c_f32_bf16 v20, v188, v188
    v_dot2c_f32_bf16 v19, s77, v189
    v_dot2c_f32_bf16 v21, v189, v189
    v_dot2c_f32_bf16 v18, s77, v190
    v_dot2c_f32_bf16 v20, v190, v190
    v_dot2c_f32_bf16 v19, s77, v191
    v_dot2c_f32_bf16 v21, v191, v191
    s_nop 1
    v_add_f32 v32, v32, v31
    v_pk_mul_f32 v[74:75], v[64:65], v[72:73] op_sel:[0,0] op_sel_hi:[1,0]
    v_pk_mul_f32 v[78:79], v[64:65], v[72:73] op_sel:[0,1] op_sel_hi:[1,1] neg_lo:[0,1] neg_hi:[0,1]
    v_pk_mul_f32 v[76:77], v[66:67], v[72:73] op_sel:[0,0] op_sel_hi:[1,0]
    v_pk_mul_f32 v[80:81], v[66:67], v[72:73] op_sel:[0,1] op_sel_hi:[1,1] neg_lo:[0,1] neg_hi:[0,1]
    v_pk_fma_f32 v[74:75], v[68:69], v[72:73], v[74:75] op_sel:[0,1,0] op_sel_hi:[1,1,1] neg_lo:[0,1,0] neg_hi:[0,1,0]
    v_pk_fma_f32 v[78:79], v[68:69], v[72:73], v[78:79] op_sel:[0,0,0] op_sel_hi:[1,0,1] neg_lo:[0,1,0] neg_hi:[0,1,0]
    v_pk_fma_f32 v[76:77], v[70:71], v[72:73], v[76:77] op_sel:[0,1,0] op_sel_hi:[1,1,1] neg_lo:[0,1,0] neg_hi:[0,1,0]
    v_pk_fma_f32 v[80:81], v[70:71], v[72:73], v[80:81] op_sel:[0,0,0] op_sel_hi:[1,0,1] neg_lo:[0,1,0] neg_hi:[0,1,0]
    s_waitcnt vmcnt(8)
    ds_read_b128 v[208:211], v3 offset:20480
    ds_read_b128 v[212:215], v4 offset:20480
    ds_read_b128 v[216:219], v5 offset:20480
    ds_read_b128 v[220:223], v6 offset:20480
    s_waitcnt lgkmcnt(4)
    s_add_u32 m0, s45, 0
    s_nop 0
    buffer_load_dwordx4 v36, s[8:11], s28 offen offset:0 lds
    v_dot2c_f32_bf16 v18, s77, v192
    v_dot2c_f32_bf16 v20, v192, v192
    v_dot2c_f32_bf16 v19, s77, v193
    v_dot2c_f32_bf16 v21, v193, v193
    v_dot2c_f32_bf16 v18, s77, v194
    v_dot2c_f32_bf16 v20, v194, v194
    v_dot2c_f32_bf16 v19, s77, v195
    v_dot2c_f32_bf16 v21, v195, v195
    s_add_u32 s99, s28, 15360
    buffer_load_dwordx4 v8, s[8:11], s99 offen offset:1024 lds
    v_dot2c_f32_bf16 v18, s77, v196
    v_dot2c_f32_bf16 v20, v196, v196
    v_dot2c_f32_bf16 v19, s77, v197
    v_dot2c_f32_bf16 v21, v197, v197
    v_dot2c_f32_bf16 v18, s77, v198
    v_dot2c_f32_bf16 v20, v198, v198
    v_dot2c_f32_bf16 v19, s77, v199
    v_dot2c_f32_bf16 v21, v199, v199
    s_add_u32 s99, s28, 30720
    buffer_load_dwordx4 v7, s[8:11], s99 offen offset:2048 lds
    v_dot2c_f32_bf16 v18, s77, v200
    v_dot2c_f32_bf16 v20, v200, v200
    v_dot2c_f32_bf16 v19, s77, v201
    v_dot2c_f32_bf16 v21, v201, v201
    v_dot2c_f32_bf16 v18, s77, v202
    v_dot2c_f32_bf16 v20, v202, v202
    v_dot2c_f32_bf16 v19, s77, v203
    v_dot2c_f32_bf16 v21, v203, v203
    s_add_u32 s99, s28, 46080
    buffer_load_dwordx4 v8, s[8:11], s99 offen offset:3072 lds
    v_dot2c_f32_bf16 v18, s77, v204
    v_dot2c_f32_bf16 v20, v204, v204
    v_dot2c_f32_bf16 v19, s77, v205
    v_dot2c_f32_bf16 v21, v205, v205
    v_dot2c_f32_bf16 v18, s77, v206
    v_dot2c_f32_bf16 v20, v206, v206
    v_dot2c_f32_bf16 v19, s77, v207
    v_dot2c_f32_bf16 v21, v207, v207
    s_nop 1
    v_cvt_pk_bf16_f32 v82, v74, v75
    v_cvt_pk_bf16_f32 v83, v76, v77
    v_cvt_pk_bf16_f32 v84, v78, v79
    v_cvt_pk_bf16_f32 v85, v80, v81
    v_accvgpr_write_b32 a108, v82
    v_accvgpr_write_b32 a109, v83
    v_accvgpr_write_b32 a220, v84
    v_accvgpr_write_b32 a221, v85
    v_cos_f32 v72, v32
    s_waitcnt vmcnt(8)
    ds_read_b128 v[224:227], v3 offset:24576
    ds_read_b128 v[228:231], v4 offset:24576
    ds_read_b128 v[232:235], v5 offset:24576
    ds_read_b128 v[236:239], v6 offset:24576
    s_waitcnt lgkmcnt(4)
    s_add_u32 m0, s45, 16384
    s_nop 0
    s_mov_b64 exec, s[40:41]
    ds_write_b128 v62, v[44:47] offset:16384
    s_not_b64 exec, exec
    buffer_load_dwordx4 v36, s[12:15], s28 offen offset:0 lds
    s_mov_b64 exec, -1
    v_dot2c_f32_bf16 v18, s77, v208
    v_dot2c_f32_bf16 v20, v208, v208
    v_dot2c_f32_bf16 v19, s77, v209
    v_dot2c_f32_bf16 v21, v209, v209
    v_dot2c_f32_bf16 v18, s77, v210
    v_dot2c_f32_bf16 v20, v210, v210
    v_dot2c_f32_bf16 v19, s77, v211
    v_dot2c_f32_bf16 v21, v211, v211
    s_add_u32 s99, s28, 15360
    buffer_load_dwordx4 v8, s[12:15], s99 offen offset:1024 lds
    v_dot2c_f32_bf16 v18, s77, v212
    v_dot2c_f32_bf16 v20, v212, v212
    v_dot2c_f32_bf16 v19, s77, v213
    v_dot2c_f32_bf16 v21, v213, v213
    v_dot2c_f32_bf16 v18, s77, v214
    v_dot2c_f32_bf16 v20, v214, v214
    v_dot2c_f32_bf16 v19, s77, v215
    v_dot2c_f32_bf16 v21, v215, v215
    s_add_u32 s99, s28, 30720
    buffer_load_dwordx4 v7, s[12:15], s99 offen offset:2048 lds
    v_dot2c_f32_bf16 v18, s77, v216
    v_dot2c_f32_bf16 v20, v216, v216
    v_dot2c_f32_bf16 v19, s77, v217
    v_dot2c_f32_bf16 v21, v217, v217
    v_dot2c_f32_bf16 v18, s77, v218
    v_dot2c_f32_bf16 v20, v218, v218
    v_dot2c_f32_bf16 v19, s77, v219
    v_dot2c_f32_bf16 v21, v219, v219
    s_add_u32 s99, s28, 46080
    buffer_load_dwordx4 v8, s[12:15], s99 offen offset:3072 lds
    v_dot2c_f32_bf16 v18, s77, v220
    v_dot2c_f32_bf16 v20, v220, v220
    v_dot2c_f32_bf16 v19, s77, v221
    v_dot2c_f32_bf16 v21, v221, v221
    v_dot2c_f32_bf16 v18, s77, v222
    v_dot2c_f32_bf16 v20, v222, v222
    v_dot2c_f32_bf16 v19, s77, v223
    v_dot2c_f32_bf16 v21, v223, v223
    s_nop 1
    v_sin_f32 v73, v32
    v_add_f32 v32, v32, v31
    v_pk_mul_f32 v[74:75], v[64:65], v[72:73] op_sel:[0,0] op_sel_hi:[1,0]
    v_pk_mul_f32 v[78:79], v[64:65], v[72:73] op_sel:[0,1] op_sel_hi:[1,1] neg_lo:[0,1] neg_hi:[0,1]
    v_pk_mul_f32 v[76:77], v[66:67], v[72:73] op_sel:[0,0] op_sel_hi:[1,0]
    v_pk_mul_f32 v[80:81], v[66:67], v[72:73] op_sel:[0,1] op_sel_hi:[1,1] neg_lo:[0,1] neg_hi:[0,1]
    v_pk_fma_f32 v[74:75], v[68:69], v[72:73], v[74:75] op_sel:[0,1,0] op_sel_hi:[1,1,1] neg_lo:[0,1,0] neg_hi:[0,1,0]
    v_pk_fma_f32 v[78:79], v[68:69], v[72:73], v[78:79] op_sel:[0,0,0] op_sel_hi:[1,0,1] neg_lo:[0,1,0] neg_hi:[0,1,0]
    v_pk_fma_f32 v[76:77], v[70:71], v[72:73], v[76:77] op_sel:[0,1,0] op_sel_hi:[1,1,1] neg_lo:[0,1,0] neg_hi:[0,1,0]
    s_waitcnt lgkmcnt(1)
    v_dot2c_f32_bf16 v18, s77, v224
    v_dot2c_f32_bf16 v20, v224, v224
    v_dot2c_f32_bf16 v19, s77, v225
    v_dot2c_f32_bf16 v21, v225, v225
    v_dot2c_f32_bf16 v18, s77, v226
    v_dot2c_f32_bf16 v20, v226, v226
    v_dot2c_f32_bf16 v19, s77, v227
    v_dot2c_f32_bf16 v21, v227, v227
    v_dot2c_f32_bf16 v18, s77, v228
    v_dot2c_f32_bf16 v20, v228, v228
    v_dot2c_f32_bf16 v19, s77, v229
    v_dot2c_f32_bf16 v21, v229, v229
    v_dot2c_f32_bf16 v18, s77, v230
    v_dot2c_f32_bf16 v20, v230, v230
    v_dot2c_f32_bf16 v19, s77, v231
    v_dot2c_f32_bf16 v21, v231, v231
    v_dot2c_f32_bf16 v18, s77, v232
    v_dot2c_f32_bf16 v20, v232, v232
    v_dot2c_f32_bf16 v19, s77, v233
    v_dot2c_f32_bf16 v21, v233, v233
    v_dot2c_f32_bf16 v18, s77, v234
    v_dot2c_f32_bf16 v20, v234, v234
    v_dot2c_f32_bf16 v19, s77, v235
    v_dot2c_f32_bf16 v21, v235, v235
    v_dot2c_f32_bf16 v18, s77, v236
    v_dot2c_f32_bf16 v20, v236, v236
    v_dot2c_f32_bf16 v19, s77, v237
    v_dot2c_f32_bf16 v21, v237, v237
    v_dot2c_f32_bf16 v18, s77, v238
    v_dot2c_f32_bf16 v20, v238, v238
    v_dot2c_f32_bf16 v19, s77, v239
    v_dot2c_f32_bf16 v21, v239, v239
    s_waitcnt vmcnt(8)
    ds_read_b128 v[240:243], v3 offset:28672
    ds_read_b128 v[244:247], v4 offset:28672
    ds_read_b128 v[248:251], v5 offset:28672
    ds_read_b128 v[252:255], v6 offset:28672
    s_nop 1
    v_pk_fma_f32 v[80:81], v[70:71], v[72:73], v[80:81] op_sel:[0,0,0] op_sel_hi:[1,0,1] neg_lo:[0,1,0] neg_hi:[0,1,0]
    v_cvt_pk_bf16_f32 v82, v74, v75
    v_cvt_pk_bf16_f32 v83, v76, v77
    v_cvt_pk_bf16_f32 v84, v78, v79
    v_cvt_pk_bf16_f32 v85, v80, v81
    v_accvgpr_write_b32 a110, v82
    v_accvgpr_write_b32 a111, v83
    v_accvgpr_write_b32 a222, v84
    v_accvgpr_write_b32 a223, v85
    s_waitcnt lgkmcnt(0)
    v_dot2c_f32_bf16 v18, s77, v240
    v_dot2c_f32_bf16 v20, v240, v240
    v_dot2c_f32_bf16 v19, s77, v241
    v_dot2c_f32_bf16 v21, v241, v241
    v_dot2c_f32_bf16 v18, s77, v242
    v_dot2c_f32_bf16 v20, v242, v242
    v_dot2c_f32_bf16 v19, s77, v243
    v_dot2c_f32_bf16 v21, v243, v243
    v_dot2c_f32_bf16 v18, s77, v244
    v_dot2c_f32_bf16 v20, v244, v244
    v_dot2c_f32_bf16 v19, s77, v245
    v_dot2c_f32_bf16 v21, v245, v245
    v_dot2c_f32_bf16 v18, s77, v246
    v_dot2c_f32_bf16 v20, v246, v246
    v_dot2c_f32_bf16 v19, s77, v247
    v_dot2c_f32_bf16 v21, v247, v247
    v_dot2c_f32_bf16 v18, s77, v248
    v_dot2c_f32_bf16 v20, v248, v248
    v_dot2c_f32_bf16 v19, s77, v249
    v_dot2c_f32_bf16 v21, v249, v249
    v_dot2c_f32_bf16 v18, s77, v250
    v_dot2c_f32_bf16 v20, v250, v250
    v_dot2c_f32_bf16 v19, s77, v251
    v_dot2c_f32_bf16 v21, v251, v251
    v_dot2c_f32_bf16 v18, s77, v252
    v_dot2c_f32_bf16 v20, v252, v252
    v_dot2c_f32_bf16 v19, s77, v253
    v_dot2c_f32_bf16 v21, v253, v253
    v_dot2c_f32_bf16 v18, s77, v254
    v_dot2c_f32_bf16 v20, v254, v254
    v_dot2c_f32_bf16 v19, s77, v255
    v_dot2c_f32_bf16 v21, v255, v255
    s_nop 2
    v_add_f32 v24, v18, v19
    v_add_f32 v26, v20, v21
    v_mov_b32 v25, v24
    v_mov_b32 v27, v26
    s_nop 1
    v_permlane32_swap_b32 v24, v25
    v_permlane32_swap_b32 v26, v27
    v_add_f32 v24, v24, v25
    v_add_f32 v26, v26, v27
    v_mul_f32 v24, 0x3b000000, v24
    v_mul_f32 v26, 0x3b000000, v26
    v_cvt_pk_bf16_f32 v25, v24, v24
    v_fma_f32 v26, -v24, v24, v26
    v_lshlrev_b32 v17, 16, v25
    v_max_f32 v26, 0, v26
    v_cvt_pk_bf16_f32 v26, v26, v26
    v_lshlrev_b32 v26, 16, v26
    v_add_f32 v26, 0x3727c5ac, v26
    v_cvt_pk_bf16_f32 v26, v26, v26
    v_lshlrev_b32 v26, 16, v26
    v_sqrt_f32 v26, v26
    s_nop 0
    v_cvt_pk_bf16_f32 v26, v26, v26
    v_lshlrev_b32 v26, 16, v26
    v_rcp_f32 v18, v26
    s_nop 0
    v_mul_f32 v17, -v17, v18
    s_sub_u32 s94, 1, s51
    s_lshl_b32 s94, s94, 30
    v_mul_f32 v17, s94, v17
    v_subrev_u32 v3, s44, v3
    v_add_u32 v9, 0x10000, v3
    v_subrev_u32 v4, s44, v4
    v_add_u32 v10, 0x10000, v4
    v_subrev_u32 v5, s44, v5
    v_add_u32 v11, 0x10000, v5
    v_subrev_u32 v6, s44, v6
    v_add_u32 v12, 0x10000, v6
    v_add_u32 v1, 0xc000, v23
    s_and_b32 s94, s68, 1
    s_lshl_b32 s94, s94, 10
    v_add_u32 v22, s94, v62
    v_add_u32 v2, 0xc000, v22
    s_barrier
    s_add_u32 m0, s45, 32768
    s_and_b32 s94, s68, 1
    buffer_load_dwordx4 v36, s[8:11], s29 offen offset:0 lds
    s_lshl_b32 s95, s94, 2
    s_sub_u32 s94, s95, s94
    s_add_u32 s96, s94, 8
    s_add_u32 s97, s95, 6
    s_cmp_lt_u32 s68, 2
    s_cselect_b32 s95, s95, s96
    s_cselect_b32 s94, s94, s97
    s_cselect_b32 s96, 0xfea9500, 0
    s_cselect_b32 s97, 0x93924e4, 0
    s_cselect_b32 s54, 0, 0xffa9540
    s_cselect_b32 s55, 0, 0xe493924
    s_or_b32 s96, s96, s54
    s_or_b32 s97, s97, s55
    s_sub_i32 s94, s94, s95
    s_add_u32 s95, s95, s74
    v_lshlrev_b32 v24, 1, v0
    v_bfe_u32 v25, s96, v24, 2
    s_add_u32 s99, s29, 15360
    v_bfe_u32 v26, s97, v24, 2
    buffer_load_dwordx4 v8, s[8:11], s99 offen offset:1024 lds
    v_and_b32 v27, 1, v25
    v_add_u32 v26, s95, v26
    v_mad_i32_i24 v26, v27, s94, v26
    s_add_u32 s94, s73, s100
    s_lshl_b32 s95, s73, 7
    v_subrev_u32 v27, 14, v26
    v_min_u32 v26, v26, v27
    v_add_u32 v25, s94, v25
    v_and_b32 v25, 3, v25
    v_lshlrev_b32 v26, 17, v26
    v_lshl_add_u32 v26, v25, 14, v26
    v_add_u32 v26, s95, v26
    s_nop 0
    v_readlane_b32 s80, v26, 0
    v_readlane_b32 s81, v26, 1
    v_readlane_b32 s82, v26, 2
    v_readlane_b32 s83, v26, 3
    s_add_u32 s99, s29, 30720
    v_readlane_b32 s84, v26, 4
    buffer_load_dwordx4 v7, s[8:11], s99 offen offset:2048 lds
    v_readlane_b32 s85, v26, 5
    v_readlane_b32 s86, v26, 6
    v_readlane_b32 s87, v26, 7
    v_readlane_b32 s88, v26, 8
    v_readlane_b32 s89, v26, 9
    v_readlane_b32 s90, v26, 10
    v_readlane_b32 s91, v26, 11
    v_readlane_b32 s92, v26, 12
    v_readlane_b32 s93, v26, 13
    s_add_u32 s94, s71, 0
    s_and_b32 s94, s94, 4
    s_lshl_b32 s94, s94, 29
    s_mul_i32 s94, s94, s51
    s_or_b32 s54, s94, 1.0
    s_add_u32 s94, s71, 1
    s_and_b32 s94, s94, 4
    s_lshl_b32 s94, s94, 29
    s_add_u32 s99, s29, 46080
    s_mul_i32 s94, s94, s51
    buffer_load_dwordx4 v8, s[8:11], s99 offen offset:3072 lds
    s_or_b32 s55, s94, 1.0
    s_add_u32 s94, s71, 2
    s_and_b32 s94, s94, 4
    s_lshl_b32 s94, s94, 29
    s_mul_i32 s94, s94, s51
    s_or_b32 s56, s94, 1.0
    s_add_u32 s94, s71, 3
    s_and_b32 s94, s94, 4
    s_lshl_b32 s94, s94, 29
    s_mul_i32 s94, s94, s51
    s_or_b32 s57, s94, 1.0
    s_lshl_b32 s94, s51, 31
    s_or_b32 s58, s94, 1.0
    v_mul_f32 v40, s54, v18
    v_mul_f32 v41, s55, v18
    v_mul_f32 v42, s56, v18
    v_mul_f32 v43, s57, v18
    s_add_u32 m0, s45, 49152
    v_lshlrev_b32 v24, 16, v128
    s_mov_b64 exec, s[40:41]
    ds_write_b128 v62, v[44:47] offset:49152
    s_not_b64 exec, exec
    buffer_load_dwordx4 v36, s[12:15], s29 offen offset:0 lds
    s_mov_b64 exec, -1
    v_and_b32 v25, s76, v128
    v_lshlrev_b32 v26, 16, v192
    v_and_b32 v27, s76, v192
    v_fmac_f32 v24, s58, v26
    v_fmac_f32 v25, s58, v27
    v_fma_f32 v24, v24, v40, v17
    v_fma_f32 v25, v25, v40, v17
    v_cvt_pk_bf16_f32 v128, v24, v25
    v_lshlrev_b32 v28, 16, v129
    v_and_b32 v29, s76, v129
    v_lshlrev_b32 v30, 16, v193
    v_and_b32 v31, s76, v193
    v_fmac_f32 v28, s58, v30
    v_fmac_f32 v29, s58, v31
    v_fma_f32 v28, v28, v40, v17
    v_fma_f32 v29, v29, v40, v17
    v_cvt_pk_bf16_f32 v129, v28, v29
    s_add_u32 s99, s29, 15360
    v_lshlrev_b32 v24, 16, v130
    buffer_load_dwordx4 v8, s[12:15], s99 offen offset:1024 lds
    v_and_b32 v25, s76, v130
    v_lshlrev_b32 v26, 16, v194
    v_and_b32 v27, s76, v194
    v_fmac_f32 v24, s58, v26
    v_fmac_f32 v25, s58, v27
    v_fma_f32 v24, v24, v40, v17
    v_fma_f32 v25, v25, v40, v17
    v_cvt_pk_bf16_f32 v130, v24, v25
    v_lshlrev_b32 v28, 16, v131
    v_and_b32 v29, s76, v131
    v_lshlrev_b32 v30, 16, v195
    v_and_b32 v31, s76, v195
    v_fmac_f32 v28, s58, v30
    v_fmac_f32 v29, s58, v31
    v_fma_f32 v28, v28, v40, v17
    v_fma_f32 v29, v29, v40, v17
    v_cvt_pk_bf16_f32 v131, v28, v29
    s_add_u32 s99, s29, 30720
    v_lshlrev_b32 v24, 16, v132
    buffer_load_dwordx4 v7, s[12:15], s99 offen offset:2048 lds
    v_and_b32 v25, s76, v132
    v_lshlrev_b32 v26, 16, v196
    v_and_b32 v27, s76, v196
    v_fmac_f32 v24, s58, v26
    v_fmac_f32 v25, s58, v27
    v_fma_f32 v24, v24, v40, v17
    v_fma_f32 v25, v25, v40, v17
    v_cvt_pk_bf16_f32 v132, v24, v25
    v_lshlrev_b32 v28, 16, v133
    v_and_b32 v29, s76, v133
    v_lshlrev_b32 v30, 16, v197
    v_and_b32 v31, s76, v197
    v_fmac_f32 v28, s58, v30
    v_fmac_f32 v29, s58, v31
    v_fma_f32 v28, v28, v40, v17
    v_fma_f32 v29, v29, v40, v17
    v_cvt_pk_bf16_f32 v133, v28, v29
    s_add_u32 s99, s29, 46080
    v_lshlrev_b32 v24, 16, v134
    buffer_load_dwordx4 v8, s[12:15], s99 offen offset:3072 lds
    v_and_b32 v25, s76, v134
    v_lshlrev_b32 v26, 16, v198
    v_and_b32 v27, s76, v198
    v_fmac_f32 v24, s58, v26
    v_fmac_f32 v25, s58, v27
    v_fma_f32 v24, v24, v40, v17
    v_fma_f32 v25, v25, v40, v17
    v_cvt_pk_bf16_f32 v134, v24, v25
    v_lshlrev_b32 v28, 16, v135
    v_and_b32 v29, s76, v135
    v_lshlrev_b32 v30, 16, v199
    v_and_b32 v31, s76, v199
    v_fmac_f32 v28, s58, v30
    v_fmac_f32 v29, s58, v31
    v_fma_f32 v28, v28, v40, v17
    v_fma_f32 v29, v29, v40, v17
    v_cvt_pk_bf16_f32 v135, v28, v29
    s_add_u32 m0, s45, 65536
    v_lshlrev_b32 v24, 16, v136
    buffer_load_dwordx4 v36, s[8:11], s30 offen offset:0 lds
    v_and_b32 v25, s76, v136
    v_lshlrev_b32 v26, 16, v200
    v_and_b32 v27, s76, v200
    v_fmac_f32 v24, s58, v26
    v_fmac_f32 v25, s58, v27
    v_fma_f32 v24, v24, v40, v17
    v_fma_f32 v25, v25, v40, v17
    v_cvt_pk_bf16_f32 v136, v24, v25
    v_lshlrev_b32 v28, 16, v137
    v_and_b32 v29, s76, v137
    v_lshlrev_b32 v30, 16, v201
    v_and_b32 v31, s76, v201
    v_fmac_f32 v28, s58, v30
    v_fmac_f32 v29, s58, v31
    v_fma_f32 v28, v28, v40, v17
    v_fma_f32 v29, v29, v40, v17
    v_cvt_pk_bf16_f32 v137, v28, v29
    s_add_u32 s99, s30, 15360
    v_lshlrev_b32 v24, 16, v138
    buffer_load_dwordx4 v8, s[8:11], s99 offen offset:1024 lds
    v_and_b32 v25, s76, v138
    v_lshlrev_b32 v26, 16, v202
    v_and_b32 v27, s76, v202
    v_fmac_f32 v24, s58, v26
    v_fmac_f32 v25, s58, v27
    v_fma_f32 v24, v24, v40, v17
    v_fma_f32 v25, v25, v40, v17
    v_cvt_pk_bf16_f32 v138, v24, v25
    v_lshlrev_b32 v28, 16, v139
    v_and_b32 v29, s76, v139
    v_lshlrev_b32 v30, 16, v203
    v_and_b32 v31, s76, v203
    v_fmac_f32 v28, s58, v30
    v_fmac_f32 v29, s58, v31
    v_fma_f32 v28, v28, v40, v17
    v_fma_f32 v29, v29, v40, v17
    v_cvt_pk_bf16_f32 v139, v28, v29
    s_add_u32 s99, s30, 30720
    v_lshlrev_b32 v24, 16, v140
    buffer_load_dwordx4 v7, s[8:11], s99 offen offset:2048 lds
    v_and_b32 v25, s76, v140
    v_lshlrev_b32 v26, 16, v204
    v_and_b32 v27, s76, v204
    v_fmac_f32 v24, s58, v26
    v_fmac_f32 v25, s58, v27
    v_fma_f32 v24, v24, v40, v17
    v_fma_f32 v25, v25, v40, v17
    v_cvt_pk_bf16_f32 v140, v24, v25
    v_lshlrev_b32 v28, 16, v141
    v_and_b32 v29, s76, v141
    v_lshlrev_b32 v30, 16, v205
    v_and_b32 v31, s76, v205
    v_fmac_f32 v28, s58, v30
    v_fmac_f32 v29, s58, v31
    v_fma_f32 v28, v28, v40, v17
    v_fma_f32 v29, v29, v40, v17
    v_cvt_pk_bf16_f32 v141, v28, v29
    s_add_u32 s99, s30, 46080
    v_lshlrev_b32 v24, 16, v142
    buffer_load_dwordx4 v8, s[8:11], s99 offen offset:3072 lds
    v_and_b32 v25, s76, v142
    v_lshlrev_b32 v26, 16, v206
    v_and_b32 v27, s76, v206
    v_fmac_f32 v24, s58, v26
    v_fmac_f32 v25, s58, v27
    v_fma_f32 v24, v24, v40, v17
    v_fma_f32 v25, v25, v40, v17
    v_cvt_pk_bf16_f32 v142, v24, v25
    v_lshlrev_b32 v28, 16, v143
    v_and_b32 v29, s76, v143
    v_lshlrev_b32 v30, 16, v207
    v_and_b32 v31, s76, v207
    v_fmac_f32 v28, s58, v30
    v_fmac_f32 v29, s58, v31
    v_fma_f32 v28, v28, v40, v17
    v_fma_f32 v29, v29, v40, v17
    v_cvt_pk_bf16_f32 v143, v28, v29
    s_add_u32 m0, s46, 0
    s_nop 0
    buffer_load_dwordx4 v13, s[16:19], s80 offen offset:0 lds
    buffer_load_dwordx4 v14, s[16:19], s80 offen offset:1024 lds
    s_add_u32 m0, s46, 2048
    s_nop 0
    buffer_load_dwordx4 v13, s[16:19], s81 offen offset:0 lds
    buffer_load_dwordx4 v14, s[16:19], s81 offen offset:1024 lds
    s_waitcnt vmcnt(20)
    s_barrier
    ds_read_b128 a[64:67], v3 offset:0
    ds_read_b128 a[68:71], v3 offset:4096
    ds_read_b128 a[72:75], v3 offset:8192
    ds_read_b128 a[76:79], v3 offset:12288
    ds_read_b128 a[80:83], v4 offset:0
    ds_read_b128 a[84:87], v4 offset:4096
    ds_read_b128 a[88:91], v4 offset:8192
    s_waitcnt lgkmcnt(3)
    v_mfma_f32_32x32x16_bf16 v[64:79], v[128:131], a[64:67], 0
    ds_read_b128 a[92:95], v4 offset:12288
    v_lshlrev_b32 v24, 16, v144
    v_and_b32 v25, s76, v144
    v_lshlrev_b32 v26, 16, v208
    v_and_b32 v27, s76, v208
    v_fmac_f32 v24, s58, v26
    v_mfma_f32_32x32x16_bf16 v[96:111], v[128:131], a[68:71], 0
    ds_read_b128 a[64:67], v5 offset:0
    v_fmac_f32 v25, s58, v27
    v_fma_f32 v24, v24, v41, v17
    v_fma_f32 v25, v25, v41, v17
    v_cvt_pk_bf16_f32 v144, v24, v25
    v_lshlrev_b32 v28, 16, v145
    v_mfma_f32_32x32x16_bf16 a[0:15], v[128:131], a[72:75], 0
    ds_read_b128 a[68:71], v5 offset:4096
    v_and_b32 v29, s76, v145
    v_lshlrev_b32 v30, 16, v209
    v_and_b32 v31, s76, v209
    v_fmac_f32 v28, s58, v30
    v_fmac_f32 v29, s58, v31
    v_mfma_f32_32x32x16_bf16 a[32:47], v[128:131], a[76:79], 0
    ds_read_b128 a[72:75], v5 offset:8192
    v_fma_f32 v28, v28, v41, v17
    v_fma_f32 v29, v29, v41, v17
    v_cvt_pk_bf16_f32 v145, v28, v29
    v_lshlrev_b32 v24, 16, v146
    s_waitcnt lgkmcnt(3)
    v_mfma_f32_32x32x16_bf16 v[64:79], v[132:135], a[80:83], v[64:79]
    ds_read_b128 a[76:79], v5 offset:12288
    v_and_b32 v25, s76, v146
    v_lshlrev_b32 v26, 16, v210
    v_and_b32 v27, s76, v210
    v_fmac_f32 v24, s58, v26
    v_fmac_f32 v25, s58, v27
    v_mfma_f32_32x32x16_bf16 v[96:111], v[132:135], a[84:87], v[96:111]
    ds_read_b128 a[80:83], v6 offset:0
    v_fma_f32 v24, v24, v41, v17
    v_fma_f32 v25, v25, v41, v17
    v_cvt_pk_bf16_f32 v146, v24, v25
    v_lshlrev_b32 v28, 16, v147
    v_and_b32 v29, s76, v147
    v_mfma_f32_32x32x16_bf16 a[0:15], v[132:135], a[88:91], a[0:15]
    ds_read_b128 a[84:87], v6 offset:4096
    v_lshlrev_b32 v30, 16, v211
    v_and_b32 v31, s76, v211
    v_fmac_f32 v28, s58, v30
    v_fmac_f32 v29, s58, v31
    v_fma_f32 v28, v28, v41, v17
    v_mfma_f32_32x32x16_bf16 a[32:47], v[132:135], a[92:95], a[32:47]
    ds_read_b128 a[88:91], v6 offset:8192
    v_fma_f32 v29, v29, v41, v17
    v_cvt_pk_bf16_f32 v147, v28, v29
    v_lshlrev_b32 v24, 16, v148
    v_and_b32 v25, s76, v148
    s_waitcnt lgkmcnt(3)
    v_mfma_f32_32x32x16_bf16 v[64:79], v[136:139], a[64:67], v[64:79]
    ds_read_b128 a[92:95], v6 offset:12288
    v_lshlrev_b32 v26, 16, v212
    v_and_b32 v27, s76, v212
    v_fmac_f32 v24, s58, v26
    v_fmac_f32 v25, s58, v27
    v_fma_f32 v24, v24, v41, v17
    v_mfma_f32_32x32x16_bf16 v[96:111], v[136:139], a[68:71], v[96:111]
    s_waitcnt vmcnt(16)
    s_barrier
    ds_read_b128 a[64:67], v3 offset:16384
    v_fma_f32 v25, v25, v41, v17
    v_cvt_pk_bf16_f32 v148, v24, v25
    v_lshlrev_b32 v28, 16, v149
    v_mfma_f32_32x32x16_bf16 a[0:15], v[136:139], a[72:75], a[0:15]
    ds_read_b128 a[68:71], v3 offset:20480
    v_and_b32 v29, s76, v149
    v_lshlrev_b32 v30, 16, v213
    v_and_b32 v31, s76, v213
    v_fmac_f32 v28, s58, v30
    v_fmac_f32 v29, s58, v31
    v_mfma_f32_32x32x16_bf16 a[32:47], v[136:139], a[76:79], a[32:47]
    s_add_u32 m0, s46, 4096
    ds_read_b128 a[72:75], v3 offset:24576
    buffer_load_dwordx4 v13, s[16:19], s82 offen offset:0 lds
    s_waitcnt lgkmcnt(3)
    v_mfma_f32_32x32x16_bf16 v[64:79], v[140:143], a[80:83], v[64:79]
    ds_read_b128 a[76:79], v3 offset:28672
    v_fma_f32 v28, v28, v41, v17
    v_fma_f32 v29, v29, v41, v17
    v_cvt_pk_bf16_f32 v149, v28, v29
    v_lshlrev_b32 v24, 16, v150
    v_and_b32 v25, s76, v150
    v_mfma_f32_32x32x16_bf16 v[96:111], v[140:143], a[84:87], v[96:111]
    ds_read_b128 a[80:83], v4 offset:16384
    buffer_load_dwordx4 v14, s[16:19], s82 offen offset:1024 lds
    v_lshlrev_b32 v26, 16, v214
    v_and_b32 v27, s76, v214
    v_mfma_f32_32x32x16_bf16 a[0:15], v[140:143], a[88:91], a[0:15]
    ds_read_b128 a[84:87], v4 offset:20480
    v_fmac_f32 v24, s58, v26
    v_fmac_f32 v25, s58, v27
    v_fma_f32 v24, v24, v41, v17
    v_fma_f32 v25, v25, v41, v17
    v_cvt_pk_bf16_f32 v150, v24, v25
    v_mfma_f32_32x32x16_bf16 a[32:47], v[140:143], a[92:95], a[32:47]
    s_add_u32 m0, s46, 6144
    ds_read_b128 a[88:91], v4 offset:24576
    buffer_load_dwordx4 v13, s[16:19], s83 offen offset:0 lds
    s_waitcnt lgkmcnt(3)
    v_mfma_f32_32x32x16_bf16 v[80:95], v[128:131], a[64:67], 0
    ds_read_b128 a[92:95], v4 offset:28672
    v_lshlrev_b32 v28, 16, v151
    v_and_b32 v29, s76, v151
    v_lshlrev_b32 v30, 16, v215
    v_and_b32 v31, s76, v215
    v_fmac_f32 v28, s58, v30
    v_mfma_f32_32x32x16_bf16 v[112:127], v[128:131], a[68:71], 0
    ds_read_b128 a[64:67], v5 offset:16384
    buffer_load_dwordx4 v14, s[16:19], s83 offen offset:1024 lds
    v_fmac_f32 v29, s58, v31
    v_fma_f32 v28, v28, v41, v17
    v_mfma_f32_32x32x16_bf16 a[16:31], v[128:131], a[72:75], 0
    ds_read_b128 a[68:71], v5 offset:20480
    v_fma_f32 v29, v29, v41, v17
    v_cvt_pk_bf16_f32 v151, v28, v29
    v_lshlrev_b32 v24, 16, v152
    v_and_b32 v25, s76, v152
    v_lshlrev_b32 v26, 16, v216
    v_mfma_f32_32x32x16_bf16 a[48:63], v[128:131], a[76:79], 0
    ds_read_b128 a[72:75], v5 offset:24576
    v_and_b32 v27, s76, v216
    v_fmac_f32 v24, s58, v26
    v_fmac_f32 v25, s58, v27
    v_fma_f32 v24, v24, v41, v17
    s_waitcnt lgkmcnt(3)
    v_mfma_f32_32x32x16_bf16 v[80:95], v[132:135], a[80:83], v[80:95]
    ds_read_b128 a[76:79], v5 offset:28672
    v_fma_f32 v25, v25, v41, v17
    v_cvt_pk_bf16_f32 v152, v24, v25
    v_lshlrev_b32 v28, 16, v153
    v_and_b32 v29, s76, v153
    v_lshlrev_b32 v30, 16, v217
    v_mfma_f32_32x32x16_bf16 v[112:127], v[132:135], a[84:87], v[112:127]
    ds_read_b128 a[80:83], v6 offset:16384
    v_and_b32 v31, s76, v217
    v_fmac_f32 v28, s58, v30
    v_fmac_f32 v29, s58, v31
    v_fma_f32 v28, v28, v41, v17
    v_fma_f32 v29, v29, v41, v17
    v_mfma_f32_32x32x16_bf16 a[16:31], v[132:135], a[88:91], a[16:31]
    ds_read_b128 a[84:87], v6 offset:20480
    v_cvt_pk_bf16_f32 v153, v28, v29
    v_lshlrev_b32 v24, 16, v154
    v_and_b32 v25, s76, v154
    v_lshlrev_b32 v26, 16, v218
    v_and_b32 v27, s76, v218
    v_mfma_f32_32x32x16_bf16 a[48:63], v[132:135], a[92:95], a[48:63]
    ds_read_b128 a[88:91], v6 offset:24576
    v_fmac_f32 v24, s58, v26
    v_fmac_f32 v25, s58, v27
    v_fma_f32 v24, v24, v41, v17
    v_fma_f32 v25, v25, v41, v17
    s_waitcnt lgkmcnt(3)
    v_mfma_f32_32x32x16_bf16 v[80:95], v[136:139], a[64:67], v[80:95]
    ds_read_b128 a[92:95], v6 offset:28672
    s_waitcnt vmcnt(4)
    ds_read_b64_tr_b16 a[128:129], v56 offset:0
    v_cvt_pk_bf16_f32 v154, v24, v25
    v_lshlrev_b32 v28, 16, v155
    v_and_b32 v29, s76, v155
    v_mfma_f32_32x32x16_bf16 v[112:127], v[136:139], a[68:71], v[112:127]
    s_barrier
    ds_read_b128 a[64:67], v3 offset:32768
    v_lshlrev_b32 v30, 16, v219
    v_and_b32 v31, s76, v219
    v_fmac_f32 v28, s58, v30
    v_fmac_f32 v29, s58, v31
    v_mfma_f32_32x32x16_bf16 a[16:31], v[136:139], a[72:75], a[16:31]
    ds_read_b128 a[68:71], v3 offset:36864
    ds_read_b64_tr_b16 a[130:131], v56 offset:1024
    v_fma_f32 v28, v28, v41, v17
    v_fma_f32 v29, v29, v41, v17
    v_cvt_pk_bf16_f32 v155, v28, v29
    v_lshlrev_b32 v24, 16, v156
    v_mfma_f32_32x32x16_bf16 a[48:63], v[136:139], a[76:79], a[48:63]
    s_add_u32 m0, s45, 0
    ds_read_b128 a[72:75], v3 offset:40960
    s_mov_b64 exec, s[40:41]
    ds_write_b128 v62, v[44:47] offset:0
    s_not_b64 exec, exec
    buffer_load_dwordx4 v36, s[12:15], s30 offen offset:0 lds
    s_mov_b64 exec, -1
    s_waitcnt lgkmcnt(6)
    v_mfma_f32_32x32x16_bf16 v[80:95], v[140:143], a[80:83], v[80:95]
    ds_read_b128 a[76:79], v3 offset:45056
    ds_read_b64_tr_b16 a[132:133], v57 offset:0
    v_and_b32 v25, s76, v156
    v_lshlrev_b32 v26, 16, v220
    v_and_b32 v27, s76, v220
    v_fmac_f32 v24, s58, v26
    v_mfma_f32_32x32x16_bf16 v[112:127], v[140:143], a[84:87], v[112:127]
    s_add_u32 s99, s30, 15360
    ds_read_b128 a[80:83], v4 offset:32768
    buffer_load_dwordx4 v8, s[12:15], s99 offen offset:1024 lds
    v_fmac_f32 v25, s58, v27
    v_mfma_f32_32x32x16_bf16 a[16:31], v[140:143], a[88:91], a[16:31]
    ds_read_b128 a[84:87], v4 offset:36864
    ds_read_b64_tr_b16 a[134:135], v57 offset:1024
    v_fma_f32 v24, v24, v41, v17
    v_fma_f32 v25, v25, v41, v17
    v_cvt_pk_bf16_f32 v156, v24, v25
    v_lshlrev_b32 v28, 16, v157
    v_mfma_f32_32x32x16_bf16 a[48:63], v[140:143], a[92:95], a[48:63]
    s_add_u32 s99, s30, 30720
    ds_read_b128 a[88:91], v4 offset:40960
    buffer_load_dwordx4 v7, s[12:15], s99 offen offset:2048 lds
    s_waitcnt lgkmcnt(5)
    v_mfma_f32_32x32x16_bf16 v[64:79], v[144:147], a[64:67], v[64:79]
    ds_read_b128 a[92:95], v4 offset:45056
    ds_read_b64_tr_b16 a[136:137], v15 offset:0
    v_and_b32 v29, s76, v157
    v_lshlrev_b32 v30, 16, v221
    v_and_b32 v31, s76, v221
    v_fmac_f32 v28, s58, v30
    v_mfma_f32_32x32x16_bf16 v[96:111], v[144:147], a[68:71], v[96:111]
    s_add_u32 s99, s30, 46080
    ds_read_b128 a[64:67], v5 offset:32768
    buffer_load_dwordx4 v8, s[12:15], s99 offen offset:3072 lds
    v_fmac_f32 v29, s58, v31
    v_mfma_f32_32x32x16_bf16 a[0:15], v[144:147], a[72:75], a[0:15]
    ds_read_b128 a[68:71], v5 offset:36864
    ds_read_b64_tr_b16 a[138:139], v15 offset:1024
    v_fma_f32 v28, v28, v41, v17
    v_fma_f32 v29, v29, v41, v17
    v_cvt_pk_bf16_f32 v157, v28, v29
    v_lshlrev_b32 v24, 16, v158
    v_mfma_f32_32x32x16_bf16 a[32:47], v[144:147], a[76:79], a[32:47]
    s_add_u32 m0, s46, 8192
    ds_read_b128 a[72:75], v5 offset:40960
    buffer_load_dwordx4 v13, s[16:19], s84 offen offset:0 lds
    s_waitcnt lgkmcnt(5)
    v_mfma_f32_32x32x16_bf16 v[64:79], v[148:151], a[80:83], v[64:79]
    ds_read_b128 a[76:79], v5 offset:45056
    ds_read_b64_tr_b16 a[140:141], v35 offset:0
    v_and_b32 v25, s76, v158
    v_lshlrev_b32 v26, 16, v222
    v_and_b32 v27, s76, v222
    v_fmac_f32 v24, s58, v26
    v_mfma_f32_32x32x16_bf16 v[96:111], v[148:151], a[84:87], v[96:111]
    ds_read_b128 a[80:83], v6 offset:32768
    buffer_load_dwordx4 v14, s[16:19], s84 offen offset:1024 lds
    v_fmac_f32 v25, s58, v27
    v_fma_f32 v24, v24, v41, v17
    v_mfma_f32_32x32x16_bf16 a[0:15], v[148:151], a[88:91], a[0:15]
    ds_read_b128 a[84:87], v6 offset:36864
    ds_read_b64_tr_b16 a[142:143], v35 offset:1024
    v_fma_f32 v25, v25, v41, v17
    v_cvt_pk_bf16_f32 v158, v24, v25
    v_lshlrev_b32 v28, 16, v159
    v_and_b32 v29, s76, v159
    v_mfma_f32_32x32x16_bf16 a[32:47], v[148:151], a[92:95], a[32:47]
    s_add_u32 m0, s46, 10240
    ds_read_b128 a[88:91], v6 offset:40960
    buffer_load_dwordx4 v13, s[16:19], s85 offen offset:0 lds
    s_waitcnt lgkmcnt(5)
    v_mfma_f32_32x32x16_bf16 v[64:79], v[152:155], a[64:67], v[64:79]
    ds_read_b128 a[92:95], v6 offset:45056
    v_lshlrev_b32 v30, 16, v223
    v_and_b32 v31, s76, v223
    v_fmac_f32 v28, s58, v30
    v_fmac_f32 v29, s58, v31
    v_fma_f32 v28, v28, v41, v17
    v_mfma_f32_32x32x16_bf16 v[96:111], v[152:155], a[68:71], v[96:111]
    s_barrier
    ds_read_b128 a[64:67], v3 offset:49152
    v_fma_f32 v29, v29, v41, v17
    v_cvt_pk_bf16_f32 v159, v28, v29
    v_lshlrev_b32 v24, 16, v160
    v_and_b32 v25, s76, v160
    v_mfma_f32_32x32x16_bf16 a[0:15], v[152:155], a[72:75], a[0:15]
    ds_read_b128 a[68:71], v3 offset:53248
    s_waitcnt vmcnt(7)
    ds_read_b64_tr_b16 a[144:145], v56 offset:4096
    v_lshlrev_b32 v26, 16, v224
    v_and_b32 v27, s76, v224
    v_fmac_f32 v24, s58, v26
    v_mfma_f32_32x32x16_bf16 a[32:47], v[152:155], a[76:79], a[32:47]
    s_add_u32 m0, s45, 16384
    ds_read_b128 a[72:75], v3 offset:57344
    buffer_load_dwordx4 v36, s[8:11], s31 offen offset:0 lds
    s_waitcnt lgkmcnt(4)
    v_mfma_f32_32x32x16_bf16 v[64:79], v[156:159], a[80:83], v[64:79]
    ds_read_b128 a[76:79], v3 offset:61440
    ds_read_b64_tr_b16 a[146:147], v56 offset:5120
    v_fmac_f32 v25, s58, v27
    v_fma_f32 v24, v24, v42, v17
    v_fma_f32 v25, v25, v42, v17
    v_cvt_pk_bf16_f32 v160, v24, v25
    v_mfma_f32_32x32x16_bf16 v[96:111], v[156:159], a[84:87], v[96:111]
    s_add_u32 s99, s31, 15360
    ds_read_b128 a[80:83], v4 offset:49152
    buffer_load_dwordx4 v8, s[8:11], s99 offen offset:1024 lds
    v_lshlrev_b32 v28, 16, v161
    v_mfma_f32_32x32x16_bf16 a[0:15], v[156:159], a[88:91], a[0:15]
    ds_read_b128 a[84:87], v4 offset:53248
    ds_read_b64_tr_b16 a[148:149], v57 offset:4096
    v_and_b32 v29, s76, v161
    v_lshlrev_b32 v30, 16, v225
    v_and_b32 v31, s76, v225
    v_fmac_f32 v28, s58, v30
    v_mfma_f32_32x32x16_bf16 a[32:47], v[156:159], a[92:95], a[32:47]
    s_add_u32 s99, s31, 30720
    ds_read_b128 a[88:91], v4 offset:57344
    buffer_load_dwordx4 v7, s[8:11], s99 offen offset:2048 lds
    s_waitcnt lgkmcnt(5)
    v_mfma_f32_32x32x16_bf16 v[80:95], v[144:147], a[64:67], v[80:95]
    ds_read_b128 a[92:95], v4 offset:61440
    ds_read_b64_tr_b16 a[150:151], v57 offset:5120
    v_fmac_f32 v29, s58, v31
    v_fma_f32 v28, v28, v42, v17
    v_fma_f32 v29, v29, v42, v17
    v_cvt_pk_bf16_f32 v161, v28, v29
    v_mfma_f32_32x32x16_bf16 v[112:127], v[144:147], a[68:71], v[112:127]
    s_add_u32 s99, s31, 46080
    ds_read_b128 a[64:67], v5 offset:49152
    buffer_load_dwordx4 v8, s[8:11], s99 offen offset:3072 lds
    v_lshlrev_b32 v24, 16, v162
    v_mfma_f32_32x32x16_bf16 a[16:31], v[144:147], a[72:75], a[16:31]
    ds_read_b128 a[68:71], v5 offset:53248
    ds_read_b64_tr_b16 a[152:153], v15 offset:4096
    v_and_b32 v25, s76, v162
    v_lshlrev_b32 v26, 16, v226
    v_and_b32 v27, s76, v226
    v_fmac_f32 v24, s58, v26
    v_mfma_f32_32x32x16_bf16 a[48:63], v[144:147], a[76:79], a[48:63]
    s_add_u32 m0, s46, 10240
    ds_read_b128 a[72:75], v5 offset:57344
    buffer_load_dwordx4 v14, s[16:19], s85 offen offset:1024 lds
    s_waitcnt lgkmcnt(5)
    v_mfma_f32_32x32x16_bf16 v[80:95], v[148:151], a[80:83], v[80:95]
    ds_read_b128 a[76:79], v5 offset:61440
    ds_read_b64_tr_b16 a[154:155], v15 offset:5120
    v_fmac_f32 v25, s58, v27
    v_fma_f32 v24, v24, v42, v17
    v_fma_f32 v25, v25, v42, v17
    v_cvt_pk_bf16_f32 v162, v24, v25
    v_mfma_f32_32x32x16_bf16 v[112:127], v[148:151], a[84:87], v[112:127]
    s_add_u32 m0, s46, 12288
    ds_read_b128 a[80:83], v6 offset:49152
    buffer_load_dwordx4 v13, s[16:19], s86 offen offset:0 lds
    v_lshlrev_b32 v28, 16, v163
    v_mfma_f32_32x32x16_bf16 a[16:31], v[148:151], a[88:91], a[16:31]
    ds_read_b128 a[84:87], v6 offset:53248
    ds_read_b64_tr_b16 a[156:157], v35 offset:4096
    v_and_b32 v29, s76, v163
    v_lshlrev_b32 v30, 16, v227
    v_and_b32 v31, s76, v227
    v_fmac_f32 v28, s58, v30
    v_mfma_f32_32x32x16_bf16 a[48:63], v[148:151], a[92:95], a[48:63]
    ds_read_b128 a[88:91], v6 offset:57344
    buffer_load_dwordx4 v14, s[16:19], s86 offen offset:1024 lds
    v_fmac_f32 v29, s58, v31
    s_waitcnt lgkmcnt(5)
    v_mfma_f32_32x32x16_bf16 v[80:95], v[152:155], a[64:67], v[80:95]
    ds_read_b128 a[92:95], v6 offset:61440
    ds_read_b64_tr_b16 a[158:159], v35 offset:5120
    v_fma_f32 v28, v28, v42, v17
    v_fma_f32 v29, v29, v42, v17
    v_cvt_pk_bf16_f32 v163, v28, v29
    v_lshlrev_b32 v24, 16, v164
    v_mfma_f32_32x32x16_bf16 v[112:127], v[152:155], a[68:71], v[112:127]
    s_barrier
    buffer_load_dword v63, off, s[36:39], 0 sc1
    ds_read_b128 a[64:67], v9 offset:0
    v_and_b32 v25, s76, v164
    v_lshlrev_b32 v26, 16, v228
    v_and_b32 v27, s76, v228
    v_mfma_f32_32x32x16_bf16 a[16:31], v[152:155], a[72:75], a[16:31]
    ds_read_b128 a[68:71], v9 offset:4096
    v_fmac_f32 v24, s58, v26
    v_fmac_f32 v25, s58, v27
    v_fma_f32 v24, v24, v42, v17
    v_fma_f32 v25, v25, v42, v17
    v_cvt_pk_bf16_f32 v164, v24, v25
    v_mfma_f32_32x32x16_bf16 a[48:63], v[152:155], a[76:79], a[48:63]
    s_add_u32 m0, s45, 32768
    ds_read_b128 a[72:75], v9 offset:8192
    s_mov_b64 exec, s[40:41]
    ds_write_b128 v62, v[44:47] offset:32768
    s_not_b64 exec, exec
    buffer_load_dwordx4 v36, s[12:15], s31 offen offset:0 lds
    s_mov_b64 exec, -1
    s_waitcnt lgkmcnt(5)
    v_mfma_f32_32x32x16_bf16 v[80:95], v[156:159], a[80:83], v[80:95]
    ds_read_b128 a[76:79], v9 offset:12288
    v_lshlrev_b32 v28, 16, v165
    v_and_b32 v29, s76, v165
    v_lshlrev_b32 v30, 16, v229
    v_and_b32 v31, s76, v229
    v_fmac_f32 v28, s58, v30
    v_mfma_f32_32x32x16_bf16 v[112:127], v[156:159], a[84:87], v[112:127]
    s_add_u32 s99, s31, 15360
    ds_read_b128 a[80:83], v10 offset:0
    buffer_load_dwordx4 v8, s[12:15], s99 offen offset:1024 lds
    v_fmac_f32 v29, s58, v31
    v_mfma_f32_32x32x16_bf16 a[16:31], v[156:159], a[88:91], a[16:31]
    ds_read_b128 a[84:87], v10 offset:4096
    v_fma_f32 v28, v28, v42, v17
    v_fma_f32 v29, v29, v42, v17
    v_cvt_pk_bf16_f32 v165, v28, v29
    v_lshlrev_b32 v24, 16, v166
    v_and_b32 v25, s76, v166
    v_mfma_f32_32x32x16_bf16 a[48:63], v[156:159], a[92:95], a[48:63]
    s_add_u32 s99, s31, 30720
    ds_read_b128 a[88:91], v10 offset:8192
    buffer_load_dwordx4 v7, s[12:15], s99 offen offset:2048 lds
    s_waitcnt lgkmcnt(3)
    v_mfma_f32_32x32x16_bf16 v[64:79], v[160:163], a[64:67], v[64:79]
    ds_read_b128 a[92:95], v10 offset:12288
    v_lshlrev_b32 v26, 16, v230
    v_and_b32 v27, s76, v230
    v_fmac_f32 v24, s58, v26
    v_fmac_f32 v25, s58, v27
    v_fma_f32 v24, v24, v42, v17
    v_mfma_f32_32x32x16_bf16 v[96:111], v[160:163], a[68:71], v[96:111]
    s_add_u32 s99, s31, 46080
    ds_read_b128 a[64:67], v11 offset:0
    buffer_load_dwordx4 v8, s[12:15], s99 offen offset:3072 lds
    v_fma_f32 v25, v25, v42, v17
    v_mfma_f32_32x32x16_bf16 a[0:15], v[160:163], a[72:75], a[0:15]
    ds_read_b128 a[68:71], v11 offset:4096
    v_cvt_pk_bf16_f32 v166, v24, v25
    v_lshlrev_b32 v28, 16, v167
    v_and_b32 v29, s76, v167
    v_lshlrev_b32 v30, 16, v231
    v_and_b32 v31, s76, v231
    v_fmac_f32 v28, s58, v30
    v_fmac_f32 v29, s58, v31
    v_fma_f32 v28, v28, v42, v17
    v_fma_f32 v29, v29, v42, v17
    v_cvt_pk_bf16_f32 v167, v28, v29
    v_mfma_f32_32x32x16_bf16 a[32:47], v[160:163], a[76:79], a[32:47]
    s_add_u32 m0, s46, 14336
    ds_read_b128 a[72:75], v11 offset:8192
    buffer_load_dwordx4 v13, s[16:19], s87 offen offset:0 lds
    s_waitcnt lgkmcnt(3)
    v_mfma_f32_32x32x16_bf16 v[64:79], v[164:167], a[80:83], v[64:79]
    ds_read_b128 a[76:79], v11 offset:12288
    v_lshlrev_b32 v24, 16, v168
    v_and_b32 v25, s76, v168
    v_lshlrev_b32 v26, 16, v232
    v_and_b32 v27, s76, v232
    v_fmac_f32 v24, s58, v26
    v_mfma_f32_32x32x16_bf16 v[96:111], v[164:167], a[84:87], v[96:111]
    ds_read_b128 a[80:83], v12 offset:0
    buffer_load_dwordx4 v14, s[16:19], s87 offen offset:1024 lds
    v_fmac_f32 v25, s58, v27
    v_fma_f32 v24, v24, v42, v17
    v_mfma_f32_32x32x16_bf16 a[0:15], v[164:167], a[88:91], a[0:15]
    ds_read_b128 a[84:87], v12 offset:4096
    v_fma_f32 v25, v25, v42, v17
    v_cvt_pk_bf16_f32 v168, v24, v25
    v_lshlrev_b32 v28, 16, v169
    v_and_b32 v29, s76, v169
    v_lshlrev_b32 v30, 16, v233
    v_and_b32 v31, s76, v233
    v_fmac_f32 v28, s58, v30
    v_fmac_f32 v29, s58, v31
    v_fma_f32 v28, v28, v42, v17
    v_fma_f32 v29, v29, v42, v17
    v_cvt_pk_bf16_f32 v169, v28, v29
    v_lshlrev_b32 v24, 16, v170
    v_and_b32 v25, s76, v170
    v_lshlrev_b32 v26, 16, v234
    v_and_b32 v27, s76, v234
    v_fmac_f32 v24, s58, v26
    v_fmac_f32 v25, s58, v27
    v_fma_f32 v24, v24, v42, v17
    v_fma_f32 v25, v25, v42, v17
    v_cvt_pk_bf16_f32 v170, v24, v25
    v_lshlrev_b32 v28, 16, v171
    v_and_b32 v29, s76, v171
    v_lshlrev_b32 v30, 16, v235
    v_and_b32 v31, s76, v235
    v_fmac_f32 v28, s58, v30
    v_fmac_f32 v29, s58, v31
    v_fma_f32 v28, v28, v42, v17
    v_fma_f32 v29, v29, v42, v17
    v_cvt_pk_bf16_f32 v171, v28, v29
    v_mfma_f32_32x32x16_bf16 a[32:47], v[164:167], a[92:95], a[32:47]
    s_add_u32 m0, s46, 16384
    ds_read_b128 a[88:91], v12 offset:8192
    buffer_load_dwordx4 v13, s[16:19], s88 offen offset:0 lds
    s_waitcnt lgkmcnt(3)
    v_mfma_f32_32x32x16_bf16 v[64:79], v[168:171], a[64:67], v[64:79]
    ds_read_b128 a[92:95], v12 offset:12288
    v_lshlrev_b32 v24, 16, v172
    v_and_b32 v25, s76, v172
    v_lshlrev_b32 v26, 16, v236
    v_and_b32 v27, s76, v236
    v_fmac_f32 v24, s58, v26
    v_mfma_f32_32x32x16_bf16 v[96:111], v[168:171], a[68:71], v[96:111]
    s_waitcnt vmcnt(18)
    s_barrier
    ds_read_b128 a[64:67], v3 offset:0
    v_fmac_f32 v25, s58, v27
    v_fma_f32 v24, v24, v42, v17
    v_fma_f32 v25, v25, v42, v17
    v_mfma_f32_32x32x16_bf16 a[0:15], v[168:171], a[72:75], a[0:15]
    ds_read_b128 a[68:71], v3 offset:4096
    v_cvt_pk_bf16_f32 v172, v24, v25
    v_lshlrev_b32 v28, 16, v173
    v_and_b32 v29, s76, v173
    v_lshlrev_b32 v30, 16, v237
    v_and_b32 v31, s76, v237
    v_fmac_f32 v28, s58, v30
    v_fmac_f32 v29, s58, v31
    v_fma_f32 v28, v28, v42, v17
    v_fma_f32 v29, v29, v42, v17
    v_cvt_pk_bf16_f32 v173, v28, v29
    v_lshlrev_b32 v24, 16, v174
    v_and_b32 v25, s76, v174
    v_lshlrev_b32 v26, 16, v238
    v_and_b32 v27, s76, v238
    v_fmac_f32 v24, s58, v26
    v_fmac_f32 v25, s58, v27
    v_fma_f32 v24, v24, v42, v17
    v_fma_f32 v25, v25, v42, v17
    v_cvt_pk_bf16_f32 v174, v24, v25
    v_lshlrev_b32 v28, 16, v175
    v_and_b32 v29, s76, v175
    v_lshlrev_b32 v30, 16, v239
    v_and_b32 v31, s76, v239
    v_fmac_f32 v28, s58, v30
    v_fmac_f32 v29, s58, v31
    v_fma_f32 v28, v28, v42, v17
    v_fma_f32 v29, v29, v42, v17
    v_cvt_pk_bf16_f32 v175, v28, v29
    v_mfma_f32_32x32x16_bf16 a[32:47], v[168:171], a[76:79], a[32:47]
    ds_read_b128 a[72:75], v3 offset:8192
    buffer_load_dwordx4 v14, s[16:19], s88 offen offset:1024 lds
    v_lshlrev_b32 v24, 16, v176
    s_waitcnt lgkmcnt(3)
    v_mfma_f32_32x32x16_bf16 v[64:79], v[172:175], a[80:83], v[64:79]
    ds_read_b128 a[76:79], v3 offset:12288
    s_waitcnt vmcnt(11)
    ds_read_b64_tr_b16 a[160:161], v56 offset:8192
    v_and_b32 v25, s76, v176
    v_lshlrev_b32 v26, 16, v240
    v_and_b32 v27, s76, v240
    v_mfma_f32_32x32x16_bf16 v[96:111], v[172:175], a[84:87], v[96:111]
    s_add_u32 m0, s46, 18432
    ds_read_b128 a[80:83], v4 offset:0
    buffer_load_dwordx4 v13, s[16:19], s89 offen offset:0 lds
    v_fmac_f32 v24, s58, v26
    v_mfma_f32_32x32x16_bf16 a[0:15], v[172:175], a[88:91], a[0:15]
    ds_read_b128 a[84:87], v4 offset:4096
    ds_read_b64_tr_b16 a[162:163], v56 offset:9216
    v_fmac_f32 v25, s58, v27
    v_fma_f32 v24, v24, v43, v17
    v_fma_f32 v25, v25, v43, v17
    v_cvt_pk_bf16_f32 v176, v24, v25
    v_mfma_f32_32x32x16_bf16 a[32:47], v[172:175], a[92:95], a[32:47]
    ds_read_b128 a[88:91], v4 offset:8192
    buffer_load_dwordx4 v14, s[16:19], s89 offen offset:1024 lds
    v_lshlrev_b32 v28, 16, v177
    s_waitcnt lgkmcnt(5)
    v_mfma_f32_32x32x16_bf16 v[80:95], v[160:163], a[64:67], v[80:95]
    ds_read_b128 a[92:95], v4 offset:12288
    ds_read_b64_tr_b16 a[164:165], v57 offset:8192
    v_and_b32 v29, s76, v177
    v_lshlrev_b32 v30, 16, v241
    v_and_b32 v31, s76, v241
    v_fmac_f32 v28, s58, v30
    v_mfma_f32_32x32x16_bf16 v[112:127], v[160:163], a[68:71], v[112:127]
    s_add_u32 m0, s46, 0
    ds_read_b128 a[64:67], v5 offset:0
    buffer_load_dwordx4 v13, s[16:19], s90 offen offset:0 lds
    v_fmac_f32 v29, s58, v31
    v_mfma_f32_32x32x16_bf16 a[16:31], v[160:163], a[72:75], a[16:31]
    ds_read_b128 a[68:71], v5 offset:4096
    ds_read_b64_tr_b16 a[166:167], v57 offset:9216
    v_fma_f32 v28, v28, v43, v17
    v_fma_f32 v29, v29, v43, v17
    v_cvt_pk_bf16_f32 v177, v28, v29
    v_lshlrev_b32 v24, 16, v178
    v_mfma_f32_32x32x16_bf16 a[48:63], v[160:163], a[76:79], a[48:63]
    ds_read_b128 a[72:75], v5 offset:8192
    v_and_b32 v25, s76, v178
    v_lshlrev_b32 v26, 16, v242
    v_and_b32 v27, s76, v242
    v_fmac_f32 v24, s58, v26
    s_waitcnt lgkmcnt(5)
    v_mfma_f32_32x32x16_bf16 v[80:95], v[164:167], a[80:83], v[80:95]
    ds_read_b128 a[76:79], v5 offset:12288
    ds_read_b64_tr_b16 a[168:169], v15 offset:8192
    v_fmac_f32 v25, s58, v27
    v_fma_f32 v24, v24, v43, v17
    v_fma_f32 v25, v25, v43, v17
    v_cvt_pk_bf16_f32 v178, v24, v25
    v_mfma_f32_32x32x16_bf16 v[112:127], v[164:167], a[84:87], v[112:127]
    ds_read_b128 a[80:83], v6 offset:0
    v_lshlrev_b32 v28, 16, v179
    v_and_b32 v29, s76, v179
    v_lshlrev_b32 v30, 16, v243
    v_and_b32 v31, s76, v243
    v_fmac_f32 v28, s58, v30
    v_mfma_f32_32x32x16_bf16 a[16:31], v[164:167], a[88:91], a[16:31]
    ds_read_b128 a[84:87], v6 offset:4096
    ds_read_b64_tr_b16 a[170:171], v15 offset:9216
    v_fmac_f32 v29, s58, v31
    v_fma_f32 v28, v28, v43, v17
    v_fma_f32 v29, v29, v43, v17
    v_cvt_pk_bf16_f32 v179, v28, v29
    v_mfma_f32_32x32x16_bf16 a[48:63], v[164:167], a[92:95], a[48:63]
    ds_read_b128 a[88:91], v6 offset:8192
    v_lshlrev_b32 v24, 16, v180
    v_and_b32 v25, s76, v180
    v_lshlrev_b32 v26, 16, v244
    v_and_b32 v27, s76, v244
    s_waitcnt lgkmcnt(5)
    v_mfma_f32_32x32x16_bf16 v[80:95], v[168:171], a[64:67], v[80:95]
    ds_read_b128 a[92:95], v6 offset:12288
    ds_read_b64_tr_b16 a[172:173], v35 offset:8192
    v_fmac_f32 v24, s58, v26
    v_fmac_f32 v25, s58, v27
    v_fma_f32 v24, v24, v43, v17
    v_fma_f32 v25, v25, v43, v17
    v_mfma_f32_32x32x16_bf16 v[112:127], v[168:171], a[68:71], v[112:127]
    s_barrier
    ds_read_b128 a[64:67], v3 offset:16384
    v_cvt_pk_bf16_f32 v180, v24, v25
    v_lshlrev_b32 v28, 16, v181
    v_and_b32 v29, s76, v181
    v_lshlrev_b32 v30, 16, v245
    v_mfma_f32_32x32x16_bf16 a[16:31], v[168:171], a[72:75], a[16:31]
    ds_read_b128 a[68:71], v3 offset:20480
    ds_read_b64_tr_b16 a[174:175], v35 offset:9216
    v_and_b32 v31, s76, v245
    v_fmac_f32 v28, s58, v30
    v_fmac_f32 v29, s58, v31
    v_fma_f32 v28, v28, v43, v17
    v_mfma_f32_32x32x16_bf16 a[48:63], v[168:171], a[76:79], a[48:63]
    ds_read_b128 a[72:75], v3 offset:24576
    buffer_load_dwordx4 v14, s[16:19], s90 offen offset:1024 lds
    v_fma_f32 v29, v29, v43, v17
    s_waitcnt lgkmcnt(5)
    v_mfma_f32_32x32x16_bf16 v[80:95], v[172:175], a[80:83], v[80:95]
    ds_read_b128 a[76:79], v3 offset:28672
    v_cvt_pk_bf16_f32 v181, v28, v29
    v_lshlrev_b32 v24, 16, v182
    v_and_b32 v25, s76, v182
    v_lshlrev_b32 v26, 16, v246
    v_and_b32 v27, s76, v246
    v_mfma_f32_32x32x16_bf16 v[112:127], v[172:175], a[84:87], v[112:127]
    s_add_u32 m0, s46, 2048
    ds_read_b128 a[80:83], v4 offset:16384
    buffer_load_dwordx4 v13, s[16:19], s91 offen offset:0 lds
    v_fmac_f32 v24, s58, v26
    v_mfma_f32_32x32x16_bf16 a[16:31], v[172:175], a[88:91], a[16:31]
    ds_read_b128 a[84:87], v4 offset:20480
    s_waitcnt vmcnt(7)
    ds_read_b64_tr_b16 a[176:177], v56 offset:12288
    v_fmac_f32 v25, s58, v27
    v_fma_f32 v24, v24, v43, v17
    v_fma_f32 v25, v25, v43, v17
    v_mfma_f32_32x32x16_bf16 a[48:63], v[172:175], a[92:95], a[48:63]
    ds_read_b128 a[88:91], v4 offset:24576
    buffer_load_dwordx4 v14, s[16:19], s91 offen offset:1024 lds
    v_cvt_pk_bf16_f32 v182, v24, v25
    s_waitcnt lgkmcnt(4)
    v_mfma_f32_32x32x16_bf16 v[64:79], v[176:179], a[64:67], v[64:79]
    ds_read_b128 a[92:95], v4 offset:28672
    ds_read_b64_tr_b16 a[178:179], v56 offset:13312
    v_lshlrev_b32 v28, 16, v183
    v_and_b32 v29, s76, v183
    v_lshlrev_b32 v30, 16, v247
    v_and_b32 v31, s76, v247
    v_mfma_f32_32x32x16_bf16 v[96:111], v[176:179], a[68:71], v[96:111]
    s_add_u32 m0, s46, 4096
    ds_read_b128 a[64:67], v5 offset:16384
    buffer_load_dwordx4 v13, s[16:19], s92 offen offset:0 lds
    v_fmac_f32 v28, s58, v30
    v_mfma_f32_32x32x16_bf16 a[0:15], v[176:179], a[72:75], a[0:15]
    ds_read_b128 a[68:71], v5 offset:20480
    ds_read_b64_tr_b16 a[180:181], v57 offset:12288
    v_fmac_f32 v29, s58, v31
    v_fma_f32 v28, v28, v43, v17
    v_fma_f32 v29, v29, v43, v17
    v_cvt_pk_bf16_f32 v183, v28, v29
    v_mfma_f32_32x32x16_bf16 a[32:47], v[176:179], a[76:79], a[32:47]
    ds_read_b128 a[72:75], v5 offset:24576
    v_lshlrev_b32 v24, 16, v184
    v_and_b32 v25, s76, v184
    v_lshlrev_b32 v26, 16, v248
    v_and_b32 v27, s76, v248
    s_waitcnt lgkmcnt(5)
    v_mfma_f32_32x32x16_bf16 v[64:79], v[180:183], a[80:83], v[64:79]
    ds_read_b128 a[76:79], v5 offset:28672
    ds_read_b64_tr_b16 a[182:183], v57 offset:13312
    v_fmac_f32 v24, s58, v26
    v_fmac_f32 v25, s58, v27
    v_fma_f32 v24, v24, v43, v17
    v_fma_f32 v25, v25, v43, v17
    v_mfma_f32_32x32x16_bf16 v[96:111], v[180:183], a[84:87], v[96:111]
    ds_read_b128 a[80:83], v6 offset:16384
    v_cvt_pk_bf16_f32 v184, v24, v25
    v_lshlrev_b32 v28, 16, v185
    v_and_b32 v29, s76, v185
    v_lshlrev_b32 v30, 16, v249
    v_and_b32 v31, s76, v249
    v_mfma_f32_32x32x16_bf16 a[0:15], v[180:183], a[88:91], a[0:15]
    ds_read_b128 a[84:87], v6 offset:20480
    ds_read_b64_tr_b16 a[184:185], v15 offset:12288
    v_fmac_f32 v28, s58, v30
    v_fmac_f32 v29, s58, v31
    v_fma_f32 v28, v28, v43, v17
    v_fma_f32 v29, v29, v43, v17
    v_cvt_pk_bf16_f32 v185, v28, v29
    v_lshlrev_b32 v24, 16, v186
    v_and_b32 v25, s76, v186
    v_lshlrev_b32 v26, 16, v250
    v_and_b32 v27, s76, v250
    v_fmac_f32 v24, s58, v26
    v_fmac_f32 v25, s58, v27
    v_fma_f32 v24, v24, v43, v17
    v_fma_f32 v25, v25, v43, v17
    v_cvt_pk_bf16_f32 v186, v24, v25
    v_lshlrev_b32 v28, 16, v187
    v_and_b32 v29, s76, v187
    v_lshlrev_b32 v30, 16, v251
    v_and_b32 v31, s76, v251
    v_fmac_f32 v28, s58, v30
    v_fmac_f32 v29, s58, v31
    v_fma_f32 v28, v28, v43, v17
    v_fma_f32 v29, v29, v43, v17
    v_cvt_pk_bf16_f32 v187, v28, v29
    v_mfma_f32_32x32x16_bf16 a[32:47], v[180:183], a[92:95], a[32:47]
    ds_read_b128 a[88:91], v6 offset:24576
    v_lshlrev_b32 v24, 16, v188
    v_and_b32 v25, s76, v188
    v_lshlrev_b32 v26, 16, v252
    v_and_b32 v27, s76, v252
    s_waitcnt lgkmcnt(5)
    v_mfma_f32_32x32x16_bf16 v[64:79], v[184:187], a[64:67], v[64:79]
    ds_read_b128 a[92:95], v6 offset:28672
    ds_read_b64_tr_b16 a[186:187], v15 offset:13312
    v_fmac_f32 v24, s58, v26
    v_fmac_f32 v25, s58, v27
    v_fma_f32 v24, v24, v43, v17
    v_fma_f32 v25, v25, v43, v17
    v_mfma_f32_32x32x16_bf16 v[96:111], v[184:187], a[68:71], v[96:111]
    s_barrier
    s_mov_b32 s79, 60000
L_tag_16:
    v_readfirstlane_b32 s75, v63
    s_nop 0
    s_cmp_lg_u32 s75, 0
    s_cbranch_scc1 L_tagd_17
    s_sub_u32 s79, s79, 1
    s_cbranch_scc1 L_tagd_17
    s_sleep 8
    buffer_load_dword v63, off, s[36:39], 0 sc1
    s_waitcnt vmcnt(0)
    s_branch L_tag_16
L_tagd_17:
    ds_read_b128 a[64:67], v3 offset:32768
    v_mfma_f32_32x32x16_bf16 a[0:15], v[184:187], a[72:75], a[0:15]
    ds_read_b128 a[68:71], v3 offset:36864
    ds_read_b64_tr_b16 a[188:189], v35 offset:12288
    v_cvt_pk_bf16_f32 v188, v24, v25
    v_lshlrev_b32 v28, 16, v189
    v_and_b32 v29, s76, v189
    v_lshlrev_b32 v30, 16, v253
    v_and_b32 v31, s76, v253
    v_fmac_f32 v28, s58, v30
    v_fmac_f32 v29, s58, v31
    v_fma_f32 v28, v28, v43, v17
    v_fma_f32 v29, v29, v43, v17
    v_cvt_pk_bf16_f32 v189, v28, v29
    v_lshlrev_b32 v24, 16, v190
    v_and_b32 v25, s76, v190
    v_lshlrev_b32 v26, 16, v254
    v_and_b32 v27, s76, v254
    v_fmac_f32 v24, s58, v26
    v_fmac_f32 v25, s58, v27
    v_fma_f32 v24, v24, v43, v17
    v_fma_f32 v25, v25, v43, v17
    v_cvt_pk_bf16_f32 v190, v24, v25
    v_lshlrev_b32 v28, 16, v191
    v_and_b32 v29, s76, v191
    v_lshlrev_b32 v30, 16, v255
    v_and_b32 v31, s76, v255
    v_fmac_f32 v28, s58, v30
    v_fmac_f32 v29, s58, v31
    v_fma_f32 v28, v28, v43, v17
    v_fma_f32 v29, v29, v43, v17
    v_cvt_pk_bf16_f32 v191, v28, v29
    v_mfma_f32_32x32x16_bf16 a[32:47], v[184:187], a[76:79], a[32:47]
    ds_read_b128 a[72:75], v3 offset:40960
    buffer_load_dwordx4 v14, s[16:19], s92 offen offset:1024 lds
    s_waitcnt lgkmcnt(5)
    v_mfma_f32_32x32x16_bf16 v[64:79], v[188:191], a[80:83], v[64:79]
    ds_read_b128 a[76:79], v3 offset:45056
    ds_read_b64_tr_b16 a[190:191], v35 offset:13312
    v_mfma_f32_32x32x16_bf16 v[96:111], v[188:191], a[84:87], v[96:111]
    s_add_u32 m0, s46, 6144
    ds_read_b128 a[80:83], v4 offset:32768
    buffer_load_dwordx4 v13, s[16:19], s93 offen offset:0 lds
    v_mfma_f32_32x32x16_bf16 a[0:15], v[188:191], a[88:91], a[0:15]
    ds_read_b128 a[84:87], v4 offset:36864
    s_waitcnt vmcnt(7)
    ds_read_b64_tr_b16 a[192:193], v56 offset:16384
    v_mfma_f32_32x32x16_bf16 a[32:47], v[188:191], a[92:95], a[32:47]
    ds_read_b128 a[88:91], v4 offset:40960
    buffer_load_dwordx4 v14, s[16:19], s93 offen offset:1024 lds
    s_waitcnt lgkmcnt(5)
    v_mfma_f32_32x32x16_bf16 v[80:95], v[176:179], a[64:67], v[80:95]
    ds_read_b128 a[92:95], v4 offset:45056
    ds_read_b64_tr_b16 a[194:195], v56 offset:17408
    v_mfma_f32_32x32x16_bf16 v[112:127], v[176:179], a[68:71], v[112:127]
    v_add_u32 v13, 0x10000, v13
    v_add_u32 v14, 0x10000, v14
    s_add_u32 m0, s46, 8192
    ds_read_b128 a[64:67], v5 offset:32768
    buffer_load_dwordx4 v13, s[16:19], s80 offen offset:0 lds
    v_mfma_f32_32x32x16_bf16 a[16:31], v[176:179], a[72:75], a[16:31]
    ds_read_b128 a[68:71], v5 offset:36864
    ds_read_b64_tr_b16 a[196:197], v57 offset:16384
    v_mfma_f32_32x32x16_bf16 a[48:63], v[176:179], a[76:79], a[48:63]
    ds_read_b128 a[72:75], v5 offset:40960
    s_waitcnt lgkmcnt(5)
    v_mfma_f32_32x32x16_bf16 v[80:95], v[180:183], a[80:83], v[80:95]
    ds_read_b128 a[76:79], v5 offset:45056
    ds_read_b64_tr_b16 a[198:199], v57 offset:17408
    v_mfma_f32_32x32x16_bf16 v[112:127], v[180:183], a[84:87], v[112:127]
    ds_read_b128 a[80:83], v6 offset:32768
    v_mfma_f32_32x32x16_bf16 a[16:31], v[180:183], a[88:91], a[16:31]
    ds_read_b128 a[84:87], v6 offset:36864
    ds_read_b64_tr_b16 a[200:201], v15 offset:16384
    v_mfma_f32_32x32x16_bf16 a[48:63], v[180:183], a[92:95], a[48:63]
    ds_read_b128 a[88:91], v6 offset:40960
    s_waitcnt lgkmcnt(5)
    v_mfma_f32_32x32x16_bf16 v[80:95], v[184:187], a[64:67], v[80:95]
    ds_read_b128 a[92:95], v6 offset:45056
    ds_read_b64_tr_b16 a[202:203], v15 offset:17408
    v_mfma_f32_32x32x16_bf16 v[112:127], v[184:187], a[68:71], v[112:127]
    v_mfma_f32_32x32x16_bf16 a[16:31], v[184:187], a[72:75], a[16:31]
    ds_read_b64_tr_b16 a[204:205], v35 offset:16384
    v_mfma_f32_32x32x16_bf16 a[48:63], v[184:187], a[76:79], a[48:63]
    s_waitcnt lgkmcnt(2)
    v_mfma_f32_32x32x16_bf16 v[80:95], v[188:191], a[80:83], v[80:95]
    ds_read_b64_tr_b16 a[206:207], v35 offset:17408
    v_mfma_f32_32x32x16_bf16 v[112:127], v[188:191], a[84:87], v[112:127]
    v_mfma_f32_32x32x16_bf16 a[16:31], v[188:191], a[88:91], a[16:31]
    v_mfma_f32_32x32x16_bf16 a[48:63], v[188:191], a[92:95], a[48:63]
    v_pk_add_f32 v[24:25], v[64:65], v[68:69]
    v_pk_add_f32 v[26:27], v[64:65], v[68:69] neg_lo:[0,1] neg_hi:[0,1]
    v_cvt_pk_bf16_f32 v128, v24, v25
    v_cvt_pk_bf16_f32 v132, v26, v27
    v_pk_add_f32 v[24:25], v[66:67], v[70:71]
    v_pk_add_f32 v[26:27], v[66:67], v[70:71] neg_lo:[0,1] neg_hi:[0,1]
    v_cvt_pk_bf16_f32 v129, v24, v25
    v_cvt_pk_bf16_f32 v133, v26, v27
    v_pk_add_f32 v[24:25], v[72:73], v[76:77]
    v_pk_add_f32 v[26:27], v[72:73], v[76:77] neg_lo:[0,1] neg_hi:[0,1]
    v_cvt_pk_bf16_f32 v130, v24, v25
    v_cvt_pk_bf16_f32 v134, v26, v27
    v_pk_add_f32 v[24:25], v[74:75], v[78:79]
    v_pk_add_f32 v[26:27], v[74:75], v[78:79] neg_lo:[0,1] neg_hi:[0,1]
    v_cvt_pk_bf16_f32 v131, v24, v25
    v_cvt_pk_bf16_f32 v135, v26, v27
    ds_write_b128 v1, v[128:131] offset:0
    ds_write_b128 v1, v[132:135] offset:1024
    v_pk_add_f32 v[24:25], v[96:97], v[100:101]
    v_pk_add_f32 v[26:27], v[96:97], v[100:101] neg_lo:[0,1] neg_hi:[0,1]
    v_cvt_pk_bf16_f32 v128, v24, v25
    v_cvt_pk_bf16_f32 v132, v26, v27
    v_pk_add_f32 v[24:25], v[98:99], v[102:103]
    v_pk_add_f32 v[26:27], v[98:99], v[102:103] neg_lo:[0,1] neg_hi:[0,1]
    v_cvt_pk_bf16_f32 v129, v24, v25
    v_cvt_pk_bf16_f32 v133, v26, v27
    v_pk_add_f32 v[24:25], v[104:105], v[108:109]
    v_pk_add_f32 v[26:27], v[104:105], v[108:109] neg_lo:[0,1] neg_hi:[0,1]
    v_cvt_pk_bf16_f32 v130, v24, v25
    v_cvt_pk_bf16_f32 v134, v26, v27
    v_pk_add_f32 v[24:25], v[106:107], v[110:111]
    v_pk_add_f32 v[26:27], v[106:107], v[110:111] neg_lo:[0,1] neg_hi:[0,1]
    v_cvt_pk_bf16_f32 v131, v24, v25
    v_cvt_pk_bf16_f32 v135, v26, v27
    ds_write_b128 v1, v[128:131] offset:16384
    ds_write_b128 v1, v[132:135] offset:17408
    s_nop 7
    v_pk_add_f32 v[24:25], v[80:81], v[84:85]
    v_pk_add_f32 v[26:27], v[80:81], v[84:85] neg_lo:[0,1] neg_hi:[0,1]
    v_cvt_pk_bf16_f32 v136, v24, v25
    v_cvt_pk_bf16_f32 v140, v26, v27
    v_pk_add_f32 v[24:25], v[82:83], v[86:87]
    v_pk_add_f32 v[26:27], v[82:83], v[86:87] neg_lo:[0,1] neg_hi:[0,1]
    v_cvt_pk_bf16_f32 v137, v24, v25
    v_cvt_pk_bf16_f32 v141, v26, v27
    v_pk_add_f32 v[24:25], v[88:89], v[92:93]
    v_pk_add_f32 v[26:27], v[88:89], v[92:93] neg_lo:[0,1] neg_hi:[0,1]
    v_cvt_pk_bf16_f32 v138, v24, v25
    v_cvt_pk_bf16_f32 v142, v26, v27
    v_pk_add_f32 v[24:25], v[90:91], v[94:95]
    v_pk_add_f32 v[26:27], v[90:91], v[94:95] neg_lo:[0,1] neg_hi:[0,1]
    v_cvt_pk_bf16_f32 v139, v24, v25
    v_cvt_pk_bf16_f32 v143, v26, v27
    ds_write_b128 v1, v[136:139] offset:8192
    ds_write_b128 v1, v[140:143] offset:9216
    v_pk_add_f32 v[24:25], v[112:113], v[116:117]
    v_pk_add_f32 v[26:27], v[112:113], v[116:117] neg_lo:[0,1] neg_hi:[0,1]
    v_cvt_pk_bf16_f32 v136, v24, v25
    v_cvt_pk_bf16_f32 v140, v26, v27
    v_pk_add_f32 v[24:25], v[114:115], v[118:119]
    v_pk_add_f32 v[26:27], v[114:115], v[118:119] neg_lo:[0,1] neg_hi:[0,1]
    v_cvt_pk_bf16_f32 v137, v24, v25
    v_cvt_pk_bf16_f32 v141, v26, v27
    v_pk_add_f32 v[24:25], v[120:121], v[124:125]
    v_pk_add_f32 v[26:27], v[120:121], v[124:125] neg_lo:[0,1] neg_hi:[0,1]
    v_cvt_pk_bf16_f32 v138, v24, v25
    v_cvt_pk_bf16_f32 v142, v26, v27
    v_pk_add_f32 v[24:25], v[122:123], v[126:127]
    v_pk_add_f32 v[26:27], v[122:123], v[126:127] neg_lo:[0,1] neg_hi:[0,1]
    v_cvt_pk_bf16_f32 v139, v24, v25
    v_cvt_pk_bf16_f32 v143, v26, v27
    ds_write_b128 v1, v[136:139] offset:24576
    ds_write_b128 v1, v[140:143] offset:25600
    s_waitcnt lgkmcnt(0)
    s_barrier
    ds_read_b128 a[64:67], v2 offset:0
    ds_read_b128 a[68:71], v2 offset:8192
    ds_read_b128 a[72:75], v2 offset:2048
    ds_read_b128 a[76:79], v2 offset:10240
    s_waitcnt lgkmcnt(2)
    v_mfma_f32_32x32x16_bf16 v[64:79], a[96:99], a[64:67], 0
    buffer_load_dwordx4 v14, s[16:19], s80 offen offset:1024 lds
    v_accvgpr_read_b32 v26, a0
    v_accvgpr_read_b32 v27, a1
    v_accvgpr_read_b32 v28, a4
    v_accvgpr_read_b32 v29, a5
    v_add_f32 v24, v26, v28
    v_mfma_f32_32x32x16_bf16 v[80:95], a[208:211], a[64:67], 0
    ds_read_b128 a[80:83], v2 offset:4096
    v_add_f32 v25, v27, v29
    v_sub_f32 v26, v26, v28
    v_sub_f32 v27, v27, v29
    v_cvt_pk_bf16_f32 v128, v24, v25
    v_cvt_pk_bf16_f32 v132, v26, v27
    v_accvgpr_read_b32 v26, a2
    v_accvgpr_read_b32 v27, a3
    v_mfma_f32_32x32x16_bf16 v[96:111], a[208:211], a[68:71], 0
    s_add_u32 m0, s46, 10240
    s_nop 0
    buffer_load_dwordx4 v13, s[16:19], s81 offen offset:0 lds
    v_accvgpr_read_b32 v28, a6
    v_accvgpr_read_b32 v29, a7
    v_add_f32 v24, v26, v28
    v_mfma_f32_32x32x16_bf16 v[112:127], a[96:99], a[68:71], 0
    ds_read_b128 a[84:87], v2 offset:12288
    v_add_f32 v25, v27, v29
    v_sub_f32 v26, v26, v28
    v_sub_f32 v27, v27, v29
    v_cvt_pk_bf16_f32 v129, v24, v25
    v_cvt_pk_bf16_f32 v133, v26, v27
    v_accvgpr_read_b32 v26, a8
    s_waitcnt lgkmcnt(2)
    v_mfma_f32_32x32x16_bf16 v[64:79], a[100:103], a[72:75], v[64:79]
    buffer_load_dwordx4 v14, s[16:19], s81 offen offset:1024 lds
    v_accvgpr_read_b32 v27, a9
    v_accvgpr_read_b32 v28, a12
    v_accvgpr_read_b32 v29, a13
    v_add_f32 v24, v26, v28
    v_add_f32 v25, v27, v29
    v_mfma_f32_32x32x16_bf16 v[80:95], a[212:215], a[72:75], v[80:95]
    ds_read_b128 a[88:91], v2 offset:6144
    v_sub_f32 v26, v26, v28
    v_sub_f32 v27, v27, v29
    v_cvt_pk_bf16_f32 v130, v24, v25
    v_cvt_pk_bf16_f32 v134, v26, v27
    v_accvgpr_read_b32 v26, a10
    v_accvgpr_read_b32 v27, a11
    v_accvgpr_read_b32 v28, a14
    v_mfma_f32_32x32x16_bf16 v[96:111], a[212:215], a[76:79], v[96:111]
    s_add_u32 m0, s46, 12288
    s_nop 0
    buffer_load_dwordx4 v13, s[16:19], s82 offen offset:0 lds
    v_accvgpr_read_b32 v29, a15
    v_add_f32 v24, v26, v28
    v_add_f32 v25, v27, v29
    v_mfma_f32_32x32x16_bf16 v[112:127], a[100:103], a[76:79], v[112:127]
    ds_read_b128 a[92:95], v2 offset:14336
    v_sub_f32 v26, v26, v28
    v_sub_f32 v27, v27, v29
    v_cvt_pk_bf16_f32 v131, v24, v25
    v_cvt_pk_bf16_f32 v135, v26, v27
    s_waitcnt lgkmcnt(2)
    v_mfma_f32_32x32x16_bf16 v[64:79], a[104:107], a[80:83], v[64:79]
    buffer_load_dwordx4 v14, s[16:19], s82 offen offset:1024 lds
    ds_write_b128 v23, v[128:131] offset:0
    v_mfma_f32_32x32x16_bf16 v[80:95], a[216:219], a[80:83], v[80:95]
    ds_read_b128 a[64:67], v2 offset:16384
    ds_write_b128 v23, v[132:135] offset:1024
    v_accvgpr_read_b32 v26, a16
    v_accvgpr_read_b32 v27, a17
    v_accvgpr_read_b32 v28, a20
    v_accvgpr_read_b32 v29, a21
    v_mfma_f32_32x32x16_bf16 v[96:111], a[216:219], a[84:87], v[96:111]
    s_add_u32 m0, s46, 14336
    s_nop 0
    buffer_load_dwordx4 v13, s[16:19], s83 offen offset:0 lds
    v_add_f32 v24, v26, v28
    v_add_f32 v25, v27, v29
    v_sub_f32 v26, v26, v28
    v_mfma_f32_32x32x16_bf16 v[112:127], a[104:107], a[84:87], v[112:127]
    ds_read_b128 a[68:71], v2 offset:24576
    v_sub_f32 v27, v27, v29
    v_cvt_pk_bf16_f32 v136, v24, v25
    v_cvt_pk_bf16_f32 v140, v26, v27
    v_accvgpr_read_b32 v26, a18
    v_accvgpr_read_b32 v27, a19
    v_accvgpr_read_b32 v28, a22
    s_waitcnt lgkmcnt(4)
    v_mfma_f32_32x32x16_bf16 v[64:79], a[108:111], a[88:91], v[64:79]
    buffer_load_dwordx4 v14, s[16:19], s83 offen offset:1024 lds
    v_accvgpr_read_b32 v29, a23
    v_add_f32 v24, v26, v28
    v_add_f32 v25, v27, v29
    v_sub_f32 v26, v26, v28
    v_sub_f32 v27, v27, v29
    v_mfma_f32_32x32x16_bf16 v[80:95], a[220:223], a[88:91], v[80:95]
    ds_read_b128 a[72:75], v2 offset:18432
    v_cvt_pk_bf16_f32 v137, v24, v25
    v_cvt_pk_bf16_f32 v141, v26, v27
    v_accvgpr_read_b32 v26, a24
    v_accvgpr_read_b32 v27, a25
    v_accvgpr_read_b32 v28, a28
    v_accvgpr_read_b32 v29, a29
    v_add_f32 v24, v26, v28
    v_mfma_f32_32x32x16_bf16 v[96:111], a[220:223], a[92:95], v[96:111]
    s_add_u32 m0, s46, 16384
    s_nop 0
    buffer_load_dwordx4 v13, s[16:19], s84 offen offset:0 lds
    v_add_f32 v25, v27, v29
    v_sub_f32 v26, v26, v28
    v_sub_f32 v27, v27, v29
    v_mfma_f32_32x32x16_bf16 v[112:127], a[108:111], a[92:95], v[112:127]
    ds_read_b128 a[76:79], v2 offset:26624
    v_cvt_pk_bf16_f32 v138, v24, v25
    v_cvt_pk_bf16_f32 v142, v26, v27
    v_accvgpr_read_b32 v26, a26
    v_accvgpr_read_b32 v27, a27
    v_accvgpr_read_b32 v28, a30
    v_accvgpr_read_b32 v29, a31
    s_waitcnt lgkmcnt(2)
    v_mfma_f32_32x32x16_bf16 v[152:167], a[96:99], a[64:67], 0
    buffer_load_dwordx4 v14, s[16:19], s84 offen offset:1024 lds
    v_add_f32 v24, v26, v28
    v_add_f32 v25, v27, v29
    v_sub_f32 v26, v26, v28
    v_sub_f32 v27, v27, v29
    v_cvt_pk_bf16_f32 v139, v24, v25
    v_mfma_f32_32x32x16_bf16 v[168:183], a[208:211], a[64:67], 0
    ds_read_b128 a[80:83], v2 offset:20480
    v_cvt_pk_bf16_f32 v143, v26, v27
    ds_write_b128 v23, v[136:139] offset:8192
    ds_write_b128 v23, v[140:143] offset:9216
    v_mfma_f32_32x32x16_bf16 v[184:199], a[208:211], a[68:71], 0
    s_add_u32 m0, s46, 18432
    s_nop 0
    buffer_load_dwordx4 v13, s[16:19], s85 offen offset:0 lds
    v_accvgpr_read_b32 v26, a32
    v_accvgpr_read_b32 v27, a33
    v_accvgpr_read_b32 v28, a36
    v_mfma_f32_32x32x16_bf16 v[168:183], a[96:99], a[68:71], v[168:183]
    ds_read_b128 a[84:87], v2 offset:28672
    v_accvgpr_read_b32 v29, a37
    v_add_f32 v24, v26, v28
    v_add_f32 v25, v27, v29
    v_sub_f32 v26, v26, v28
    v_sub_f32 v27, v27, v29
    v_cvt_pk_bf16_f32 v128, v24, v25
    s_waitcnt lgkmcnt(4)
    v_mfma_f32_32x32x16_bf16 v[152:167], a[100:103], a[72:75], v[152:167]
    buffer_load_dwordx4 v14, s[16:19], s85 offen offset:1024 lds
    v_cvt_pk_bf16_f32 v132, v26, v27
    v_accvgpr_read_b32 v26, a34
    v_accvgpr_read_b32 v27, a35
    v_accvgpr_read_b32 v28, a38
    v_accvgpr_read_b32 v29, a39
    v_mfma_f32_32x32x16_bf16 v[168:183], a[212:215], a[72:75], v[168:183]
    ds_read_b128 a[88:91], v2 offset:22528
    v_add_f32 v24, v26, v28
    v_add_f32 v25, v27, v29
    v_sub_f32 v26, v26, v28
    v_sub_f32 v27, v27, v29
    v_cvt_pk_bf16_f32 v129, v24, v25
    v_cvt_pk_bf16_f32 v133, v26, v27
    v_accvgpr_read_b32 v26, a40
    v_mfma_f32_32x32x16_bf16 v[184:199], a[212:215], a[76:79], v[184:199]
    v_accvgpr_read_b32 v27, a41
    v_accvgpr_read_b32 v28, a44
    v_accvgpr_read_b32 v29, a45
    v_add_f32 v24, v26, v28
    v_add_f32 v25, v27, v29
    v_sub_f32 v26, v26, v28
    v_sub_f32 v27, v27, v29
    v_cvt_pk_bf16_f32 v130, v24, v25
    v_mfma_f32_32x32x16_bf16 v[168:183], a[100:103], a[76:79], v[168:183]
    ds_read_b128 a[92:95], v2 offset:30720
    v_cvt_pk_bf16_f32 v134, v26, v27
    v_accvgpr_read_b32 v26, a42
    v_accvgpr_read_b32 v27, a43
    v_accvgpr_read_b32 v28, a46
    v_accvgpr_read_b32 v29, a47
    v_add_f32 v24, v26, v28
    s_waitcnt lgkmcnt(2)
    v_mfma_f32_32x32x16_bf16 v[152:167], a[104:107], a[80:83], v[152:167]
    v_add_f32 v25, v27, v29
    v_sub_f32 v26, v26, v28
    v_sub_f32 v27, v27, v29
    v_cvt_pk_bf16_f32 v131, v24, v25
    v_cvt_pk_bf16_f32 v135, v26, v27
    ds_write_b128 v23, v[128:131] offset:16384
    v_mfma_f32_32x32x16_bf16 v[168:183], a[216:219], a[80:83], v[168:183]
    ds_write_b128 v23, v[132:135] offset:17408
    v_accvgpr_read_b32 v26, a48
    v_accvgpr_read_b32 v27, a49
    v_accvgpr_read_b32 v28, a52
    v_accvgpr_read_b32 v29, a53
    v_add_f32 v24, v26, v28
    v_add_f32 v25, v27, v29
    v_sub_f32 v26, v26, v28
    v_sub_f32 v27, v27, v29
    v_cvt_pk_bf16_f32 v136, v24, v25
    v_cvt_pk_bf16_f32 v140, v26, v27
    v_accvgpr_read_b32 v26, a50
    v_accvgpr_read_b32 v27, a51
    v_accvgpr_read_b32 v28, a54
    v_accvgpr_read_b32 v29, a55
    v_add_f32 v24, v26, v28
    v_add_f32 v25, v27, v29
    v_sub_f32 v26, v26, v28
    v_sub_f32 v27, v27, v29
    v_cvt_pk_bf16_f32 v137, v24, v25
    v_cvt_pk_bf16_f32 v141, v26, v27
    v_accvgpr_read_b32 v26, a56
    v_accvgpr_read_b32 v27, a57
    v_accvgpr_read_b32 v28, a60
    v_accvgpr_read_b32 v29, a61
    v_add_f32 v24, v26, v28
    v_add_f32 v25, v27, v29
    v_sub_f32 v26, v26, v28
    v_sub_f32 v27, v27, v29
    v_cvt_pk_bf16_f32 v138, v24, v25
    v_cvt_pk_bf16_f32 v142, v26, v27
    v_accvgpr_read_b32 v26, a58
    v_accvgpr_read_b32 v27, a59
    v_accvgpr_read_b32 v28, a62
    v_accvgpr_read_b32 v29, a63
    v_add_f32 v24, v26, v28
    v_add_f32 v25, v27, v29
    v_sub_f32 v26, v26, v28
    v_sub_f32 v27, v27, v29
    v_cvt_pk_bf16_f32 v139, v24, v25
    v_cvt_pk_bf16_f32 v143, v26, v27
    ds_write_b128 v23, v[136:139] offset:24576
    ds_write_b128 v23, v[140:143] offset:25600
    s_waitcnt lgkmcnt(0)
    s_barrier
    ds_read_b128 a[64:67], v22 offset:0
    s_waitcnt vmcnt(16)
    ds_read_b64_tr_b16 a[0:1], v56 offset:0
    v_mfma_f32_32x32x16_bf16 v[184:199], a[216:219], a[84:87], v[184:199]
    ds_read_b64_tr_b16 a[2:3], v56 offset:1024
    s_lshl_b32 s61, s78, 8
    s_add_u32 s61, s61, 0x1000
    s_lshl_b32 s94, s78, 1
    s_add_u32 s94, s94, s72
    s_mul_i32 s94, s94, 229376
    s_lshl_b32 s96, s73, 3
    s_sub_u32 s94, s94, s96
    v_mfma_f32_32x32x16_bf16 v[168:183], a[104:107], a[84:87], v[168:183]
    ds_read_b128 a[68:71], v22 offset:8192
    ds_read_b64_tr_b16 a[4:5], v57 offset:0
    s_add_u32 s59, s94, 0x20000
    s_lshl_b32 s47, s68, 12
    s_mov_b32 s64, 1.0
    s_mov_b32 s65, 1.0
    v_add_u32 v16, 113664, v62
    v_mfma_f32_32x32x16_bf16 v[152:167], a[108:111], a[88:91], v[152:167]
    ds_read_b64_tr_b16 a[6:7], v57 offset:1024
    v_and_b32 v58, 0xf0, v62
    v_bfe_u32 v59, v0, 4, 1
    v_lshl_add_u32 v58, v59, 9, v58
    v_lshrrev_b32 v59, 5, v0
    v_lshl_add_u32 v58, v59, 11, v58
    s_add_u32 s94, s47, 0x4000
    v_add_u32 v58, s94, v58
    v_mfma_f32_32x32x16_bf16 v[168:183], a[220:223], a[88:91], v[168:183]
    ds_read_b128 a[72:75], v22 offset:2048
    ds_read_b64_tr_b16 a[8:9], v15 offset:0
    v_min_u32 v59, 13, v0
    v_lshlrev_b32 v59, 2, v59
    s_lshl_b32 s60, s69, 17
    s_lshl_b32 s94, s68, 7
    s_add_u32 s60, s60, s94
    s_add_u32 s60, s60, 0xc00000
    v_mfma_f32_32x32x16_bf16 v[184:199], a[220:223], a[92:95], v[184:199]
    ds_read_b64_tr_b16 a[10:11], v15 offset:1024
    s_add_u32 s94, s94, 0x8000
    v_lshrrev_b32 v48, 5, v0
    v_lshlrev_b32 v50, 30, v48
    v_lshlrev_b32 v48, 4, v48
    v_add_u32 v48, s94, v48
    v_and_b32 v49, 31, v0
    v_lshl_add_u32 v50, v49, 2, v50
    v_mfma_f32_32x32x16_bf16 v[168:183], a[108:111], a[92:95], v[168:183]
    ds_read_b128 a[76:79], v22 offset:10240
    ds_read_b64_tr_b16 a[12:13], v35 offset:0
    v_lshlrev_b32 v49, 2, v49
    v_add_u32 v49, s94, v49
    s_mov_b32 s40, 1
    s_mov_b32 s41, 1
    s_lshl_b32 s94, s51, 30
    s_waitcnt lgkmcnt(7)
    v_mfma_f32_32x32x16_bf16 v[200:215], a[96:99], a[64:67], 0
    ds_read_b64_tr_b16 a[14:15], v35 offset:1024
    v_add_u32 v50, s94, v50
    v_cvt_pk_bf16_f32 v24, v112, v96
    v_cndmask_b32 v112, v112, 0, s[42:43]
    v_cndmask_b32 v96, v96, 0, s[42:43]
    v_add_f32 v80, v80, v112
    v_sub_f32 v64, v64, v96
    s_add_u32 s97, s52, 0
    v_mfma_f32_32x32x16_bf16 v[216:231], a[208:211], a[64:67], 0
    ds_read_b128 a[80:83], v22 offset:4096
    s_waitcnt vmcnt(12)
    ds_read_b64_tr_b16 a[16:17], v56 offset:4096
    v_cvt_pk_bf16_f32 v144, v64, v80
    buffer_store_dword v144, v37, s[20:23], s97 offen offset:0 sc1
    v_cvt_pk_bf16_f32 v25, v113, v97
    v_cndmask_b32 v113, v113, 0, s[42:43]
    v_mfma_f32_32x32x16_bf16 v[232:247], a[208:211], a[68:71], 0
    ds_read_b64_tr_b16 a[18:19], v56 offset:5120
    v_cndmask_b32 v97, v97, 0, s[42:43]
    v_add_f32 v81, v81, v113
    v_sub_f32 v65, v65, v97
    v_cvt_pk_bf16_f32 v145, v65, v81
    buffer_store_dword v145, v37, s[20:23], s97 offen offset:1024 sc1
    v_cvt_pk_bf16_f32 v26, v114, v98
    v_mfma_f32_32x32x16_bf16 v[216:231], a[96:99], a[68:71], v[216:231]
    ds_read_b128 a[84:87], v22 offset:12288
    ds_read_b64_tr_b16 a[20:21], v57 offset:4096
    v_cndmask_b32 v114, v114, 0, s[42:43]
    v_cndmask_b32 v98, v98, 0, s[42:43]
    v_add_f32 v82, v82, v114
    v_sub_f32 v66, v66, v98
    v_cvt_pk_bf16_f32 v146, v66, v82
    s_waitcnt lgkmcnt(7)
    v_mfma_f32_32x32x16_bf16 v[200:215], a[100:103], a[72:75], v[200:215]
    ds_read_b64_tr_b16 a[22:23], v57 offset:5120
    buffer_store_dword v146, v37, s[20:23], s97 offen offset:2048 sc1
    v_cvt_pk_bf16_f32 v27, v115, v99
    v_cndmask_b32 v115, v115, 0, s[42:43]
    v_cndmask_b32 v99, v99, 0, s[42:43]
    v_add_f32 v83, v83, v115
    v_mfma_f32_32x32x16_bf16 v[216:231], a[212:215], a[72:75], v[216:231]
    ds_read_b128 a[88:91], v22 offset:6144
    ds_read_b64_tr_b16 a[24:25], v15 offset:4096
    s_mov_b64 exec, s[40:41]
    ds_write_b128 v48, v[24:27] offset:0
    s_mov_b64 exec, -1
    v_sub_f32 v67, v67, v99
    v_cvt_pk_bf16_f32 v147, v67, v83
    v_mfma_f32_32x32x16_bf16 v[232:247], a[212:215], a[76:79], v[232:247]
    ds_read_b64_tr_b16 a[26:27], v15 offset:5120
    buffer_store_dword v147, v37, s[20:23], s97 offen offset:3072 sc1
    v_cvt_pk_bf16_f32 v24, v116, v100
    v_cndmask_b32 v116, v116, 0, s[42:43]
    v_cndmask_b32 v100, v100, 0, s[42:43]
    v_add_f32 v84, v84, v116
    v_sub_f32 v68, v68, v100
    v_mfma_f32_32x32x16_bf16 v[216:231], a[100:103], a[76:79], v[216:231]
    ds_read_b128 a[92:95], v22 offset:14336
    ds_read_b64_tr_b16 a[28:29], v35 offset:4096
    s_add_u32 s97, s52, 8192
    v_cvt_pk_bf16_f32 v148, v68, v84
    buffer_store_dword v148, v37, s[20:23], s97 offen offset:0 sc1
    v_cvt_pk_bf16_f32 v25, v117, v101
    s_waitcnt lgkmcnt(8)
    v_mfma_f32_32x32x16_bf16 v[200:215], a[104:107], a[80:83], v[200:215]
    s_add_u32 m0, s46, 0
    s_nop 0
    buffer_load_dwordx4 v13, s[16:19], s86 offen offset:0 lds
    ds_read_b64_tr_b16 a[30:31], v35 offset:5120
    v_cndmask_b32 v117, v117, 0, s[42:43]
    v_cndmask_b32 v101, v101, 0, s[42:43]
    v_mfma_f32_32x32x16_bf16 v[216:231], a[216:219], a[80:83], v[216:231]
    ds_read_b128 a[64:67], v22 offset:16384
    s_waitcnt vmcnt(14)
    ds_read_b64_tr_b16 a[32:33], v56 offset:8192
    v_add_f32 v85, v85, v117
    v_sub_f32 v69, v69, v101
    v_cvt_pk_bf16_f32 v149, v69, v85
    buffer_store_dword v149, v37, s[20:23], s97 offen offset:1024 sc1
    v_mfma_f32_32x32x16_bf16 v[232:247], a[216:219], a[84:87], v[232:247]
    buffer_load_dwordx4 v14, s[16:19], s86 offen offset:1024 lds
    ds_read_b64_tr_b16 a[34:35], v56 offset:9216
    v_cvt_pk_bf16_f32 v26, v118, v102
    v_cndmask_b32 v118, v118, 0, s[42:43]
    v_cndmask_b32 v102, v102, 0, s[42:43]
    v_add_f32 v86, v86, v118
    v_mfma_f32_32x32x16_bf16 v[216:231], a[104:107], a[84:87], v[216:231]
    ds_read_b128 a[68:71], v22 offset:24576
    ds_read_b64_tr_b16 a[36:37], v57 offset:8192
    v_sub_f32 v70, v70, v102
    v_cvt_pk_bf16_f32 v150, v70, v86
    buffer_store_dword v150, v37, s[20:23], s97 offen offset:2048 sc1
    v_cvt_pk_bf16_f32 v27, v119, v103
    s_waitcnt lgkmcnt(7)
    v_mfma_f32_32x32x16_bf16 v[200:215], a[108:111], a[88:91], v[200:215]
    s_add_u32 m0, s46, 2048
    s_nop 0
    buffer_load_dwordx4 v13, s[16:19], s87 offen offset:0 lds
    ds_read_b64_tr_b16 a[38:39], v57 offset:9216
    v_cndmask_b32 v119, v119, 0, s[42:43]
    v_cndmask_b32 v103, v103, 0, s[42:43]
    v_mfma_f32_32x32x16_bf16 v[216:231], a[220:223], a[88:91], v[216:231]
    ds_read_b128 a[72:75], v22 offset:18432
    ds_read_b64_tr_b16 a[40:41], v15 offset:8192
    v_add_f32 v87, v87, v119
    s_mov_b64 exec, s[40:41]
    ds_write_b128 v48, v[24:27] offset:32
    s_mov_b64 exec, -1
    v_sub_f32 v71, v71, v103
    v_mfma_f32_32x32x16_bf16 v[232:247], a[220:223], a[92:95], v[232:247]
    buffer_load_dwordx4 v14, s[16:19], s87 offen offset:1024 lds
    ds_read_b64_tr_b16 a[42:43], v15 offset:9216
    v_cvt_pk_bf16_f32 v151, v71, v87
    buffer_store_dword v151, v37, s[20:23], s97 offen offset:3072 sc1
    v_cvt_pk_bf16_f32 v24, v120, v104
    v_cndmask_b32 v120, v120, 0, s[42:43]
    v_cndmask_b32 v104, v104, 0, s[42:43]
    v_add_f32 v88, v88, v120
    v_sub_f32 v72, v72, v104
    s_add_u32 s97, s52, 16384
    v_cvt_pk_bf16_f32 v144, v72, v88
    buffer_store_dword v144, v37, s[20:23], s97 offen offset:0 sc1
    v_cvt_pk_bf16_f32 v25, v121, v105
    v_cndmask_b32 v121, v121, 0, s[42:43]
    v_cndmask_b32 v105, v105, 0, s[42:43]
    v_add_f32 v89, v89, v121
    v_sub_f32 v73, v73, v105
    v_cvt_pk_bf16_f32 v145, v73, v89
    buffer_store_dword v145, v37, s[20:23], s97 offen offset:1024 sc1
    v_cvt_pk_bf16_f32 v26, v122, v106
    v_cndmask_b32 v122, v122, 0, s[42:43]
    v_cndmask_b32 v106, v106, 0, s[42:43]
    v_add_f32 v90, v90, v122
    v_sub_f32 v74, v74, v106
    v_cvt_pk_bf16_f32 v146, v74, v90
    buffer_store_dword v146, v37, s[20:23], s97 offen offset:2048 sc1
    v_cvt_pk_bf16_f32 v27, v123, v107
    v_cndmask_b32 v123, v123, 0, s[42:43]
    v_cndmask_b32 v107, v107, 0, s[42:43]
    v_add_f32 v91, v91, v123
    s_mov_b64 exec, s[40:41]
    ds_write_b128 v48, v[24:27] offset:64
    s_mov_b64 exec, -1
    v_sub_f32 v75, v75, v107
    v_cvt_pk_bf16_f32 v147, v75, v91
    buffer_store_dword v147, v37, s[20:23], s97 offen offset:3072 sc1
    v_cvt_pk_bf16_f32 v24, v124, v108
    v_cndmask_b32 v124, v124, 0, s[42:43]
    v_cndmask_b32 v108, v108, 0, s[42:43]
    v_add_f32 v92, v92, v124
    v_sub_f32 v76, v76, v108
    s_add_u32 s97, s52, 24576
    v_cvt_pk_bf16_f32 v148, v76, v92
    buffer_store_dword v148, v37, s[20:23], s97 offen offset:0 sc1
    v_cvt_pk_bf16_f32 v25, v125, v109
    v_cndmask_b32 v125, v125, 0, s[42:43]
    v_cndmask_b32 v109, v109, 0, s[42:43]
    v_add_f32 v93, v93, v125
    v_sub_f32 v77, v77, v109
    v_cvt_pk_bf16_f32 v149, v77, v93
    buffer_store_dword v149, v37, s[20:23], s97 offen offset:1024 sc1
    v_cvt_pk_bf16_f32 v26, v126, v110
    v_cndmask_b32 v126, v126, 0, s[42:43]
    v_cndmask_b32 v110, v110, 0, s[42:43]
    v_add_f32 v94, v94, v126
    v_sub_f32 v78, v78, v110
    v_cvt_pk_bf16_f32 v150, v78, v94
    buffer_store_dword v150, v37, s[20:23], s97 offen offset:2048 sc1
    v_cvt_pk_bf16_f32 v27, v127, v111
    v_cndmask_b32 v127, v127, 0, s[42:43]
    v_cndmask_b32 v111, v111, 0, s[42:43]
    v_add_f32 v95, v95, v127
    s_mov_b64 exec, s[40:41]
    ds_write_b128 v48, v[24:27] offset:96
    s_mov_b64 exec, -1
    v_sub_f32 v79, v79, v111
    v_cvt_pk_bf16_f32 v151, v79, v95
    buffer_store_dword v151, v37, s[20:23], s97 offen offset:3072 sc1
    v_mfma_f32_32x32x16_bf16 v[216:231], a[108:111], a[92:95], v[216:231]
    ds_read_b128 a[76:79], v22 offset:26624
    s_waitcnt lgkmcnt(9)
    ds_read_b64_tr_b16 a[44:45], v35 offset:8192
    s_waitcnt lgkmcnt(2)
    ds_read_b32 v24, v49
    s_nop 7
    s_nop 7
    v_mfma_f32_32x32x16_bf16 v[64:79], a[96:99], a[64:67], 0
    s_add_u32 m0, s46, 4096
    s_nop 0
    buffer_load_dwordx4 v13, s[16:19], s88 offen offset:0 lds
    ds_read_b64_tr_b16 a[46:47], v35 offset:9216
    v_mfma_f32_32x32x16_bf16 v[80:95], a[208:211], a[64:67], 0
    ds_read_b128 a[80:83], v22 offset:20480
    s_waitcnt vmcnt(25)
    ds_read_b64_tr_b16 a[48:49], v56 offset:12288
    s_waitcnt lgkmcnt(3)
    buffer_store_dword v24, v50, s[20:23], s60 offen sc1
    v_sub_f32 v152, v152, v184
    s_add_u32 s97, s52, 128
    v_mfma_f32_32x32x16_bf16 v[96:111], a[208:211], a[68:71], 0
    buffer_load_dwordx4 v14, s[16:19], s88 offen offset:1024 lds
    ds_read_b64_tr_b16 a[50:51], v56 offset:13312
    v_cvt_pk_bf16_f32 v144, v152, v168
    buffer_store_dword v144, v37, s[20:23], s97 offen offset:0 sc1
    v_sub_f32 v153, v153, v185
    v_mfma_f32_32x32x16_bf16 v[80:95], a[96:99], a[68:71], v[80:95]
    ds_read_b128 a[84:87], v22 offset:28672
    ds_read_b64_tr_b16 a[52:53], v57 offset:12288
    v_cvt_pk_bf16_f32 v145, v153, v169
    buffer_store_dword v145, v37, s[20:23], s97 offen offset:1024 sc1
    v_sub_f32 v154, v154, v186
    v_cvt_pk_bf16_f32 v146, v154, v170
    v_mfma_f32_32x32x16_bf16 v[64:79], a[100:103], a[72:75], v[64:79]
    s_add_u32 m0, s46, 6144
    s_nop 0
    buffer_load_dwordx4 v13, s[16:19], s89 offen offset:0 lds
    ds_read_b64_tr_b16 a[54:55], v57 offset:13312
    buffer_store_dword v146, v37, s[20:23], s97 offen offset:2048 sc1
    v_mfma_f32_32x32x16_bf16 v[80:95], a[212:215], a[72:75], v[80:95]
    ds_read_b128 a[88:91], v22 offset:22528
    ds_read_b64_tr_b16 a[56:57], v15 offset:12288
    v_sub_f32 v155, v155, v187
    v_cvt_pk_bf16_f32 v147, v155, v171
    buffer_store_dword v147, v37, s[20:23], s97 offen offset:3072 sc1
    v_sub_f32 v156, v156, v188
    s_add_u32 s97, s52, 8320
    v_mfma_f32_32x32x16_bf16 v[96:111], a[212:215], a[76:79], v[96:111]
    buffer_load_dwordx4 v14, s[16:19], s89 offen offset:1024 lds
    ds_read_b64_tr_b16 a[58:59], v15 offset:13312
    v_cvt_pk_bf16_f32 v148, v156, v172
    buffer_store_dword v148, v37, s[20:23], s97 offen offset:0 sc1
    v_sub_f32 v157, v157, v189
    v_mfma_f32_32x32x16_bf16 v[80:95], a[100:103], a[76:79], v[80:95]
    ds_read_b128 a[92:95], v22 offset:30720
    ds_read_b64_tr_b16 a[60:61], v35 offset:12288
    v_cvt_pk_bf16_f32 v149, v157, v173
    buffer_store_dword v149, v37, s[20:23], s97 offen offset:1024 sc1
    v_sub_f32 v158, v158, v190
    v_cvt_pk_bf16_f32 v150, v158, v174
    s_waitcnt lgkmcnt(7)
    v_mfma_f32_32x32x16_bf16 v[64:79], a[104:107], a[80:83], v[64:79]
    s_add_u32 m0, s46, 8192
    s_nop 0
    buffer_load_dwordx4 v13, s[16:19], s90 offen offset:0 lds
    ds_read_b64_tr_b16 a[62:63], v35 offset:13312
    buffer_store_dword v150, v37, s[20:23], s97 offen offset:2048 sc1
    v_mfma_f32_32x32x16_bf16 v[80:95], a[216:219], a[80:83], v[80:95]
    v_sub_f32 v159, v159, v191
    v_cvt_pk_bf16_f32 v151, v159, v175
    buffer_store_dword v151, v37, s[20:23], s97 offen offset:3072 sc1
    v_sub_f32 v160, v160, v192
    s_add_u32 s97, s52, 16512
    v_cvt_pk_bf16_f32 v144, v160, v176
    v_mfma_f32_32x32x16_bf16 v[96:111], a[216:219], a[84:87], v[96:111]
    buffer_load_dwordx4 v14, s[16:19], s90 offen offset:1024 lds
    buffer_store_dword v144, v37, s[20:23], s97 offen offset:0 sc1
    v_sub_f32 v161, v161, v193
    v_cvt_pk_bf16_f32 v145, v161, v177
    v_mfma_f32_32x32x16_bf16 v[80:95], a[104:107], a[84:87], v[80:95]
    buffer_store_dword v145, v37, s[20:23], s97 offen offset:1024 sc1
    v_sub_f32 v162, v162, v194
    v_cvt_pk_bf16_f32 v146, v162, v178
    buffer_store_dword v146, v37, s[20:23], s97 offen offset:2048 sc1
    v_sub_f32 v163, v163, v195
    s_waitcnt lgkmcnt(2)
    v_mfma_f32_32x32x16_bf16 v[64:79], a[108:111], a[88:91], v[64:79]
    s_add_u32 m0, s46, 10240
    s_nop 0
    buffer_load_dwordx4 v13, s[16:19], s91 offen offset:0 lds
    v_cvt_pk_bf16_f32 v147, v163, v179
    buffer_store_dword v147, v37, s[20:23], s97 offen offset:3072 sc1
    v_mfma_f32_32x32x16_bf16 v[80:95], a[220:223], a[88:91], v[80:95]
    v_sub_f32 v164, v164, v196
    s_add_u32 s97, s52, 24704
    v_cvt_pk_bf16_f32 v148, v164, v180
    buffer_store_dword v148, v37, s[20:23], s97 offen offset:0 sc1
    v_sub_f32 v165, v165, v197
    v_cvt_pk_bf16_f32 v149, v165, v181
    v_mfma_f32_32x32x16_bf16 v[96:111], a[220:223], a[92:95], v[96:111]
    buffer_load_dwordx4 v14, s[16:19], s91 offen offset:1024 lds
    buffer_store_dword v149, v37, s[20:23], s97 offen offset:1024 sc1
    v_sub_f32 v166, v166, v198
    v_cvt_pk_bf16_f32 v150, v166, v182
    v_mfma_f32_32x32x16_bf16 v[80:95], a[108:111], a[92:95], v[80:95]
    buffer_store_dword v150, v37, s[20:23], s97 offen offset:2048 sc1
    v_sub_f32 v167, v167, v199
    v_cvt_pk_bf16_f32 v151, v167, v183
    buffer_store_dword v151, v37, s[20:23], s97 offen offset:3072 sc1
    v_sub_f32 v200, v200, v232
    s_add_u32 s97, s52, 256
    v_cvt_pk_bf16_f32 v144, v200, v216
    buffer_store_dword v144, v37, s[20:23], s97 offen offset:0 sc1
    v_sub_f32 v201, v201, v233
    v_cvt_pk_bf16_f32 v145, v201, v217
    buffer_store_dword v145, v37, s[20:23], s97 offen offset:1024 sc1
    v_sub_f32 v202, v202, v234
    v_cvt_pk_bf16_f32 v146, v202, v218
    buffer_store_dword v146, v37, s[20:23], s97 offen offset:2048 sc1
    v_sub_f32 v203, v203, v235
    v_cvt_pk_bf16_f32 v147, v203, v219
    buffer_store_dword v147, v37, s[20:23], s97 offen offset:3072 sc1
    v_sub_f32 v204, v204, v236
    s_add_u32 s97, s52, 8448
    v_cvt_pk_bf16_f32 v148, v204, v220
    buffer_store_dword v148, v37, s[20:23], s97 offen offset:0 sc1
    v_sub_f32 v205, v205, v237
    v_cvt_pk_bf16_f32 v149, v205, v221
    buffer_store_dword v149, v37, s[20:23], s97 offen offset:1024 sc1
    v_sub_f32 v206, v206, v238
    v_cvt_pk_bf16_f32 v150, v206, v222
    buffer_store_dword v150, v37, s[20:23], s97 offen offset:2048 sc1
    v_sub_f32 v207, v207, v239
    v_cvt_pk_bf16_f32 v151, v207, v223
    buffer_store_dword v151, v37, s[20:23], s97 offen offset:3072 sc1
    v_sub_f32 v208, v208, v240
    s_add_u32 s97, s52, 16640
    v_cvt_pk_bf16_f32 v144, v208, v224
    buffer_store_dword v144, v37, s[20:23], s97 offen offset:0 sc1
    v_sub_f32 v209, v209, v241
    v_cvt_pk_bf16_f32 v145, v209, v225
    buffer_store_dword v145, v37, s[20:23], s97 offen offset:1024 sc1
    v_sub_f32 v210, v210, v242
    v_cvt_pk_bf16_f32 v146, v210, v226
    buffer_store_dword v146, v37, s[20:23], s97 offen offset:2048 sc1
    v_sub_f32 v211, v211, v243
    v_cvt_pk_bf16_f32 v147, v211, v227
    s_waitcnt vmcnt(49)
    buffer_store_dword v147, v37, s[20:23], s97 offen offset:3072 sc1
    v_sub_f32 v212, v212, v244
    s_add_u32 s97, s52, 24832
    v_cvt_pk_bf16_f32 v148, v212, v228
    buffer_store_dword v148, v37, s[20:23], s97 offen offset:0 sc1
    v_sub_f32 v213, v213, v245
    v_cvt_pk_bf16_f32 v149, v213, v229
    buffer_store_dword v149, v37, s[20:23], s97 offen offset:1024 sc1
    v_sub_f32 v214, v214, v246
    v_cvt_pk_bf16_f32 v150, v214, v230
    buffer_store_dword v150, v37, s[20:23], s97 offen offset:2048 sc1
    v_sub_f32 v215, v215, v247
    v_cvt_pk_bf16_f32 v151, v215, v231
    buffer_store_dword v151, v37, s[20:23], s97 offen offset:3072 sc1
    s_cmp_lg_u32 s68, 0
    s_cbranch_scc1 L_np_18
    buffer_load_dword v63, v59, s[20:23], s61 offen sc1
L_np_18:
    s_nop 8
    v_sub_f32 v64, v64, v96
    s_add_u32 s97, s52, 384
    v_cvt_pk_bf16_f32 v144, v64, v80
    buffer_store_dword v144, v37, s[20:23], s97 offen offset:0 sc1
    v_sub_f32 v65, v65, v97
    v_cvt_pk_bf16_f32 v145, v65, v81
    buffer_store_dword v145, v37, s[20:23], s97 offen offset:1024 sc1
    v_sub_f32 v66, v66, v98
    v_cvt_pk_bf16_f32 v146, v66, v82
    buffer_store_dword v146, v37, s[20:23], s97 offen offset:2048 sc1
    v_sub_f32 v67, v67, v99
    v_cvt_pk_bf16_f32 v147, v67, v83
    buffer_store_dword v147, v37, s[20:23], s97 offen offset:3072 sc1
    v_sub_f32 v68, v68, v100
    s_add_u32 s97, s52, 8576
    v_cvt_pk_bf16_f32 v148, v68, v84
    buffer_store_dword v148, v37, s[20:23], s97 offen offset:0 sc1
    v_sub_f32 v69, v69, v101
    v_cvt_pk_bf16_f32 v149, v69, v85
    buffer_store_dword v149, v37, s[20:23], s97 offen offset:1024 sc1
    v_sub_f32 v70, v70, v102
    v_cvt_pk_bf16_f32 v150, v70, v86
    s_waitcnt vmcnt(49)
    buffer_store_dword v150, v37, s[20:23], s97 offen offset:2048 sc1
    v_sub_f32 v71, v71, v103
    v_cvt_pk_bf16_f32 v151, v71, v87
    buffer_store_dword v151, v37, s[20:23], s97 offen offset:3072 sc1
    v_sub_f32 v72, v72, v104
    s_add_u32 s97, s52, 16768
    v_cvt_pk_bf16_f32 v144, v72, v88
    buffer_store_dword v144, v37, s[20:23], s97 offen offset:0 sc1
    v_sub_f32 v73, v73, v105
    v_cvt_pk_bf16_f32 v145, v73, v89
    buffer_store_dword v145, v37, s[20:23], s97 offen offset:1024 sc1
    v_sub_f32 v74, v74, v106
    v_cvt_pk_bf16_f32 v146, v74, v90
    buffer_store_dword v146, v37, s[20:23], s97 offen offset:2048 sc1
    v_sub_f32 v75, v75, v107
    v_cvt_pk_bf16_f32 v147, v75, v91
    buffer_store_dword v147, v37, s[20:23], s97 offen offset:3072 sc1
    v_sub_f32 v76, v76, v108
    s_add_u32 s97, s52, 24960
    v_cvt_pk_bf16_f32 v148, v76, v92
    buffer_store_dword v148, v37, s[20:23], s97 offen offset:0 sc1
    v_sub_f32 v77, v77, v109
    v_cvt_pk_bf16_f32 v149, v77, v93
    buffer_store_dword v149, v37, s[20:23], s97 offen offset:1024 sc1
    v_sub_f32 v78, v78, v110
    v_cvt_pk_bf16_f32 v150, v78, v94
    buffer_store_dword v150, v37, s[20:23], s97 offen offset:2048 sc1
    v_sub_f32 v79, v79, v111
    v_cvt_pk_bf16_f32 v151, v79, v95
    buffer_store_dword v151, v37, s[20:23], s97 offen offset:3072 sc1
    ds_read_b64_tr_b16 a[64:65], v56 offset:16384
    ds_read_b64_tr_b16 a[66:67], v56 offset:17408
    ds_read_b64_tr_b16 a[68:69], v57 offset:16384
    ds_read_b64_tr_b16 a[70:71], v57 offset:17408
    ds_read_b64_tr_b16 a[72:73], v15 offset:16384
    ds_read_b64_tr_b16 a[74:75], v15 offset:17408
    ds_read_b64_tr_b16 a[76:77], v35 offset:16384
    ds_read_b64_tr_b16 a[78:79], v35 offset:17408
    s_waitcnt lgkmcnt(0)
    s_cmp_lg_u32 s68, 0
    s_cbranch_scc1 L_pj_19
    s_waitcnt vmcnt(16)
    v_cmp_ne_u32 vcc, s75, v63
    s_cbranch_vccz L_pj_19
    s_mov_b32 s79, 60000
    buffer_load_dword v63, v59, s[20:23], s61 offen sc1
    s_sleep 12
    buffer_load_dword v253, v59, s[20:23], s61 offen sc1
    s_sleep 12
    buffer_load_dword v254, v59, s[20:23], s61 offen sc1
L_pl_20:
    s_waitcnt vmcnt(2)
    v_cmp_ne_u32 vcc, s75, v63
    s_cbranch_vccz L_pj_19
    buffer_load_dword v63, v59, s[20:23], s61 offen sc1
    s_waitcnt vmcnt(2)
    v_cmp_ne_u32 vcc, s75, v253
    s_cbranch_vccz L_pj_19
    buffer_load_dword v253, v59, s[20:23], s61 offen sc1
    s_waitcnt vmcnt(2)
    v_cmp_ne_u32 vcc, s75, v254
    s_cbranch_vccz L_pj_19
    buffer_load_dword v254, v59, s[20:23], s61 offen sc1
    s_sub_u32 s79, s79, 1
    s_cbranch_scc0 L_pl_20
L_pj_19:
    s_barrier
    s_lshr_b32 s98, s80, 4
    s_add_u32 s98, s98, s59
    s_add_u32 m0, s47, 16384
    s_nop 0
    buffer_load_dwordx4 v62, s[20:23], s98 offen offset:0 sc1 lds
    s_waitcnt vmcnt(49)
    buffer_load_dwordx4 v16, s[20:23], s98 offen offset:1024 sc1 lds
    s_lshr_b32 s98, s81, 4
    s_add_u32 s98, s98, s59
    s_add_u32 m0, s47, 18432
    s_nop 0
    buffer_load_dwordx4 v62, s[20:23], s98 offen offset:0 sc1 lds
    buffer_load_dwordx4 v16, s[20:23], s98 offen offset:1024 sc1 lds
    s_lshr_b32 s98, s82, 4
    s_add_u32 s98, s98, s59
    s_add_u32 m0, s47, 32768
    s_nop 0
    buffer_load_dwordx4 v62, s[20:23], s98 offen offset:0 sc1 lds
    buffer_load_dwordx4 v16, s[20:23], s98 offen offset:1024 sc1 lds
    s_lshr_b32 s98, s83, 4
    s_add_u32 s98, s98, s59
    s_add_u32 m0, s47, 34816
    s_nop 0
    buffer_load_dwordx4 v62, s[20:23], s98 offen offset:0 sc1 lds
    buffer_load_dwordx4 v16, s[20:23], s98 offen offset:1024 sc1 lds
    s_waitcnt vmcnt(8)
    s_barrier
    s_cmp_lg_u32 s68, 0
    s_cbranch_scc1 L_nf_21
    v_mov_b32 v38, s75
    v_lshlrev_b32 v255, 7, v0
    s_mov_b32 exec_hi, 0
    buffer_store_dword v38, v255, s[20:23], s53 offen sc1
    s_mov_b64 exec, -1
L_nf_21:
    s_lshl_b32 s94, s78, 8
    s_lshl_b32 s95, s72, 7
    s_add_u32 s94, s94, s95
    s_add_u32 s95, s94, 0x3000
    s_add_u32 s94, s94, 0x4000
    v_and_b32 v24, 31, v0
    v_lshlrev_b32 v22, 2, v24
    v_add_u32 v22, s95, v22
    v_min_u32 v24, 27, v0
    v_lshlrev_b32 v24, 2, v24
    v_add_u32 v23, s94, v24
    s_lshl_b32 s96, s72, 2
    s_add_u32 s96, s96, s68
    s_lshl_b32 s96, s96, 4
    s_add_u32 s96, s96, s78
    s_lshl_b32 s48, s96, 10
    s_lshl_b32 s97, s73, 7
    s_add_u32 s48, s48, s97
    v_lshrrev_b32 v26, 3, v0
    v_and_b32 v27, 7, v0
    v_lshlrev_b32 v28, 4, v27
    v_lshl_add_u32 v60, v26, 17, v28
    v_lshl_add_u32 v54, v26, 16, v28
    v_and_b32 v28, 15, v0
    v_lshlrev_b32 v55, 17, v28
    v_and_b32 v28, 1, v27
    v_lshlrev_b32 v28, 9, v28
    v_lshrrev_b32 v30, 1, v27
    v_lshl_add_u32 v28, v30, 10, v28
    v_and_b32 v29, 3, v27
    v_lshl_add_u32 v29, v29, 2, v26
    s_lshl_b32 s95, s68, 14
    s_add_u32 s95, s95, 0x4000
    s_mov_b32 s97, s47
    v_add_u32 v31, 0, v29
    v_and_b32 v31, 15, v31
    v_lshl_add_u32 v31, v31, 4, v28
    v_add_u32 v48, s95, v31
    v_add_u32 v31, 8, v29
    v_and_b32 v31, 15, v31
    v_lshl_add_u32 v31, v31, 4, v28
    v_add_u32 v49, s95, v31
    v_and_b32 v28, 1, v27
    v_lshlrev_b32 v28, 11, v28
    v_bfe_u32 v31, v27, 1, 1
    v_lshl_add_u32 v28, v31, 9, v28
    v_lshrrev_b32 v30, 2, v27
    v_lshl_add_u32 v29, v30, 4, v29
    v_add_u32 v31, 0, v29
    v_and_b32 v31, 31, v31
    v_lshl_add_u32 v31, v31, 4, v28
    v_add_u32 v50, s97, v31
    v_add_u32 v31, 8, v29
    v_and_b32 v31, 31, v31
    v_lshl_add_u32 v31, v31, 4, v28
    v_add_u32 v51, s97, v31
    v_lshrrev_b32 v24, 5, v0
    v_lshl_add_u32 v28, v24, 3, v0
    v_add_u32 v29, 0, v28
    v_and_b32 v29, 31, v29
    v_lshlrev_b32 v29, 4, v29
    v_lshl_add_u32 v29, v24, 9, v29
    v_add_u32 v52, s47, v29
    v_add_u32 v29, 4, v28
    v_and_b32 v29, 31, v29
    v_lshlrev_b32 v29, 4, v29
    v_lshl_add_u32 v29, v24, 9, v29
    v_add_u32 v53, s47, v29
    s_sub_u32 s94, 7, s73
    s_sub_u32 s95, 0x80, s96
    s_and_b32 s95, s95, 0x7f
    s_cmp_ge_u32 s73, 4
    s_cselect_b32 s94, s94, s73
    s_cselect_b32 s95, s95, s96
    s_cselect_b64 vcc, -1, 0
    s_lshl_b32 s95, s95, 9
    s_add_u32 s95, s95, 0x800000
    s_lshl_b32 s94, s94, 7
    s_add_u32 s49, s95, s94
    s_add_u32 s94, s94, 0x80
    s_and_b32 s94, s94, 0x1ff
    s_add_u32 s50, s95, s94
    s_lshr_b32 s94, s96, 6
    s_lshl_b32 s94, s94, 8
    s_and_b32 s95, s96, 1
    s_lshl_b32 s95, s95, 7
    s_add_u32 s94, s94, s95
    s_and_b32 s95, s96, 62
    s_lshl_b32 s95, s95, 1
    s_add_u32 s94, s94, s95
    s_and_b32 s95, s94, 12
    s_sub_u32 s94, s94, s95
    s_add_u32 s94, s94, 0xc00000
    s_cmp_eq_u32 s73, 0
    s_cselect_b32 s50, s94, s50
    s_cselect_b32 s55, s95, 0
    s_cselect_b32 s54, 0, 64
    v_and_b32 v27, 3, v0
    v_bfe_u32 v28, v0, 2, 1
    v_lshl_add_u32 v27, v28, 4, v27
    v_bfe_u32 v28, v0, 3, 2
    v_lshl_add_u32 v27, v28, 2, v27
    v_add_u32 v28, 0, v27
    v_sub_u32 v29, 64, v28
    v_cndmask_b32 v28, v28, v29, vcc
    v_and_b32 v29, 1, v28
    v_lshrrev_b32 v31, 1, v28
    v_lshlrev_b32 v31, 2, v31
    v_lshl_add_u32 v31, v29, 7, v31
    v_lshl_add_u32 v31, v24, 10, v31
    v_add_u32 v33, s97, v31
    v_mov_b32 v34, v28
    v_add_u32 v28, 32, v27
    v_sub_u32 v29, 64, v28
    v_cndmask_b32 v28, v28, v29, vcc
    v_and_b32 v29, 1, v28
    v_lshrrev_b32 v31, 1, v28
    v_lshlrev_b32 v31, 2, v31
    v_lshl_add_u32 v31, v29, 7, v31
    v_lshl_add_u32 v31, v24, 10, v31
    v_add_u32 v61, s97, v31
    v_and_b32 v25, 15, v0
    s_cmp_eq_u32 s96, 0
    s_cselect_b32 s94, 16, 15
    v_sub_u32 v30, s94, v25
    v_and_b32 v30, 15, v30
    v_cndmask_b32 v30, v25, v30, vcc
    v_cmp_eq_u32 vcc, s54, v34
    s_add_u32 s94, s46, 16384
    s_add_u32 s94, s94, s55
    v_lshlrev_b32 v28, 6, v24
    v_add_u32 v28, s94, v28
    v_mov_b32 v29, 0x100
    v_cndmask_b32 v1, v33, v28, vcc
    v_cndmask_b32 v2, v29, 16, vcc
    v_bfe_u32 v26, v0, 4, 1
    v_cvt_f32_u32 v31, v30
    v_lshlrev_b32 v30, 31, v30
    v_mul_f32 v31, 0x3d800000, v31
    v_cvt_f32_u32 v32, v24
    v_lshrrev_b32 v29, 16, v30
    v_mul_f32 v32, 4.0, v32
    v_or_b32 v30, v30, v29
    v_mul_f32 v32, v32, v31
    v_cmp_eq_u32 vcc, 0, v26
    v_cos_f32 v33, v32
    v_sin_f32 v34, v32
    v_add_f32 v32, v32, v31
    v_cvt_pk_bf16_f32 v33, v33, v34
    v_cndmask_b32 v34, 0, v33, vcc
    v_cndmask_b32 v29, 0, v30, vcc
    v_accvgpr_write_b32 a240, v34
    v_xor_b32 v33, v33, v34
    v_xor_b32 v34, v34, v29
    v_accvgpr_write_b32 a248, v33
    v_xor_b32 v29, v29, v30
    v_accvgpr_write_b32 a244, v34
    v_xor_b32 v33, v33, v29
    v_accvgpr_write_b32 a252, v33
    v_cos_f32 v33, v32
    v_sin_f32 v34, v32
    v_add_f32 v32, v32, v31
    v_cvt_pk_bf16_f32 v33, v33, v34
    v_cndmask_b32 v34, 0, v33, vcc
    v_cndmask_b32 v29, 0, v30, vcc
    v_accvgpr_write_b32 a241, v34
    v_xor_b32 v33, v33, v34
    v_xor_b32 v34, v34, v29
    v_accvgpr_write_b32 a249, v33
    v_xor_b32 v29, v29, v30
    v_accvgpr_write_b32 a245, v34
    v_xor_b32 v33, v33, v29
    v_accvgpr_write_b32 a253, v33
    v_cos_f32 v33, v32
    v_sin_f32 v34, v32
    v_add_f32 v32, v32, v31
    v_cvt_pk_bf16_f32 v33, v33, v34
    v_cndmask_b32 v34, 0, v33, vcc
    v_cndmask_b32 v29, 0, v30, vcc
    v_accvgpr_write_b32 a242, v34
    v_xor_b32 v33, v33, v34
    v_xor_b32 v34, v34, v29
    v_accvgpr_write_b32 a250, v33
    v_xor_b32 v29, v29, v30
    v_accvgpr_write_b32 a246, v34
    v_xor_b32 v33, v33, v29
    v_accvgpr_write_b32 a254, v33
    v_cos_f32 v33, v32
    v_sin_f32 v34, v32
    v_add_f32 v32, v32, v31
    v_cvt_pk_bf16_f32 v33, v33, v34
    v_cndmask_b32 v34, 0, v33, vcc
    v_cndmask_b32 v29, 0, v30, vcc
    v_accvgpr_write_b32 a243, v34
    v_xor_b32 v33, v33, v34
    v_xor_b32 v34, v34, v29
    v_accvgpr_write_b32 a251, v33
    v_xor_b32 v29, v29, v30
    v_accvgpr_write_b32 a247, v34
    v_xor_b32 v33, v33, v29
    v_accvgpr_write_b32 a255, v33
    s_waitcnt vmcnt(4)
    ds_read_b128 v[128:131], v58 offset:0
    ds_read_b128 v[132:135], v58 offset:256
    ds_read_b128 v[136:139], v58 offset:1024
    ds_read_b128 v[140:143], v58 offset:1280
    s_waitcnt lgkmcnt(0)
    v_mfma_f32_16x16x32_bf16 v[64:67], a[128:131], v[128:131], 0
    s_lshr_b32 s98, s84, 4
    s_add_u32 s98, s98, s59
    s_add_u32 m0, s47, 49152
    v_mfma_f32_16x16x32_bf16 v[68:71], a[132:135], v[128:131], 0
    buffer_load_dwordx4 v62, s[20:23], s98 offen offset:0 sc1 lds
    v_mfma_f32_16x16x32_bf16 v[72:75], a[136:139], v[128:131], 0
    buffer_load_dwordx4 v16, s[20:23], s98 offen offset:1024 sc1 lds
    v_mfma_f32_16x16x32_bf16 v[76:79], a[140:143], v[128:131], 0
    s_lshr_b32 s98, s85, 4
    s_add_u32 s98, s98, s59
    s_add_u32 m0, s47, 51200
    v_mfma_f32_16x16x32_bf16 v[80:83], a[128:131], v[132:135], 0
    buffer_load_dwordx4 v62, s[20:23], s98 offen offset:0 sc1 lds
    v_mfma_f32_16x16x32_bf16 v[84:87], a[132:135], v[132:135], 0
    buffer_load_dwordx4 v16, s[20:23], s98 offen offset:1024 sc1 lds
    v_mfma_f32_16x16x32_bf16 v[88:91], a[136:139], v[132:135], 0
    s_lshr_b32 s98, s86, 4
    s_add_u32 s98, s98, s59
    s_add_u32 m0, s47, 65536
    v_mfma_f32_16x16x32_bf16 v[92:95], a[140:143], v[132:135], 0
    buffer_load_dwordx4 v62, s[20:23], s98 offen offset:0 sc1 lds
    v_mfma_f32_16x16x32_bf16 v[96:99], a[128:131], v[136:139], 0
    buffer_load_dwordx4 v16, s[20:23], s98 offen offset:1024 sc1 lds
    v_mfma_f32_16x16x32_bf16 v[100:103], a[132:135], v[136:139], 0
    s_lshr_b32 s98, s87, 4
    s_add_u32 s98, s98, s59
    s_add_u32 m0, s47, 67584
    v_mfma_f32_16x16x32_bf16 v[104:107], a[136:139], v[136:139], 0
    buffer_load_dwordx4 v62, s[20:23], s98 offen offset:0 sc1 lds
    v_mfma_f32_16x16x32_bf16 v[108:111], a[140:143], v[136:139], 0
    buffer_load_dwordx4 v16, s[20:23], s98 offen offset:1024 sc1 lds
    v_mfma_f32_16x16x32_bf16 v[112:115], a[128:131], v[140:143], 0
    s_add_u32 m0, s46, 12288
    s_waitcnt vmcnt(8)
    ds_read_b128 v[144:147], v58 offset:16384
    v_mfma_f32_16x16x32_bf16 v[116:119], a[132:135], v[140:143], 0
    buffer_load_dwordx4 v13, s[16:19], s92 offen offset:0 lds
    v_mfma_f32_16x16x32_bf16 v[120:123], a[136:139], v[140:143], 0
    buffer_load_dwordx4 v14, s[16:19], s92 offen offset:1024 lds
    v_mfma_f32_16x16x32_bf16 v[124:127], a[140:143], v[140:143], 0
    ds_read_b128 v[148:151], v58 offset:16640
    ds_read_b128 v[152:155], v58 offset:17408
    ds_read_b128 v[156:159], v58 offset:17664
    v_add_u32 v233, 0x100000, v60
    v_lshrrev_b32 v24, 5, v0
    v_lshl_add_u32 v24, v24, 2, v0
    v_lshrrev_b32 v25, 4, v0
    v_lshlrev_b32 v25, 8, v25
    s_add_u32 s94, s47, 0x4000
    v_add_u32 v25, s94, v25
    v_add_u32 v26, 0, v24
    v_and_b32 v26, 15, v26
    v_lshl_add_u32 v225, v26, 4, v25
    v_add_u32 v26, 8, v24
    v_and_b32 v26, 15, v26
    v_lshl_add_u32 v226, v26, 4, v25
    v_mad_u32_u24 v216, v2, 0, v1
    v_mad_u32_u24 v217, v2, 1, v1
    v_mad_u32_u24 v218, v2, 2, v1
    v_mad_u32_u24 v219, v2, 3, v1
    v_mad_u32_u24 v220, v2, 8, v1
    v_mad_u32_u24 v221, v2, 9, v1
    v_mad_u32_u24 v222, v2, 10, v1
    v_mad_u32_u24 v223, v2, 11, v1
    s_waitcnt lgkmcnt(0)
    v_mfma_f32_16x16x32_bf16 v[64:67], a[144:147], v[144:147], v[64:67]
    s_lshr_b32 s98, s88, 4
    s_add_u32 s98, s98, s59
    s_add_u32 m0, s47, 16384
    v_mfma_f32_16x16x32_bf16 v[68:71], a[148:151], v[144:147], v[68:71]
    buffer_load_dwordx4 v62, s[20:23], s98 offen offset:0 sc1 lds
    v_mfma_f32_16x16x32_bf16 v[72:75], a[152:155], v[144:147], v[72:75]
    buffer_load_dwordx4 v16, s[20:23], s98 offen offset:1024 sc1 lds
    v_mfma_f32_16x16x32_bf16 v[76:79], a[156:159], v[144:147], v[76:79]
    s_lshr_b32 s98, s89, 4
    s_add_u32 s98, s98, s59
    s_add_u32 m0, s47, 18432
    v_mfma_f32_16x16x32_bf16 v[80:83], a[144:147], v[148:151], v[80:83]
    buffer_load_dwordx4 v62, s[20:23], s98 offen offset:0 sc1 lds
    v_mfma_f32_16x16x32_bf16 v[84:87], a[148:151], v[148:151], v[84:87]
    buffer_load_dwordx4 v16, s[20:23], s98 offen offset:1024 sc1 lds
    v_mfma_f32_16x16x32_bf16 v[88:91], a[152:155], v[148:151], v[88:91]
    s_lshr_b32 s98, s90, 4
    s_add_u32 s98, s98, s59
    s_add_u32 m0, s47, 32768
    v_mfma_f32_16x16x32_bf16 v[92:95], a[156:159], v[148:151], v[92:95]
    buffer_load_dwordx4 v62, s[20:23], s98 offen offset:0 sc1 lds
    v_mfma_f32_16x16x32_bf16 v[96:99], a[144:147], v[152:155], v[96:99]
    buffer_load_dwordx4 v16, s[20:23], s98 offen offset:1024 sc1 lds
    v_mfma_f32_16x16x32_bf16 v[100:103], a[148:151], v[152:155], v[100:103]
    s_lshr_b32 s98, s91, 4
    s_add_u32 s98, s98, s59
    s_add_u32 m0, s47, 34816
    v_mfma_f32_16x16x32_bf16 v[104:107], a[152:155], v[152:155], v[104:107]
    buffer_load_dwordx4 v62, s[20:23], s98 offen offset:0 sc1 lds
    v_mfma_f32_16x16x32_bf16 v[108:111], a[156:159], v[152:155], v[108:111]
    buffer_load_dwordx4 v16, s[20:23], s98 offen offset:1024 sc1 lds
    v_mfma_f32_16x16x32_bf16 v[112:115], a[144:147], v[156:159], v[112:115]
    s_add_u32 m0, s46, 14336
    s_waitcnt vmcnt(14)
    ds_read_b128 v[160:163], v58 offset:32768
    v_mfma_f32_16x16x32_bf16 v[116:119], a[148:151], v[156:159], v[116:119]
    buffer_load_dwordx4 v13, s[16:19], s93 offen offset:0 lds
    v_mfma_f32_16x16x32_bf16 v[120:123], a[152:155], v[156:159], v[120:123]
    buffer_load_dwordx4 v14, s[16:19], s93 offen offset:1024 lds
    v_mfma_f32_16x16x32_bf16 v[124:127], a[156:159], v[156:159], v[124:127]
    ds_read_b128 v[164:167], v58 offset:33024
    ds_read_b128 v[168:171], v58 offset:33792
    ds_read_b128 v[172:175], v58 offset:34048
    s_waitcnt lgkmcnt(0)
    v_mfma_f32_16x16x32_bf16 v[64:67], a[160:163], v[160:163], v[64:67]
    s_lshr_b32 s98, s92, 4
    s_add_u32 s98, s98, s59
    s_add_u32 m0, s47, 49152
    v_mfma_f32_16x16x32_bf16 v[68:71], a[164:167], v[160:163], v[68:71]
    buffer_load_dwordx4 v62, s[20:23], s98 offen offset:0 sc1 lds
    v_mfma_f32_16x16x32_bf16 v[72:75], a[168:171], v[160:163], v[72:75]
    buffer_load_dwordx4 v16, s[20:23], s98 offen offset:1024 sc1 lds
    v_mfma_f32_16x16x32_bf16 v[76:79], a[172:175], v[160:163], v[76:79]
    s_lshr_b32 s98, s93, 4
    s_add_u32 s98, s98, s59
    s_add_u32 m0, s47, 51200
    v_mfma_f32_16x16x32_bf16 v[80:83], a[160:163], v[164:167], v[80:83]
    buffer_load_dwordx4 v62, s[20:23], s98 offen offset:0 sc1 lds
    v_mfma_f32_16x16x32_bf16 v[84:87], a[164:167], v[164:167], v[84:87]
    buffer_load_dwordx4 v16, s[20:23], s98 offen offset:1024 sc1 lds
    v_mfma_f32_16x16x32_bf16 v[88:91], a[168:171], v[164:167], v[88:91]
    ds_read_b64_tr_b16 a[128:129], v56 offset:0
    ds_read_b64_tr_b16 a[130:131], v56 offset:1024
    v_mfma_f32_16x16x32_bf16 v[92:95], a[172:175], v[164:167], v[92:95]
    ds_read_b64_tr_b16 a[132:133], v57 offset:0
    ds_read_b64_tr_b16 a[134:135], v57 offset:1024
    v_mfma_f32_16x16x32_bf16 v[96:99], a[160:163], v[168:171], v[96:99]
    ds_read_b64_tr_b16 a[136:137], v15 offset:0
    ds_read_b64_tr_b16 a[138:139], v15 offset:1024
    v_mfma_f32_16x16x32_bf16 v[100:103], a[164:167], v[168:171], v[100:103]
    ds_read_b64_tr_b16 a[140:141], v35 offset:0
    ds_read_b64_tr_b16 a[142:143], v35 offset:1024
    v_mfma_f32_16x16x32_bf16 v[104:107], a[168:171], v[168:171], v[104:107]
    ds_read_b64_tr_b16 a[144:145], v56 offset:4096
    ds_read_b64_tr_b16 a[146:147], v56 offset:5120
    v_mfma_f32_16x16x32_bf16 v[108:111], a[172:175], v[168:171], v[108:111]
    ds_read_b64_tr_b16 a[148:149], v57 offset:4096
    ds_read_b64_tr_b16 a[150:151], v57 offset:5120
    v_mfma_f32_16x16x32_bf16 v[112:115], a[160:163], v[172:175], v[112:115]
    s_waitcnt vmcnt(16)
    ds_read_b128 v[128:131], v58 offset:49152
    ds_read_b128 v[132:135], v58 offset:49408
    v_mfma_f32_16x16x32_bf16 v[116:119], a[164:167], v[172:175], v[116:119]
    ds_read_b128 v[136:139], v58 offset:50176
    s_waitcnt lgkmcnt(9)
    ds_read_b128 v[140:143], v58 offset:50432
    v_mfma_f32_16x16x32_bf16 v[120:123], a[168:171], v[172:175], v[120:123]
    ds_read_b64_tr_b16 a[152:153], v15 offset:4096
    ds_read_b64_tr_b16 a[154:155], v15 offset:5120
    v_mfma_f32_16x16x32_bf16 v[124:127], a[172:175], v[172:175], v[124:127]
    ds_read_b64_tr_b16 a[156:157], v35 offset:4096
    ds_read_b64_tr_b16 a[158:159], v35 offset:5120
    s_waitcnt lgkmcnt(4)
    v_mfma_f32_16x16x32_bf16 v[64:67], a[176:179], v[128:131], v[64:67]
    ds_read_b64_tr_b16 a[160:161], v56 offset:8192
    ds_read_b64_tr_b16 a[162:163], v56 offset:9216
    v_mfma_f32_16x16x32_bf16 v[68:71], a[180:183], v[128:131], v[68:71]
    ds_read_b64_tr_b16 a[164:165], v57 offset:8192
    ds_read_b64_tr_b16 a[166:167], v57 offset:9216
    v_mfma_f32_16x16x32_bf16 v[72:75], a[184:187], v[128:131], v[72:75]
    ds_read_b64_tr_b16 a[168:169], v15 offset:8192
    ds_read_b64_tr_b16 a[170:171], v15 offset:9216
    v_mfma_f32_16x16x32_bf16 v[76:79], a[188:191], v[128:131], v[76:79]
    ds_read_b64_tr_b16 a[172:173], v35 offset:8192
    ds_read_b64_tr_b16 a[174:175], v35 offset:9216
    v_mfma_f32_16x16x32_bf16 v[80:83], a[176:179], v[132:135], v[80:83]
    s_add_u32 s59, s59, 0x1000
    s_lshr_b32 s98, s80, 4
    s_add_u32 s98, s98, s59
    v_mfma_f32_16x16x32_bf16 v[84:87], a[180:183], v[132:135], v[84:87]
    v_mfma_f32_16x16x32_bf16 v[88:91], a[184:187], v[132:135], v[88:91]
    v_mfma_f32_16x16x32_bf16 v[92:95], a[188:191], v[132:135], v[92:95]
    v_mfma_f32_16x16x32_bf16 v[96:99], a[176:179], v[136:139], v[96:99]
    s_cmp_lg_u32 s68, 0
    s_cbranch_scc1 L_np_22
    buffer_load_dword v63, v23, s[20:23], 0 offen sc1
L_np_22:
    buffer_load_dwordx4 v[192:195], v60, s[4:7], s48 offen
    buffer_load_dwordx4 v[196:199], v233, s[4:7], s48 offen
    v_mfma_f32_16x16x32_bf16 v[100:103], a[180:183], v[136:139], v[100:103]
    v_mfma_f32_16x16x32_bf16 v[104:107], a[184:187], v[136:139], v[104:107]
    v_mfma_f32_16x16x32_bf16 v[108:111], a[188:191], v[136:139], v[108:111]
    v_mfma_f32_16x16x32_bf16 v[112:115], a[176:179], v[140:143], v[112:115]
    s_waitcnt vmcnt(12)
    ds_read_b128 v[144:147], v58 offset:0
    ds_read_b128 v[148:151], v58 offset:256
    v_mfma_f32_16x16x32_bf16 v[116:119], a[180:183], v[140:143], v[116:119]
    ds_read_b128 v[152:155], v58 offset:1024
    s_waitcnt lgkmcnt(9)
    ds_read_b128 v[156:159], v58 offset:1280
    v_mfma_f32_16x16x32_bf16 v[120:123], a[184:187], v[140:143], v[120:123]
    v_mfma_f32_16x16x32_bf16 v[124:127], a[188:191], v[140:143], v[124:127]
    s_waitcnt lgkmcnt(0)
    v_mfma_f32_16x16x32_bf16 v[64:67], a[192:195], v[144:147], v[64:67]
    s_waitcnt vmcnt(6)
    ds_read_b64_tr_b16 a[176:177], v56 offset:12288
    ds_read_b64_tr_b16 a[178:179], v56 offset:13312
    v_mfma_f32_16x16x32_bf16 v[68:71], a[196:199], v[144:147], v[68:71]
    ds_read_b64_tr_b16 a[180:181], v57 offset:12288
    ds_read_b64_tr_b16 a[182:183], v57 offset:13312
    v_mfma_f32_16x16x32_bf16 v[72:75], a[200:203], v[144:147], v[72:75]
    ds_read_b64_tr_b16 a[184:185], v15 offset:12288
    ds_read_b64_tr_b16 a[186:187], v15 offset:13312
    v_mfma_f32_16x16x32_bf16 v[76:79], a[204:207], v[144:147], v[76:79]
    ds_read_b64_tr_b16 a[188:189], v35 offset:12288
    ds_read_b64_tr_b16 a[190:191], v35 offset:13312
    v_mfma_f32_16x16x32_bf16 v[80:83], a[192:195], v[148:151], v[80:83]
    v_mfma_f32_16x16x32_bf16 v[84:87], a[196:199], v[148:151], v[84:87]
    v_mfma_f32_16x16x32_bf16 v[88:91], a[200:203], v[148:151], v[88:91]
    v_mfma_f32_16x16x32_bf16 v[92:95], a[204:207], v[148:151], v[92:95]
    s_cmp_lg_u32 s68, 0
    s_cbranch_scc1 L_pj_23
    s_waitcnt vmcnt(2)
    v_cmp_ne_u32 vcc, s75, v63
    s_cbranch_vccz L_pj_23
    s_mov_b32 s79, 60000
    buffer_load_dword v63, v23, s[20:23], 0 offen sc1
    s_sleep 3
    buffer_load_dword v253, v23, s[20:23], 0 offen sc1
    s_sleep 3
    buffer_load_dword v254, v23, s[20:23], 0 offen sc1
L_pl_24:
    s_waitcnt vmcnt(2)
    v_cmp_ne_u32 vcc, s75, v63
    s_cbranch_vccz L_pj_23
    buffer_load_dword v63, v23, s[20:23], 0 offen sc1
    s_waitcnt vmcnt(2)
    v_cmp_ne_u32 vcc, s75, v253
    s_cbranch_vccz L_pj_23
    buffer_load_dword v253, v23, s[20:23], 0 offen sc1
    s_waitcnt vmcnt(2)
    v_cmp_ne_u32 vcc, s75, v254
    s_cbranch_vccz L_pj_23
    buffer_load_dword v254, v23, s[20:23], 0 offen sc1
    s_sub_u32 s79, s79, 1
    s_cbranch_scc0 L_pl_24
L_pj_23:
    s_barrier
    s_add_u32 m0, s47, 65536
    s_nop 0
    buffer_load_dwordx4 v62, s[20:23], s98 offen offset:0 sc1 lds
    buffer_load_dwordx4 v16, s[20:23], s98 offen offset:1024 sc1 lds
    v_mfma_f32_16x16x32_bf16 v[96:99], a[192:195], v[152:155], v[96:99]
    s_lshr_b32 s98, s81, 4
    s_add_u32 s98, s98, s59
    s_add_u32 m0, s47, 67584
    v_mfma_f32_16x16x32_bf16 v[100:103], a[196:199], v[152:155], v[100:103]
    buffer_load_dwordx4 v62, s[20:23], s98 offen offset:0 sc1 lds
    v_mfma_f32_16x16x32_bf16 v[104:107], a[200:203], v[152:155], v[104:107]
    buffer_load_dwordx4 v16, s[20:23], s98 offen offset:1024 sc1 lds
    v_mfma_f32_16x16x32_bf16 v[108:111], a[204:207], v[152:155], v[108:111]
    s_lshr_b32 s98, s82, 4
    s_add_u32 s98, s98, s59
    s_add_u32 m0, s47, 16384
    v_mfma_f32_16x16x32_bf16 v[112:115], a[192:195], v[156:159], v[112:115]
    buffer_load_dwordx4 v62, s[20:23], s98 offen offset:0 sc1 lds
    v_mfma_f32_16x16x32_bf16 v[116:119], a[196:199], v[156:159], v[116:119]
    buffer_load_dwordx4 v16, s[20:23], s98 offen offset:1024 sc1 lds
    v_mfma_f32_16x16x32_bf16 v[120:123], a[200:203], v[156:159], v[120:123]
    s_lshr_b32 s98, s83, 4
    s_add_u32 s98, s98, s59
    s_add_u32 m0, s47, 18432
    v_mfma_f32_16x16x32_bf16 v[124:127], a[204:207], v[156:159], v[124:127]
    buffer_load_dwordx4 v62, s[20:23], s98 offen offset:0 sc1 lds
    buffer_load_dwordx4 v16, s[20:23], s98 offen offset:1024 sc1 lds
    ds_read_b128 v[160:163], v58 offset:16384
    ds_read_b128 v[164:167], v58 offset:16640
    ds_read_b128 v[168:171], v58 offset:17408
    ds_read_b128 v[172:175], v58 offset:17664
    s_waitcnt lgkmcnt(0)
    v_mfma_f32_16x16x32_bf16 v[64:67], a[0:3], v[160:163], v[64:67]
    s_lshr_b32 s98, s84, 4
    s_add_u32 s98, s98, s59
    s_add_u32 m0, s47, 32768
    v_mfma_f32_16x16x32_bf16 v[68:71], a[4:7], v[160:163], v[68:71]
    buffer_load_dwordx4 v62, s[20:23], s98 offen offset:0 sc1 lds
    v_mfma_f32_16x16x32_bf16 v[72:75], a[8:11], v[160:163], v[72:75]
    buffer_load_dwordx4 v16, s[20:23], s98 offen offset:1024 sc1 lds
    v_mfma_f32_16x16x32_bf16 v[76:79], a[12:15], v[160:163], v[76:79]
    s_lshr_b32 s98, s85, 4
    s_add_u32 s98, s98, s59
    s_add_u32 m0, s47, 34816
    v_mfma_f32_16x16x32_bf16 v[80:83], a[0:3], v[164:167], v[80:83]
    buffer_load_dwordx4 v62, s[20:23], s98 offen offset:0 sc1 lds
    v_mfma_f32_16x16x32_bf16 v[84:87], a[4:7], v[164:167], v[84:87]
    buffer_load_dwordx4 v16, s[20:23], s98 offen offset:1024 sc1 lds
    v_mfma_f32_16x16x32_bf16 v[88:91], a[8:11], v[164:167], v[88:91]
    s_lshr_b32 s98, s86, 4
    s_add_u32 s98, s98, s59
    v_mfma_f32_16x16x32_bf16 v[92:95], a[12:15], v[164:167], v[92:95]
    v_mfma_f32_16x16x32_bf16 v[96:99], a[0:3], v[168:171], v[96:99]
    v_mfma_f32_16x16x32_bf16 v[100:103], a[4:7], v[168:171], v[100:103]
    v_mfma_f32_16x16x32_bf16 v[104:107], a[8:11], v[168:171], v[104:107]
    v_mfma_f32_16x16x32_bf16 v[108:111], a[12:15], v[168:171], v[108:111]
    v_mfma_f32_16x16x32_bf16 v[112:115], a[0:3], v[172:175], v[112:115]
    s_waitcnt vmcnt(14)
    ds_read_b128 v[128:131], v58 offset:32768
    ds_read_b128 v[132:135], v58 offset:33024
    v_mfma_f32_16x16x32_bf16 v[116:119], a[4:7], v[172:175], v[116:119]
    ds_read_b128 v[136:139], v58 offset:33792
    ds_read_b128 v[140:143], v58 offset:34048
    v_mfma_f32_16x16x32_bf16 v[120:123], a[8:11], v[172:175], v[120:123]
    v_mfma_f32_16x16x32_bf16 v[124:127], a[12:15], v[172:175], v[124:127]
    s_cmp_lg_u32 s68, 0
    s_cbranch_scc1 L_np_25
    buffer_load_dword v252, v22, s[20:23], 0 offen sc1
L_np_25:
    s_waitcnt lgkmcnt(0)
    v_mfma_f32_16x16x32_bf16 v[64:67], a[16:19], v[128:131], v[64:67]
    s_add_u32 m0, s47, 49152
    v_mfma_f32_16x16x32_bf16 v[68:71], a[20:23], v[128:131], v[68:71]
    buffer_load_dwordx4 v62, s[20:23], s98 offen offset:0 sc1 lds
    v_mfma_f32_16x16x32_bf16 v[72:75], a[24:27], v[128:131], v[72:75]
    buffer_load_dwordx4 v16, s[20:23], s98 offen offset:1024 sc1 lds
    v_mfma_f32_16x16x32_bf16 v[76:79], a[28:31], v[128:131], v[76:79]
    s_lshr_b32 s98, s87, 4
    s_add_u32 s98, s98, s59
    s_add_u32 m0, s47, 51200
    v_mfma_f32_16x16x32_bf16 v[80:83], a[16:19], v[132:135], v[80:83]
    buffer_load_dwordx4 v62, s[20:23], s98 offen offset:0 sc1 lds
    v_mfma_f32_16x16x32_bf16 v[84:87], a[20:23], v[132:135], v[84:87]
    buffer_load_dwordx4 v16, s[20:23], s98 offen offset:1024 sc1 lds
    v_mfma_f32_16x16x32_bf16 v[88:91], a[24:27], v[132:135], v[88:91]
    s_lshr_b32 s98, s88, 4
    s_add_u32 s98, s98, s59
    v_mfma_f32_16x16x32_bf16 v[92:95], a[28:31], v[132:135], v[92:95]
    v_mfma_f32_16x16x32_bf16 v[96:99], a[16:19], v[136:139], v[96:99]
    v_mfma_f32_16x16x32_bf16 v[100:103], a[20:23], v[136:139], v[100:103]
    v_mfma_f32_16x16x32_bf16 v[104:107], a[24:27], v[136:139], v[104:107]
    v_mfma_f32_16x16x32_bf16 v[108:111], a[28:31], v[136:139], v[108:111]
    v_mfma_f32_16x16x32_bf16 v[112:115], a[16:19], v[140:143], v[112:115]
    s_waitcnt vmcnt(12)
    ds_read_b128 v[144:147], v58 offset:49152
    ds_read_b128 v[148:151], v58 offset:49408
    v_mfma_f32_16x16x32_bf16 v[116:119], a[20:23], v[140:143], v[116:119]
    ds_read_b128 v[152:155], v58 offset:50176
    ds_read_b128 v[156:159], v58 offset:50432
    v_mfma_f32_16x16x32_bf16 v[120:123], a[24:27], v[140:143], v[120:123]
    v_mfma_f32_16x16x32_bf16 v[124:127], a[28:31], v[140:143], v[124:127]
    s_waitcnt lgkmcnt(0)
    v_mfma_f32_16x16x32_bf16 v[64:67], a[32:35], v[144:147], v[64:67]
    s_add_u32 m0, s47, 65536
    v_mfma_f32_16x16x32_bf16 v[68:71], a[36:39], v[144:147], v[68:71]
    buffer_load_dwordx4 v62, s[20:23], s98 offen offset:0 sc1 lds
    v_mfma_f32_16x16x32_bf16 v[72:75], a[40:43], v[144:147], v[72:75]
    buffer_load_dwordx4 v16, s[20:23], s98 offen offset:1024 sc1 lds
    v_mfma_f32_16x16x32_bf16 v[76:79], a[44:47], v[144:147], v[76:79]
    s_lshr_b32 s98, s89, 4
    s_add_u32 s98, s98, s59
    s_add_u32 m0, s47, 67584
    v_mfma_f32_16x16x32_bf16 v[80:83], a[32:35], v[148:151], v[80:83]
    buffer_load_dwordx4 v62, s[20:23], s98 offen offset:0 sc1 lds
    v_mfma_f32_16x16x32_bf16 v[84:87], a[36:39], v[148:151], v[84:87]
    buffer_load_dwordx4 v16, s[20:23], s98 offen offset:1024 sc1 lds
    v_mfma_f32_16x16x32_bf16 v[88:91], a[40:43], v[148:151], v[88:91]
    s_lshr_b32 s98, s90, 4
    s_add_u32 s98, s98, s59
    v_mfma_f32_16x16x32_bf16 v[92:95], a[44:47], v[148:151], v[92:95]
    v_mfma_f32_16x16x32_bf16 v[96:99], a[32:35], v[152:155], v[96:99]
    v_mfma_f32_16x16x32_bf16 v[100:103], a[36:39], v[152:155], v[100:103]
    v_mfma_f32_16x16x32_bf16 v[104:107], a[40:43], v[152:155], v[104:107]
    v_mfma_f32_16x16x32_bf16 v[108:111], a[44:47], v[152:155], v[108:111]
    v_mfma_f32_16x16x32_bf16 v[112:115], a[32:35], v[156:159], v[112:115]
    s_waitcnt vmcnt(12)
    ds_read_b128 v[160:163], v58 offset:0
    ds_read_b128 v[164:167], v58 offset:256
    v_mfma_f32_16x16x32_bf16 v[116:119], a[36:39], v[156:159], v[116:119]
    ds_read_b128 v[168:171], v58 offset:1024
    ds_read_b128 v[172:175], v58 offset:1280
    v_mfma_f32_16x16x32_bf16 v[120:123], a[40:43], v[156:159], v[120:123]
    v_mfma_f32_16x16x32_bf16 v[124:127], a[44:47], v[156:159], v[124:127]
    s_cmp_lg_u32 s68, 0
    s_cbranch_scc1 L_pj_26
    s_waitcnt vmcnt(8)
    v_cmp_ne_u32 vcc, s75, v252
    s_cbranch_vccz L_pj_26
    s_mov_b32 s79, 60000
    buffer_load_dword v252, v22, s[20:23], 0 offen sc1
    s_sleep 12
    buffer_load_dword v253, v22, s[20:23], 0 offen sc1
    s_sleep 12
    buffer_load_dword v254, v22, s[20:23], 0 offen sc1
L_pl_27:
    s_waitcnt vmcnt(2)
    v_cmp_ne_u32 vcc, s75, v252
    s_cbranch_vccz L_pj_26
    buffer_load_dword v252, v22, s[20:23], 0 offen sc1
    s_waitcnt vmcnt(2)
    v_cmp_ne_u32 vcc, s75, v253
    s_cbranch_vccz L_pj_26
    buffer_load_dword v253, v22, s[20:23], 0 offen sc1
    s_waitcnt vmcnt(2)
    v_cmp_ne_u32 vcc, s75, v254
    s_cbranch_vccz L_pj_26
    buffer_load_dword v254, v22, s[20:23], 0 offen sc1
    s_sub_u32 s79, s79, 1
    s_cbranch_scc0 L_pl_27
L_pj_26:
    s_barrier
    s_waitcnt lgkmcnt(0)
    v_mfma_f32_16x16x32_bf16 v[64:67], a[48:51], v[160:163], v[64:67]
    s_add_u32 m0, s47, 16384
    v_mfma_f32_16x16x32_bf16 v[68:71], a[52:55], v[160:163], v[68:71]
    buffer_load_dwordx4 v62, s[20:23], s98 offen offset:0 sc1 lds
    v_mfma_f32_16x16x32_bf16 v[72:75], a[56:59], v[160:163], v[72:75]
    buffer_load_dwordx4 v16, s[20:23], s98 offen offset:1024 sc1 lds
    v_mfma_f32_16x16x32_bf16 v[76:79], a[60:63], v[160:163], v[76:79]
    s_lshr_b32 s98, s91, 4
    s_add_u32 s98, s98, s59
    s_add_u32 m0, s47, 18432
    v_mfma_f32_16x16x32_bf16 v[80:83], a[48:51], v[164:167], v[80:83]
    buffer_load_dwordx4 v62, s[20:23], s98 offen offset:0 sc1 lds
    v_mfma_f32_16x16x32_bf16 v[84:87], a[52:55], v[164:167], v[84:87]
    buffer_load_dwordx4 v16, s[20:23], s98 offen offset:1024 sc1 lds
    v_mfma_f32_16x16x32_bf16 v[88:91], a[56:59], v[164:167], v[88:91]
    s_add_u32 s99, s49, 0x0
    s_mov_b32 m0, s47
    v_mfma_f32_16x16x32_bf16 v[92:95], a[60:63], v[164:167], v[92:95]
    buffer_load_dwordx4 v54, s[20:23], s99 offen offset:0 sc1 lds
    v_mfma_f32_16x16x32_bf16 v[96:99], a[48:51], v[168:171], v[96:99]
    s_add_u32 s99, s49, 0x7fc00
    v_mfma_f32_16x16x32_bf16 v[100:103], a[52:55], v[168:171], v[100:103]
    buffer_load_dwordx4 v54, s[20:23], s99 offen offset:1024 sc1 lds
    v_mfma_f32_16x16x32_bf16 v[104:107], a[56:59], v[168:171], v[104:107]
    s_add_u32 s99, s49, 0xff800
    v_mfma_f32_16x16x32_bf16 v[108:111], a[60:63], v[168:171], v[108:111]
    buffer_load_dwordx4 v54, s[20:23], s99 offen offset:2048 sc1 lds
    v_mfma_f32_16x16x32_bf16 v[112:115], a[48:51], v[172:175], v[112:115]
    s_add_u32 s99, s49, 0x17f400
    s_waitcnt vmcnt(15)
    ds_read_b128 v[128:131], v58 offset:16384
    v_mfma_f32_16x16x32_bf16 v[116:119], a[52:55], v[172:175], v[116:119]
    buffer_load_dwordx4 v54, s[20:23], s99 offen offset:3072 sc1 lds
    v_mfma_f32_16x16x32_bf16 v[120:123], a[56:59], v[172:175], v[120:123]
    s_add_u32 m0, s46, 16384
    ds_read_b128 v[132:135], v58 offset:16640
    v_mfma_f32_16x16x32_bf16 v[124:127], a[60:63], v[172:175], v[124:127]
    s_mov_b64 exec, 0xffff
    buffer_load_dwordx4 v55, s[20:23], s50 offen sc1 lds
    s_mov_b64 exec, -1
    ds_read_b128 v[136:139], v58 offset:17408
    ds_read_b128 v[140:143], v58 offset:17664
    s_waitcnt lgkmcnt(0)
    v_mfma_f32_16x16x32_bf16 v[64:67], a[64:67], v[128:131], v[64:67]
    s_lshr_b32 s98, s92, 4
    s_add_u32 s98, s98, s59
    s_add_u32 m0, s47, 32768
    v_mfma_f32_16x16x32_bf16 v[68:71], a[68:71], v[128:131], v[68:71]
    buffer_load_dwordx4 v62, s[20:23], s98 offen offset:0 sc1 lds
    v_mfma_f32_16x16x32_bf16 v[72:75], a[72:75], v[128:131], v[72:75]
    buffer_load_dwordx4 v16, s[20:23], s98 offen offset:1024 sc1 lds
    v_mfma_f32_16x16x32_bf16 v[76:79], a[76:79], v[128:131], v[76:79]
    s_lshr_b32 s98, s93, 4
    s_add_u32 s98, s98, s59
    s_add_u32 m0, s47, 34816
    v_mfma_f32_16x16x32_bf16 v[80:83], a[64:67], v[132:135], v[80:83]
    buffer_load_dwordx4 v62, s[20:23], s98 offen offset:0 sc1 lds
    v_mfma_f32_16x16x32_bf16 v[84:87], a[68:71], v[132:135], v[84:87]
    buffer_load_dwordx4 v16, s[20:23], s98 offen offset:1024 sc1 lds
    v_mfma_f32_16x16x32_bf16 v[88:91], a[72:75], v[132:135], v[88:91]
    v_lshlrev_b32 v234, 16, v192
    v_and_b32 v235, s76, v192
    v_mfma_f32_16x16x32_bf16 v[92:95], a[76:79], v[132:135], v[92:95]
    v_lshlrev_b32 v236, 16, v193
    v_and_b32 v237, s76, v193
    v_mfma_f32_16x16x32_bf16 v[96:99], a[64:67], v[136:139], v[96:99]
    v_lshlrev_b32 v238, 16, v194
    v_and_b32 v239, s76, v194
    v_mfma_f32_16x16x32_bf16 v[100:103], a[68:71], v[136:139], v[100:103]
    v_lshlrev_b32 v240, 16, v195
    v_and_b32 v241, s76, v195
    v_mfma_f32_16x16x32_bf16 v[104:107], a[72:75], v[136:139], v[104:107]
    v_lshlrev_b32 v242, 16, v196
    v_and_b32 v243, s76, v196
    v_mfma_f32_16x16x32_bf16 v[108:111], a[76:79], v[136:139], v[108:111]
    v_lshlrev_b32 v244, 16, v197
    v_and_b32 v245, s76, v197
    v_mfma_f32_16x16x32_bf16 v[112:115], a[64:67], v[140:143], v[112:115]
    s_waitcnt vmcnt(17)
    ds_read_b128 v[144:147], v58 offset:32768
    ds_read_b128 v[148:151], v58 offset:33024
    v_mfma_f32_16x16x32_bf16 v[116:119], a[68:71], v[140:143], v[116:119]
    ds_read_b128 v[152:155], v58 offset:33792
    ds_read_b128 v[156:159], v58 offset:34048
    v_mfma_f32_16x16x32_bf16 v[120:123], a[72:75], v[140:143], v[120:123]
    v_lshlrev_b32 v246, 16, v198
    v_and_b32 v247, s76, v198
    v_mfma_f32_16x16x32_bf16 v[124:127], a[76:79], v[140:143], v[124:127]
    v_lshlrev_b32 v248, 16, v199
    v_and_b32 v249, s76, v199
    s_waitcnt lgkmcnt(0)
    v_mfma_f32_16x16x32_bf16 v[64:67], a[128:131], v[144:147], v[64:67]
    v_mfma_f32_16x16x32_bf16 v[68:71], a[132:135], v[144:147], v[68:71]
    v_mfma_f32_16x16x32_bf16 v[72:75], a[136:139], v[144:147], v[72:75]
    v_mfma_f32_16x16x32_bf16 v[76:79], a[140:143], v[144:147], v[76:79]
    v_mfma_f32_16x16x32_bf16 v[80:83], a[128:131], v[148:151], v[80:83]
    v_mfma_f32_16x16x32_bf16 v[84:87], a[132:135], v[148:151], v[84:87]
    v_mfma_f32_16x16x32_bf16 v[88:91], a[136:139], v[148:151], v[88:91]
    v_mfma_f32_16x16x32_bf16 v[92:95], a[140:143], v[148:151], v[92:95]
    v_mfma_f32_16x16x32_bf16 v[96:99], a[128:131], v[152:155], v[96:99]
    v_mfma_f32_16x16x32_bf16 v[100:103], a[132:135], v[152:155], v[100:103]
    v_mfma_f32_16x16x32_bf16 v[104:107], a[136:139], v[152:155], v[104:107]
    v_mfma_f32_16x16x32_bf16 v[108:111], a[140:143], v[152:155], v[108:111]
    v_mfma_f32_16x16x32_bf16 v[112:115], a[128:131], v[156:159], v[112:115]
    s_waitcnt vmcnt(13)
    ds_read_b128 v[160:163], v58 offset:49152
    ds_read_b128 v[164:167], v58 offset:49408
    v_mfma_f32_16x16x32_bf16 v[116:119], a[132:135], v[156:159], v[116:119]
    ds_read_b128 v[168:171], v58 offset:50176
    ds_read_b128 v[172:175], v58 offset:50432
    v_mfma_f32_16x16x32_bf16 v[120:123], a[136:139], v[156:159], v[120:123]
    v_mfma_f32_16x16x32_bf16 v[124:127], a[140:143], v[156:159], v[124:127]
    s_waitcnt lgkmcnt(0)
    v_mfma_f32_16x16x32_bf16 v[64:67], a[144:147], v[160:163], v[64:67]
    s_waitcnt vmcnt(4)
    ds_read_b32 v176, v216
    v_mfma_f32_16x16x32_bf16 v[68:71], a[148:151], v[160:163], v[68:71]
    ds_read_b32 v177, v217
    ds_read_b32 v178, v218
    v_mfma_f32_16x16x32_bf16 v[72:75], a[152:155], v[160:163], v[72:75]
    ds_read_b32 v179, v219
    ds_read_b32 v180, v220
    v_mfma_f32_16x16x32_bf16 v[76:79], a[156:159], v[160:163], v[76:79]
    ds_read_b32 v181, v221
    ds_read_b32 v182, v222
    v_mfma_f32_16x16x32_bf16 v[80:83], a[144:147], v[164:167], v[80:83]
    ds_read_b32 v183, v223
    ds_read_b32 v184, v61 offset:0
    v_mfma_f32_16x16x32_bf16 v[84:87], a[148:151], v[164:167], v[84:87]
    ds_read_b32 v185, v61 offset:256
    ds_read_b32 v186, v61 offset:512
    v_mfma_f32_16x16x32_bf16 v[88:91], a[152:155], v[164:167], v[88:91]
    ds_read_b32 v187, v61 offset:768
    ds_read_b32 v188, v61 offset:2048
    v_mfma_f32_16x16x32_bf16 v[92:95], a[156:159], v[164:167], v[92:95]
    ds_read_b32 v189, v61 offset:2304
    ds_read_b32 v190, v61 offset:2560
    v_mfma_f32_16x16x32_bf16 v[96:99], a[144:147], v[168:171], v[96:99]
    s_waitcnt lgkmcnt(9)
    ds_read_b32 v191, v61 offset:2816
    v_mfma_f32_16x16x32_bf16 v[100:103], a[148:151], v[168:171], v[100:103]
    v_mfma_f32_16x16x32_bf16 v[104:107], a[152:155], v[168:171], v[104:107]
    v_mfma_f32_16x16x32_bf16 v[108:111], a[156:159], v[168:171], v[108:111]
    v_mfma_f32_16x16x32_bf16 v[112:115], a[144:147], v[172:175], v[112:115]
    ds_read_b128 v[128:131], v58 offset:0
    ds_read_b128 v[132:135], v58 offset:256
    v_mfma_f32_16x16x32_bf16 v[116:119], a[148:151], v[172:175], v[116:119]
    ds_read_b128 v[136:139], v58 offset:1024
    ds_read_b128 v[140:143], v58 offset:1280
    v_mfma_f32_16x16x32_bf16 v[120:123], a[152:155], v[172:175], v[120:123]
    v_mfma_f32_16x16x32_bf16 v[124:127], a[156:159], v[172:175], v[124:127]
    s_waitcnt lgkmcnt(4)
    v_mfma_f32_32x32x16_bf16 v[200:215], v[176:179], a[240:243], 0
    s_waitcnt vmcnt(0)
    ds_read_b128 v[144:147], v58 offset:16384
    ds_read_b128 v[148:151], v58 offset:16640
    ds_read_b128 v[152:155], v58 offset:17408
    ds_read_b128 v[156:159], v58 offset:17664
    v_mfma_f32_32x32x16_bf16 v[200:215], v[180:183], a[244:247], v[200:215]
    v_mfma_f32_32x32x16_bf16 v[200:215], v[184:187], a[248:251], v[200:215]
    v_mfma_f32_32x32x16_bf16 v[200:215], v[188:191], a[252:255], v[200:215]
    s_waitcnt lgkmcnt(0)
    v_mfma_f32_16x16x32_bf16 v[64:67], a[160:163], v[128:131], v[64:67]
    s_nop 1
    v_mfma_f32_16x16x32_bf16 v[68:71], a[164:167], v[128:131], v[68:71]
    s_nop 1
    v_mfma_f32_16x16x32_bf16 v[72:75], a[168:171], v[128:131], v[72:75]
    s_nop 1
    v_mfma_f32_16x16x32_bf16 v[76:79], a[172:175], v[128:131], v[76:79]
    s_nop 1
    v_mfma_f32_16x16x32_bf16 v[64:67], a[176:179], v[144:147], v[64:67]
    s_nop 1
    v_mfma_f32_16x16x32_bf16 v[68:71], a[180:183], v[144:147], v[68:71]
    s_nop 1
    v_mfma_f32_16x16x32_bf16 v[72:75], a[184:187], v[144:147], v[72:75]
    s_nop 1
    v_mfma_f32_16x16x32_bf16 v[76:79], a[188:191], v[144:147], v[76:79]
    s_nop 1
    v_mfma_f32_16x16x32_bf16 v[80:83], a[160:163], v[132:135], v[80:83]
    s_nop 1
    v_mfma_f32_16x16x32_bf16 v[84:87], a[164:167], v[132:135], v[84:87]
    s_nop 1
    v_mfma_f32_16x16x32_bf16 v[88:91], a[168:171], v[132:135], v[88:91]
    s_nop 1
    v_mfma_f32_16x16x32_bf16 v[92:95], a[172:175], v[132:135], v[92:95]
    ds_write_b128 v52, v[200:203] offset:0
    v_mfma_f32_16x16x32_bf16 v[80:83], a[176:179], v[148:151], v[80:83]
    ds_write_b128 v52, v[204:207] offset:1024
    v_mfma_f32_16x16x32_bf16 v[84:87], a[180:183], v[148:151], v[84:87]
    ds_write_b128 v53, v[208:211] offset:2048
    v_mfma_f32_16x16x32_bf16 v[88:91], a[184:187], v[148:151], v[88:91]
    ds_write_b128 v53, v[212:215] offset:3072
    v_mfma_f32_16x16x32_bf16 v[92:95], a[188:191], v[148:151], v[92:95]
    ds_write_b128 v225, v[64:67] offset:0
    v_mfma_f32_16x16x32_bf16 v[96:99], a[160:163], v[136:139], v[96:99]
    s_nop 1
    v_mfma_f32_16x16x32_bf16 v[100:103], a[164:167], v[136:139], v[100:103]
    s_nop 1
    v_mfma_f32_16x16x32_bf16 v[104:107], a[168:171], v[136:139], v[104:107]
    s_nop 1
    v_mfma_f32_16x16x32_bf16 v[108:111], a[172:175], v[136:139], v[108:111]
    ds_write_b128 v226, v[68:71] offset:1024
    v_mfma_f32_16x16x32_bf16 v[96:99], a[176:179], v[152:155], v[96:99]
    ds_write_b128 v225, v[72:75] offset:2048
    v_mfma_f32_16x16x32_bf16 v[100:103], a[180:183], v[152:155], v[100:103]
    ds_write_b128 v226, v[76:79] offset:3072
    v_mfma_f32_16x16x32_bf16 v[104:107], a[184:187], v[152:155], v[104:107]
    ds_write_b128 v225, v[80:83] offset:16384
    v_mfma_f32_16x16x32_bf16 v[108:111], a[188:191], v[152:155], v[108:111]
    ds_write_b128 v226, v[84:87] offset:17408
    v_mfma_f32_16x16x32_bf16 v[112:115], a[160:163], v[140:143], v[112:115]
    s_nop 1
    v_mfma_f32_16x16x32_bf16 v[116:119], a[164:167], v[140:143], v[116:119]
    s_nop 1
    v_mfma_f32_16x16x32_bf16 v[120:123], a[168:171], v[140:143], v[120:123]
    s_nop 1
    v_mfma_f32_16x16x32_bf16 v[124:127], a[172:175], v[140:143], v[124:127]
    ds_write_b128 v225, v[88:91] offset:18432
    v_mfma_f32_16x16x32_bf16 v[112:115], a[176:179], v[156:159], v[112:115]
    ds_write_b128 v226, v[92:95] offset:19456
    v_mfma_f32_16x16x32_bf16 v[116:119], a[180:183], v[156:159], v[116:119]
    ds_write_b128 v225, v[96:99] offset:32768
    v_mfma_f32_16x16x32_bf16 v[120:123], a[184:187], v[156:159], v[120:123]
    ds_write_b128 v226, v[100:103] offset:33792
    v_mfma_f32_16x16x32_bf16 v[124:127], a[188:191], v[156:159], v[124:127]
    ds_write_b128 v225, v[104:107] offset:34816
    s_nop 3
    s_waitcnt lgkmcnt(9)
    ds_write_b128 v226, v[108:111] offset:35840
    ds_write_b128 v225, v[112:115] offset:49152
    ds_write_b128 v226, v[116:119] offset:50176
    ds_write_b128 v225, v[120:123] offset:51200
    ds_write_b128 v226, v[124:127] offset:52224
    s_waitcnt lgkmcnt(0)
    s_barrier
    ds_read_b128 v[64:67], v48 offset:0
    ds_read_b128 v[68:71], v48 offset:4096
    ds_read_b128 v[72:75], v48 offset:8192
    ds_read_b128 v[76:79], v48 offset:12288
    ds_read_b128 v[128:131], v50 offset:0
    ds_read_b128 v[80:83], v48 offset:256
    ds_read_b128 v[84:87], v48 offset:4352
    ds_read_b128 v[88:91], v48 offset:8448
    ds_read_b128 v[92:95], v48 offset:12544
    ds_read_b128 v[132:135], v50 offset:1024
    ds_read_b128 v[96:99], v49 offset:0
    ds_read_b128 v[100:103], v49 offset:4096
    ds_read_b128 v[104:107], v49 offset:8192
    ds_read_b128 v[108:111], v49 offset:12288
    ds_read_b128 v[136:139], v51 offset:0
    s_waitcnt lgkmcnt(9)
    ds_read_b128 v[112:115], v49 offset:256
    ds_read_b128 v[116:119], v49 offset:4352
    ds_read_b128 v[120:123], v49 offset:8448
    ds_read_b128 v[124:127], v49 offset:12544
    ds_read_b128 v[140:143], v51 offset:1024
    v_pk_add_f32 v[64:65], v[64:65], v[68:69]
    v_pk_add_f32 v[72:73], v[72:73], v[76:77]
    v_pk_add_f32 v[66:67], v[66:67], v[70:71]
    v_pk_add_f32 v[74:75], v[74:75], v[78:79]
    v_pk_add_f32 v[64:65], v[64:65], v[72:73]
    v_pk_add_f32 v[66:67], v[66:67], v[74:75]
    v_pk_mul_f32 v[28:29], v[64:65], s[66:67]
    v_pk_mul_f32 v[30:31], v[66:67], s[66:67]
    v_exp_f32 v28, v28
    v_exp_f32 v29, v29
    v_exp_f32 v30, v30
    v_exp_f32 v31, v31
    v_pk_mul_f32 v[64:65], v[64:65], v[128:129]
    v_pk_mul_f32 v[66:67], v[66:67], v[130:131]
    v_pk_add_f32 v[28:29], v[28:29], s[64:65]
    v_pk_add_f32 v[30:31], v[30:31], s[64:65]
    v_rcp_f32 v28, v28
    v_rcp_f32 v29, v29
    v_rcp_f32 v30, v30
    v_rcp_f32 v31, v31
    s_nop 0
    v_pk_fma_f32 v[64:65], v[64:65], v[28:29], v[234:235]
    v_pk_fma_f32 v[66:67], v[66:67], v[30:31], v[236:237]
    v_cvt_pk_bf16_f32 v144, v64, v65
    v_cvt_pk_bf16_f32 v145, v66, v67
    s_waitcnt lgkmcnt(10)
    v_pk_add_f32 v[80:81], v[80:81], v[84:85]
    v_pk_add_f32 v[88:89], v[88:89], v[92:93]
    v_pk_add_f32 v[82:83], v[82:83], v[86:87]
    v_pk_add_f32 v[90:91], v[90:91], v[94:95]
    v_pk_add_f32 v[80:81], v[80:81], v[88:89]
    v_pk_add_f32 v[82:83], v[82:83], v[90:91]
    v_pk_mul_f32 v[28:29], v[80:81], s[66:67]
    v_pk_mul_f32 v[30:31], v[82:83], s[66:67]
    v_exp_f32 v28, v28
    v_exp_f32 v29, v29
    v_exp_f32 v30, v30
    v_exp_f32 v31, v31
    v_pk_mul_f32 v[80:81], v[80:81], v[132:133]
    v_pk_mul_f32 v[82:83], v[82:83], v[134:135]
    v_pk_add_f32 v[28:29], v[28:29], s[64:65]
    v_pk_add_f32 v[30:31], v[30:31], s[64:65]
    v_rcp_f32 v28, v28
    v_rcp_f32 v29, v29
    v_rcp_f32 v30, v30
    v_rcp_f32 v31, v31
    s_nop 0
    v_pk_fma_f32 v[80:81], v[80:81], v[28:29], v[238:239]
    v_pk_fma_f32 v[82:83], v[82:83], v[30:31], v[240:241]
    v_cvt_pk_bf16_f32 v146, v80, v81
    v_cvt_pk_bf16_f32 v147, v82, v83
    buffer_store_dwordx4 v[144:147], v60, s[24:27], s48 offen sc1
    s_waitcnt lgkmcnt(5)
    v_pk_add_f32 v[96:97], v[96:97], v[100:101]
    v_pk_add_f32 v[104:105], v[104:105], v[108:109]
    v_pk_add_f32 v[98:99], v[98:99], v[102:103]
    v_pk_add_f32 v[106:107], v[106:107], v[110:111]
    v_pk_add_f32 v[96:97], v[96:97], v[104:105]
    v_pk_add_f32 v[98:99], v[98:99], v[106:107]
    v_pk_mul_f32 v[28:29], v[96:97], s[66:67]
    v_pk_mul_f32 v[30:31], v[98:99], s[66:67]
    v_exp_f32 v28, v28
    v_exp_f32 v29, v29
    v_exp_f32 v30, v30
    v_exp_f32 v31, v31
    v_pk_mul_f32 v[96:97], v[96:97], v[136:137]
    v_pk_mul_f32 v[98:99], v[98:99], v[138:139]
    v_pk_add_f32 v[28:29], v[28:29], s[64:65]
    v_pk_add_f32 v[30:31], v[30:31], s[64:65]
    v_rcp_f32 v28, v28
    v_rcp_f32 v29, v29
    v_rcp_f32 v30, v30
    v_rcp_f32 v31, v31
    s_nop 0
    v_pk_fma_f32 v[96:97], v[96:97], v[28:29], v[242:243]
    v_pk_fma_f32 v[98:99], v[98:99], v[30:31], v[244:245]
    v_cvt_pk_bf16_f32 v148, v96, v97
    v_cvt_pk_bf16_f32 v149, v98, v99
    s_waitcnt lgkmcnt(0)
    v_pk_add_f32 v[112:113], v[112:113], v[116:117]
    v_pk_add_f32 v[120:121], v[120:121], v[124:125]
    v_pk_add_f32 v[114:115], v[114:115], v[118:119]
    v_pk_add_f32 v[122:123], v[122:123], v[126:127]
    v_pk_add_f32 v[112:113], v[112:113], v[120:121]
    v_pk_add_f32 v[114:115], v[114:115], v[122:123]
    v_pk_mul_f32 v[28:29], v[112:113], s[66:67]
    v_pk_mul_f32 v[30:31], v[114:115], s[66:67]
    v_exp_f32 v28, v28
    v_exp_f32 v29, v29
    v_exp_f32 v30, v30
    v_exp_f32 v31, v31
    v_pk_mul_f32 v[112:113], v[112:113], v[140:141]
    v_pk_mul_f32 v[114:115], v[114:115], v[142:143]
    v_pk_add_f32 v[28:29], v[28:29], s[64:65]
    v_pk_add_f32 v[30:31], v[30:31], s[64:65]
    v_rcp_f32 v28, v28
    v_rcp_f32 v29, v29
    v_rcp_f32 v30, v30
    v_rcp_f32 v31, v31
    s_nop 0
    v_pk_fma_f32 v[112:113], v[112:113], v[28:29], v[246:247]
    v_pk_fma_f32 v[114:115], v[114:115], v[30:31], v[248:249]
    v_cvt_pk_bf16_f32 v150, v112, v113
    v_cvt_pk_bf16_f32 v151, v114, v115
    buffer_store_dwordx4 v[148:151], v233, s[24:27], s48 offen sc1
    s_endpgm
L_slow_5:
    v_mfma_f32_32x32x16_bf16 v[112:127], a[76:79], v[240:243], v[112:127]
    ds_read_b64_tr_b16 a[72:73], v11 offset:8192
    ds_read_b64_tr_b16 a[74:75], v11 offset:8704
    s_add_u32 s52, s52, 0x1000
    s_lshl_b32 s53, s69, 8
    s_lshl_b32 s94, s70, 3
    s_waitcnt lgkmcnt(10)
    v_mfma_f32_32x32x16_bf16 v[64:79], a[80:83], v[244:247], v[64:79]
    ds_read_b64_tr_b16 a[76:77], v12 offset:8192
    ds_read_b64_tr_b16 a[78:79], v12 offset:8704
    s_add_u32 s53, s53, s94
    s_and_b32 s94, s68, 1
    s_lshl_b32 s94, s94, 2
    v_mfma_f32_32x32x16_bf16 v[80:95], a[84:87], v[244:247], v[80:95]
    ds_read_b64_tr_b16 a[80:81], v9 offset:12288
    ds_read_b64_tr_b16 a[82:83], v9 offset:12800
    s_add_u32 s53, s53, s94
    s_lshr_b32 s94, s68, 1
    s_lshl_b32 s94, s94, 7
    v_mfma_f32_32x32x16_bf16 v[96:111], a[88:91], v[244:247], v[96:111]
    ds_read_b64_tr_b16 a[84:85], v10 offset:12288
    s_waitcnt lgkmcnt(9)
    ds_read_b64_tr_b16 a[86:87], v10 offset:12800
    s_add_u32 s53, s53, s94
    s_add_u32 s53, s53, 0x4000
    v_mov_b32 v38, s75
    v_mfma_f32_32x32x16_bf16 v[112:127], a[92:95], v[244:247], v[112:127]
    ds_read_b64_tr_b16 a[88:89], v11 offset:12288
    ds_read_b64_tr_b16 a[90:91], v11 offset:12800
    s_waitcnt lgkmcnt(6)
    v_mfma_f32_32x32x16_bf16 v[64:79], a[64:67], v[248:251], v[64:79]
    ds_read_b64_tr_b16 a[92:93], v12 offset:12288
    ds_read_b64_tr_b16 a[94:95], v12 offset:12800
    v_mfma_f32_32x32x16_bf16 v[80:95], a[68:71], v[248:251], v[80:95]
    v_mfma_f32_32x32x16_bf16 v[96:111], a[72:75], v[248:251], v[96:111]
    v_mfma_f32_32x32x16_bf16 v[112:127], a[76:79], v[248:251], v[112:127]
    s_waitcnt lgkmcnt(0)
    v_mfma_f32_32x32x16_bf16 v[64:79], a[80:83], v[252:255], v[64:79]
    v_mfma_f32_32x32x16_bf16 v[80:95], a[84:87], v[252:255], v[80:95]
    v_mfma_f32_32x32x16_bf16 v[96:111], a[88:91], v[252:255], v[96:111]
    v_mfma_f32_32x32x16_bf16 v[112:127], a[92:95], v[252:255], v[112:127]
    s_barrier
    s_nop 7
    v_pk_mul_f32 v[64:65], v[64:65], v[20:21]
    v_pk_mul_f32 v[66:67], v[66:67], v[20:21]
    v_pk_mul_f32 v[68:69], v[68:69], v[20:21]
    v_pk_mul_f32 v[70:71], v[70:71], v[20:21]
    v_exp_f32 v64, v64
    v_exp_f32 v65, v65
    v_exp_f32 v66, v66
    v_exp_f32 v67, v67
    v_exp_f32 v68, v68
    v_exp_f32 v69, v69
    v_exp_f32 v70, v70
    v_exp_f32 v71, v71
    v_pk_add_f32 v[64:65], v[64:65], s[64:65]
    v_pk_add_f32 v[66:67], v[66:67], s[64:65]
    v_pk_add_f32 v[68:69], v[68:69], s[64:65]
    v_pk_add_f32 v[70:71], v[70:71], s[64:65]
    v_rcp_f32 v64, v64
    v_rcp_f32 v65, v65
    v_pk_mul_f32 v[72:73], v[72:73], v[18:19]
    v_rcp_f32 v66, v66
    v_rcp_f32 v67, v67
    v_pk_mul_f32 v[74:75], v[74:75], v[18:19]
    v_rcp_f32 v68, v68
    v_rcp_f32 v69, v69
    v_pk_mul_f32 v[76:77], v[76:77], v[18:19]
    v_rcp_f32 v70, v70
    v_rcp_f32 v71, v71
    v_pk_mul_f32 v[78:79], v[78:79], v[18:19]
    v_pk_mul_f32 v[72:73], v[72:73], v[64:65]
    v_pk_mul_f32 v[74:75], v[74:75], v[66:67]
    v_pk_mul_f32 v[76:77], v[76:77], v[68:69]
    v_pk_mul_f32 v[78:79], v[78:79], v[70:71]
    v_cvt_pk_bf16_f32 v40, v72, v73
    v_cvt_pk_bf16_f32 v41, v74, v75
    v_cvt_pk_bf16_f32 v42, v76, v77
    v_cvt_pk_bf16_f32 v43, v78, v79
    buffer_store_dwordx4 v[40:43], v62, s[20:23], s52 offen offset:0 sc1
    v_pk_mul_f32 v[80:81], v[80:81], v[20:21]
    v_pk_mul_f32 v[82:83], v[82:83], v[20:21]
    v_pk_mul_f32 v[84:85], v[84:85], v[20:21]
    v_pk_mul_f32 v[86:87], v[86:87], v[20:21]
    v_exp_f32 v80, v80
    v_exp_f32 v81, v81
    v_exp_f32 v82, v82
    v_exp_f32 v83, v83
    v_exp_f32 v84, v84
    v_exp_f32 v85, v85
    v_exp_f32 v86, v86
    v_exp_f32 v87, v87
    v_pk_add_f32 v[80:81], v[80:81], s[64:65]
    v_pk_add_f32 v[82:83], v[82:83], s[64:65]
    v_pk_add_f32 v[84:85], v[84:85], s[64:65]
    v_pk_add_f32 v[86:87], v[86:87], s[64:65]
    v_rcp_f32 v80, v80
    v_rcp_f32 v81, v81
    v_pk_mul_f32 v[88:89], v[88:89], v[18:19]
    v_rcp_f32 v82, v82
    v_rcp_f32 v83, v83
    v_pk_mul_f32 v[90:91], v[90:91], v[18:19]
    v_rcp_f32 v84, v84
    v_rcp_f32 v85, v85
    v_pk_mul_f32 v[92:93], v[92:93], v[18:19]
    v_rcp_f32 v86, v86
    v_rcp_f32 v87, v87
    v_pk_mul_f32 v[94:95], v[94:95], v[18:19]
    v_pk_mul_f32 v[88:89], v[88:89], v[80:81]
    v_pk_mul_f32 v[90:91], v[90:91], v[82:83]
    v_pk_mul_f32 v[92:93], v[92:93], v[84:85]
    v_pk_mul_f32 v[94:95], v[94:95], v[86:87]
    v_cvt_pk_bf16_f32 v44, v88, v89
    v_cvt_pk_bf16_f32 v45, v90, v91
    v_cvt_pk_bf16_f32 v46, v92, v93
    v_cvt_pk_bf16_f32 v47, v94, v95
    buffer_store_dwordx4 v[44:47], v62, s[20:23], s52 offen offset:1024 sc1
    v_pk_mul_f32 v[96:97], v[96:97], v[20:21]
    v_pk_mul_f32 v[98:99], v[98:99], v[20:21]
    v_pk_mul_f32 v[100:101], v[100:101], v[20:21]
    v_pk_mul_f32 v[102:103], v[102:103], v[20:21]
    v_exp_f32 v96, v96
    v_exp_f32 v97, v97
    v_exp_f32 v98, v98
    v_exp_f32 v99, v99
    v_exp_f32 v100, v100
    v_exp_f32 v101, v101
    v_exp_f32 v102, v102
    v_exp_f32 v103, v103
    v_pk_add_f32 v[96:97], v[96:97], s[64:65]
    v_pk_add_f32 v[98:99], v[98:99], s[64:65]
    v_pk_add_f32 v[100:101], v[100:101], s[64:65]
    v_pk_add_f32 v[102:103], v[102:103], s[64:65]
    v_rcp_f32 v96, v96
    v_rcp_f32 v97, v97
    v_pk_mul_f32 v[104:105], v[104:105], v[18:19]
    v_rcp_f32 v98, v98
    v_rcp_f32 v99, v99
    v_pk_mul_f32 v[106:107], v[106:107], v[18:19]
    v_rcp_f32 v100, v100
    v_rcp_f32 v101, v101
    v_pk_mul_f32 v[108:109], v[108:109], v[18:19]
    v_rcp_f32 v102, v102
    v_rcp_f32 v103, v103
    v_pk_mul_f32 v[110:111], v[110:111], v[18:19]
    v_pk_mul_f32 v[104:105], v[104:105], v[96:97]
    v_pk_mul_f32 v[106:107], v[106:107], v[98:99]
    v_pk_mul_f32 v[108:109], v[108:109], v[100:101]
    v_pk_mul_f32 v[110:111], v[110:111], v[102:103]
    v_cvt_pk_bf16_f32 v40, v104, v105
    v_cvt_pk_bf16_f32 v41, v106, v107
    v_cvt_pk_bf16_f32 v42, v108, v109
    v_cvt_pk_bf16_f32 v43, v110, v111
    buffer_store_dwordx4 v[40:43], v62, s[20:23], s52 offen offset:2048 sc1
    v_pk_mul_f32 v[112:113], v[112:113], v[20:21]
    v_pk_mul_f32 v[114:115], v[114:115], v[20:21]
    v_pk_mul_f32 v[116:117], v[116:117], v[20:21]
    v_pk_mul_f32 v[118:119], v[118:119], v[20:21]
    v_exp_f32 v112, v112
    v_exp_f32 v113, v113
    v_exp_f32 v114, v114
    v_exp_f32 v115, v115
    v_exp_f32 v116, v116
    v_exp_f32 v117, v117
    v_exp_f32 v118, v118
    v_exp_f32 v119, v119
    v_pk_add_f32 v[112:113], v[112:113], s[64:65]
    v_pk_add_f32 v[114:115], v[114:115], s[64:65]
    v_pk_add_f32 v[116:117], v[116:117], s[64:65]
    v_pk_add_f32 v[118:119], v[118:119], s[64:65]
    v_rcp_f32 v112, v112
    v_rcp_f32 v113, v113
    v_pk_mul_f32 v[120:121], v[120:121], v[18:19]
    v_rcp_f32 v114, v114
    v_rcp_f32 v115, v115
    v_pk_mul_f32 v[122:123], v[122:123], v[18:19]
    v_rcp_f32 v116, v116
    v_rcp_f32 v117, v117
    v_pk_mul_f32 v[124:125], v[124:125], v[18:19]
    v_rcp_f32 v118, v118
    v_rcp_f32 v119, v119
    v_pk_mul_f32 v[126:127], v[126:127], v[18:19]
    v_pk_mul_f32 v[120:121], v[120:121], v[112:113]
    v_pk_mul_f32 v[122:123], v[122:123], v[114:115]
    v_pk_mul_f32 v[124:125], v[124:125], v[116:117]
    v_pk_mul_f32 v[126:127], v[126:127], v[118:119]
    v_cvt_pk_bf16_f32 v44, v120, v121
    v_cvt_pk_bf16_f32 v45, v122, v123
    v_cvt_pk_bf16_f32 v46, v124, v125
    v_cvt_pk_bf16_f32 v47, v126, v127
    buffer_store_dwordx4 v[44:47], v62, s[20:23], s52 offen offset:3072 sc1
    buffer_load_dword v63, v59, s[20:23], s61 offen sc1
    s_waitcnt vmcnt(1)
    s_mov_b64 exec, 1
    buffer_store_dword v38, off, s[20:23], s53 sc1
    s_mov_b64 exec, -1
    s_mov_b32 s79, 60000
    s_waitcnt vmcnt(1)
L_poll_7:
    v_cmp_ne_u32 vcc, s75, v63
    s_cbranch_vccz L_polld_8
    s_sub_u32 s79, s79, 1
    s_cbranch_scc1 L_polld_8
    s_sleep 3
    buffer_load_dword v63, v59, s[20:23], s61 offen sc1
    s_waitcnt vmcnt(0)
    s_branch L_poll_7
L_polld_8:
    s_lshr_b32 s98, s80, 4
    s_add_u32 s98, s98, s59
    s_add_u32 m0, s47, 16384
    s_nop 0
    buffer_load_dwordx4 v62, s[20:23], s98 offen offset:0 sc1 lds
    buffer_load_dwordx4 v16, s[20:23], s98 offen offset:1024 sc1 lds
    s_lshr_b32 s98, s81, 4
    s_add_u32 s98, s98, s59
    s_add_u32 m0, s47, 18432
    s_nop 0
    buffer_load_dwordx4 v62, s[20:23], s98 offen offset:0 sc1 lds
    buffer_load_dwordx4 v16, s[20:23], s98 offen offset:1024 sc1 lds
    s_lshr_b32 s98, s82, 4
    s_add_u32 s98, s98, s59
    s_add_u32 m0, s47, 32768
    s_nop 0
    buffer_load_dwordx4 v62, s[20:23], s98 offen offset:0 sc1 lds
    buffer_load_dwordx4 v16, s[20:23], s98 offen offset:1024 sc1 lds
    s_lshr_b32 s98, s83, 4
    s_add_u32 s98, s98, s59
    s_add_u32 m0, s47, 34816
    s_nop 0
    buffer_load_dwordx4 v62, s[20:23], s98 offen offset:0 sc1 lds
    buffer_load_dwordx4 v16, s[20:23], s98 offen offset:1024 sc1 lds
    s_lshr_b32 s98, s84, 4
    s_add_u32 s98, s98, s59
    s_add_u32 m0, s47, 49152
    s_nop 0
    buffer_load_dwordx4 v62, s[20:23], s98 offen offset:0 sc1 lds
    buffer_load_dwordx4 v16, s[20:23], s98 offen offset:1024 sc1 lds
    s_lshr_b32 s98, s85, 4
    s_add_u32 s98, s98, s59
    s_add_u32 m0, s47, 51200
    s_nop 0
    buffer_load_dwordx4 v62, s[20:23], s98 offen offset:0 sc1 lds
    buffer_load_dwordx4 v16, s[20:23], s98 offen offset:1024 sc1 lds
    buffer_load_dword v252, off, s[20:23], s61
    buffer_load_dword v252, off, s[20:23], s61
    buffer_load_dword v252, off, s[20:23], s61
    buffer_load_dword v252, off, s[20:23], s61
    s_lshr_b32 s98, s86, 4
    s_add_u32 s98, s98, s59
    s_add_u32 m0, s47, 65536
    s_nop 0
    buffer_load_dwordx4 v62, s[20:23], s98 offen offset:0 sc1 lds
    buffer_load_dwordx4 v16, s[20:23], s98 offen offset:1024 sc1 lds
    s_lshr_b32 s98, s87, 4
    s_add_u32 s98, s98, s59
    s_add_u32 m0, s47, 67584
    s_nop 0
    buffer_load_dwordx4 v62, s[20:23], s98 offen offset:0 sc1 lds
    buffer_load_dwordx4 v16, s[20:23], s98 offen offset:1024 sc1 lds
    s_branch L_join_6
L_end:
    s_endpgm
.section .rodata,"a"
.p2align 6
.amdhsa_kernel recurrent_scan__spectral_fnet__glu_gated_glu__prompt_kernel
  .amdhsa_next_free_vgpr 512
  .amdhsa_next_free_sgpr 102
  .amdhsa_accum_offset 256
  .amdhsa_group_segment_fixed_size 0
  .amdhsa_kernarg_size 96
  .amdhsa_user_sgpr_count 2
  .amdhsa_user_sgpr_kernarg_segment_ptr 1
  .amdhsa_system_sgpr_workgroup_id_x 1
.end_amdhsa_kernel
```
